```python
import torch

def _softmax(x, axis=-1):
    return torch.softmax(x, dim=axis)
def _gelu(x):
    return torch.nn.functional.gelu(x, approximate="tanh")
def _silu(x):
    return torch.nn.functional.silu(x)
def _sigmoid(x):
    return torch.sigmoid(x)
def _layernorm(x, axis=-1, eps=1e-5):
    m = x.mean(dim=axis, keepdim=True)
    v = x.var(dim=axis, keepdim=True, unbiased=False)
    return (x - m) / torch.sqrt(v + eps)
def _scatter_add(tgt, idx, src, axis=0):
    return tgt.clone().index_add_(axis, idx, src)
def _segment_sum(src, seg, n):
    out = torch.zeros((n,) + src.shape[1:], dtype=src.dtype)
    return out.index_add_(0, seg, src)
def _pad(x, pw):
    flat = tuple(v for pair in reversed(pw) for v in pair)
    return torch.nn.functional.pad(x, flat)

kernel_name = 'recurrent_scan__grouped_kv_mqa__dense_activation_squared_relu__prompt'

def setup_inputs():

    _w = (lambda a: (lambda t: t.to(torch.bfloat16) if t.is_floating_point() else t)(torch.as_tensor(a)))
    def _A_setup():
        B, S, D, H = 1, 2048, 1024, 32
        Dh = D // H
        return {
            "x": _w((lambda *s: torch.randn(*s, dtype=torch.bfloat16) * 0.05)(B, S, D)),
            "wq": _w((lambda *s: torch.randn(*s, dtype=torch.bfloat16) * 0.05)(D, H * Dh)),
            "wk": _w((lambda *s: torch.randn(*s, dtype=torch.bfloat16) * 0.05)(D, Dh)),
            "wv": _w((lambda *s: torch.randn(*s, dtype=torch.bfloat16) * 0.05)(D, Dh)),
            "wo": _w((lambda *s: torch.randn(*s, dtype=torch.bfloat16) * 0.05)(H * Dh, D)),
        }
    _A_in = _A_setup()

    def _B_setup():
        B, S, D, F = 1, 2048, 1024, 3584
        return {
            "x": _w((lambda *s: torch.randn(*s, dtype=torch.bfloat16) * 0.05)(B, S, D)),
            "w1": _w((lambda *s: torch.randn(*s, dtype=torch.bfloat16) * 0.05)(D, F)),
            "b1": _w((lambda *s: torch.randn(*s, dtype=torch.bfloat16) * 0.8)(F)),
            "w2": _w((lambda *s: torch.randn(*s, dtype=torch.bfloat16) * 0.05)(F, D)),
            "b2": _w((lambda *s: torch.randn(*s, dtype=torch.bfloat16) * 6.4)(D)),
        }
    _B_in = _B_setup()

    return {
        "A_x": _A_in["x"],
        "A_wq": _A_in["wq"],
        "A_wk": _A_in["wk"],
        "A_wv": _A_in["wv"],
        "A_wo": _A_in["wo"],
        "B_x": _B_in["x"],
        "B_w1": _B_in["w1"],
        "B_b1": _B_in["b1"],
        "B_w2": _B_in["w2"],
        "B_b2": _B_in["b2"],
    }

def reference(A_x, A_wq, A_wk, A_wv, A_wo, B_x, B_w1, B_b1, B_w2, B_b2):
    def _A_ref(x, wq, wk, wv, wo):
        B, S, D = x.shape
        H = 32
        Dh = D // H
        q = (lambda x, *d: x.permute(*d))((x @ wq).reshape(B, S, H, Dh), 0, 2, 1, 3)
        k = x @ wk
        v = x @ wv
        scores = torch.einsum("bhqd,bkd->bhqk", q, k) * (Dh ** -0.5)
        p = _softmax(scores, axis=-1)
        o = torch.einsum("bhqk,bkd->bhqd", p, v)
        return (lambda x, *d: x.permute(*d))(o, 0, 2, 1, 3).reshape(B, S, H * Dh) @ wo

    def _B_ref(x, w1, b1, w2, b2):
        h = torch.einsum("bsd,df->bsf", x, w1) + b1
        zero = torch.zeros_like(h)
        r = torch.where(h > zero, h, zero)
        h = r * r
        out = torch.einsum("bsf,fd->bsd", h, w2) + b2
        return out

    x = A_x
    xn = _layernorm(x, axis=-1)
    s = _A_ref(xn, A_wq, A_wk, A_wv, A_wo)
    g = _silu(_B_ref(xn, B_w1, B_b1, B_w2, B_b2))
    return x + s * g
```

```asm
; @launch grid=(256,1,1) block=(512,1,1) lds=163840
.amdgcn_target "amdgcn-amd-amdhsa--gfx950"
.text
.globl recurrent_scan__grouped_kv_mqa__dense_activation_squared_relu__prompt_kernel
.p2align 8
.type recurrent_scan__grouped_kv_mqa__dense_activation_squared_relu__prompt_kernel,@function
recurrent_scan__grouped_kv_mqa__dense_activation_squared_relu__prompt_kernel:
    s_cmp_ge_u32 s2, 256
    s_cbranch_scc1 L_exit
    s_load_dwordx16 s[36:51], s[0:1], 0
    s_load_dwordx8 s[52:59], s[0:1], 64
    s_load_dwordx2 s[60:61], s[0:1], 96
    v_lshrrev_b32 v1, 6, v0
    v_and_b32 v0, 63, v0
    s_and_b32 s13, s2, 7
    v_readfirstlane_b32 s3, v1
    s_lshr_b32 s14, s2, 3
    s_and_b32 s4, s13, 3
    s_lshl_b32 s4, s4, 2
    s_and_b32 s15, s14, 3
    s_add_u32 s4, s4, s15
    s_lshr_b32 s5, s13, 2
    s_lshl_b32 s5, s5, 3
    s_lshr_b32 s15, s14, 2
    s_add_u32 s5, s5, s15
    s_and_b32 s6, s3, 3
    s_and_b32 s7, s6, 1
    s_lshr_b32 s8, s6, 1
    s_waitcnt lgkmcnt(0)
    s_mov_b32 s64, s60
    s_and_b32 s65, s61, 0xffff
    s_mov_b32 s66, 0x10000000
    s_mov_b32 s67, 0x00020000
    s_mov_b32 s68, s36
    s_and_b32 s69, s37, 0xffff
    s_mov_b32 s70, 0x400000
    s_mov_b32 s71, 0x00020000
    s_mov_b32 s32, s58
    s_and_b32 s33, s59, 0xffff
    s_mov_b32 s34, 0x100
    s_mov_b32 s35, 0x00020000
    v_lshlrev_b32 v5, 4, v0
    s_lshl_b32 s18, s7, 1
    s_add_u32 s19, s18, 1
    s_sub_u32 s19, s19, s8
    s_add_u32 s18, s18, s8
    s_and_b32 s25, s5, 1
    s_cmp_lt_u32 s5, 8
    s_cselect_b32 s12, 1, 0
    s_cmp_ge_u32 s3, 4
    s_cbranch_scc1 L_role_g_1
    v_mov_b32 v14, 0
    s_mov_b32 s72, s36
    s_and_b32 s73, s37, 0xffff
    s_mov_b32 s74, 0x400000
    s_mov_b32 s75, 0x00020000
    s_mov_b32 s80, s38
    s_and_b32 s81, s39, 0xffff
    s_mov_b32 s82, 0x200000
    s_mov_b32 s83, 0x00020000
    v_lshrrev_b32 v20, 3, v0
    v_and_b32 v21, 7, v0
    v_lshrrev_b32 v22, 4, v0
    v_xor_b32 v23, v21, v22
    v_lshlrev_b32 v23, 4, v23
    v_lshl_add_u32 v1, v20, 11, v23
    v_xor_b32 v2, 64, v1
    s_lshl_b32 s13, s4, 7
    s_lshl_b32 s14, s6, 4
    s_add_u32 s13, s13, s14
    s_lshl_b32 s88, s13, 11
    s_lshl_b32 s96, s6, 11
    v_and_b32 v23, 1, v22
    v_lshlrev_b32 v23, 2, v23
    v_xor_b32 v23, v23, v21
    v_lshlrev_b32 v23, 4, v23
    v_lshl_add_u32 v3, v20, 11, v23
    s_lshl_b32 s90, s6, 14
    s_lshl_b32 s13, s5, 7
    s_add_u32 s90, s90, s13
    s_mov_b32 s94, 65536
    s_lshl_b32 s98, s6, 10
    s_add_u32 s98, s98, 14336
    s_cmp_ge_u32 s6, 2
    s_cbranch_scc1 L_a_f_2
    s_cmp_eq_u32 s25, 0
    s_cselect_b32 s84, s40, s42
    s_cselect_b32 s85, s41, s43
    s_and_b32 s85, s85, 0xffff
    s_lshl_b32 s86, s12, 16
    s_mov_b32 s87, 0x00020000
    v_mov_b32 v4, v5
    s_lshl_b32 s91, s6, 10
    s_mov_b32 s95, 2048
    s_lshl_b32 s99, s6, 10
    s_add_u32 s99, s99, 18432
    s_branch L_a_fd_3
L_a_f_2:
    s_add_u32 s13, s6, 10
    s_mov_b32 s84, s48
    s_and_b32 s85, s49, 0xffff
    s_mov_b32 s86, 0x700000
    s_mov_b32 s87, 0x00020000
    s_cmp_ge_u32 s13, 7
    s_cselect_b32 s14, 1, 0
    s_mul_i32 s15, s14, 7
    s_sub_u32 s15, s13, s15
    s_lshl_b32 s15, s15, 10
    v_add_u32 v24, s15, v5
    s_mov_b32 s16, 9363
    v_mul_lo_u32 v25, v24, s16
    v_lshrrev_b32 v25, 22, v25
    s_mov_b32 s16, 6720
    v_mul_lo_u32 v25, v25, s16
    v_add_u32 v4, v24, v25
    s_mul_i32 s16, s14, 114688
    s_mul_i32 s91, s5, 448
    s_add_u32 s91, s91, s16
    s_mov_b32 s95, 229376
    s_mul_i32 s16, s14, 7168
    s_add_u32 s99, s15, s16
L_a_fd_3:
    s_add_u32 m0, s98, 0
    s_nop 0
    buffer_load_dwordx4 v3, s[80:83], s90 offen  lds
    s_add_u32 s90, s90, s94
    s_add_u32 m0, s99, 0
    s_nop 0
    buffer_load_dwordx4 v4, s[84:87], s91 offen  lds
    s_add_u32 s91, s91, s95
    s_add_u32 m0, s96, 102400
    s_add_u32 s92, s88, 0
    buffer_load_dwordx4 v1, s[72:75], s92 offen lds
    s_add_u32 m0, s96, 103424
    s_add_u32 s92, s88, 16384
    buffer_load_dwordx4 v2, s[72:75], s92 offen lds
    s_add_u32 m0, s96, 110592
    s_add_u32 s92, s88, 131072
    buffer_load_dwordx4 v1, s[72:75], s92 offen lds
    s_add_u32 m0, s96, 111616
    s_add_u32 s92, s88, 147456
    buffer_load_dwordx4 v2, s[72:75], s92 offen lds
    s_add_u32 m0, s98, 20480
    s_nop 0
    buffer_load_dwordx4 v3, s[80:83], s90 offen  lds
    s_add_u32 s90, s90, s94
    s_add_u32 m0, s99, 20480
    s_nop 0
    buffer_load_dwordx4 v4, s[84:87], s91 offen  lds
    s_add_u32 s91, s91, s95
    s_add_u32 m0, s98, 40960
    s_nop 0
    buffer_load_dwordx4 v3, s[80:83], s90 offen  lds
    s_add_u32 s90, s90, s94
    s_add_u32 m0, s99, 40960
    s_nop 0
    buffer_load_dwordx4 v4, s[84:87], s91 offen  lds
    s_add_u32 s91, s91, s95
    s_add_u32 m0, s96, 118784
    s_add_u32 s92, s88, 128
    buffer_load_dwordx4 v1, s[72:75], s92 offen lds
    s_add_u32 m0, s96, 119808
    s_add_u32 s92, s88, 16512
    buffer_load_dwordx4 v2, s[72:75], s92 offen lds
    s_add_u32 m0, s96, 126976
    s_add_u32 s92, s88, 131200
    buffer_load_dwordx4 v1, s[72:75], s92 offen lds
    s_add_u32 m0, s96, 128000
    s_add_u32 s92, s88, 147584
    buffer_load_dwordx4 v2, s[72:75], s92 offen lds
    s_add_u32 m0, s98, 61440
    s_nop 0
    buffer_load_dwordx4 v3, s[80:83], s90 offen  lds
    s_add_u32 s90, s90, s94
    s_add_u32 m0, s99, 61440
    s_nop 0
    buffer_load_dwordx4 v4, s[84:87], s91 offen  lds
    s_add_u32 s91, s91, s95
    v_lshrrev_b32 v20, 5, v0
    v_bfe_u32 v21, v0, 2, 2
    v_lshl_add_u32 v22, v20, 3, v21
    v_bfe_u32 v23, v0, 4, 1
    v_and_b32 v24, 3, v0
    v_lshlrev_b32 v25, 3, v24
    v_lshl_add_u32 v25, v23, 5, v25
    s_lshl_b32 s13, s8, 6
    v_add_u32 v26, s13, v25
    v_lshrrev_b32 v27, 1, v21
    v_lshlrev_b32 v27, 6, v27
    v_xor_b32 v26, v26, v27
    v_lshl_add_u32 v26, v22, 7, v26
    v_add_u32 v220, 14336, v26
    v_lshrrev_b32 v26, 4, v0
    v_lshl_add_u32 v27, v26, 3, v21
    v_lshlrev_b32 v27, 6, v27
    v_lshl_add_u32 v27, v24, 3, v27
    s_lshl_b32 s13, s7, 5
    s_add_u32 s13, s13, 18432
    v_add_u32 v222, s13, v27
    v_bfe_u32 v27, v0, 1, 3
    v_xor_b32 v27, v27, v26
    v_and_b32 v26, 15, v0
    v_lshlrev_b32 v26, 7, v26
    v_lshl_add_u32 v26, v27, 4, v26
    s_lshr_b32 s13, s5, 1
    s_and_b32 s13, s13, 3
    s_lshl_b32 s13, s13, 12
    s_lshl_b32 s14, s8, 11
    s_add_u32 s13, s13, s14
    s_add_u32 s13, s13, 102400
    v_add_u32 v232, s13, v26
    v_xor_b32 v233, 64, v232
    v_add_u32 v221, 0xf000, v220
    v_add_u32 v223, 0xf000, v222
    v_bfe_u32 v27, v0, 1, 3
    v_xor_b32 v27, v27, v20
    v_and_b32 v26, 31, v0
    v_lshlrev_b32 v26, 7, v26
    v_lshl_add_u32 v26, v27, 4, v26
    s_lshl_b32 s13, s18, 12
    s_add_u32 s13, s13, 102400
    s_lshl_b32 s14, s19, 12
    s_add_u32 s14, s14, 102400
    v_add_u32 v224, s13, v26
    v_add_u32 v228, s14, v26
    v_xor_b32 v225, 32, v224
    v_xor_b32 v226, 64, v224
    v_xor_b32 v227, 96, v224
    v_xor_b32 v229, 32, v228
    v_xor_b32 v230, 64, v228
    v_xor_b32 v231, 96, v228
    v_mov_b32 v116, 0
    v_mov_b32 v117, 0
    v_mov_b32 v118, 0
    v_mov_b32 v119, 0
    v_mov_b32 v120, 0
    v_mov_b32 v121, 0
    v_mov_b32 v122, 0
    v_mov_b32 v123, 0
    v_mov_b32 v124, 0
    v_mov_b32 v125, 0
    v_mov_b32 v126, 0
    v_mov_b32 v127, 0
    v_mov_b32 v128, 0
    v_mov_b32 v129, 0
    v_mov_b32 v130, 0
    v_mov_b32 v131, 0
    v_mov_b32 v132, 0
    v_mov_b32 v133, 0
    v_mov_b32 v134, 0
    v_mov_b32 v135, 0
    v_mov_b32 v136, 0
    v_mov_b32 v137, 0
    v_mov_b32 v138, 0
    v_mov_b32 v139, 0
    v_mov_b32 v140, 0
    v_mov_b32 v141, 0
    v_mov_b32 v142, 0
    v_mov_b32 v143, 0
    v_mov_b32 v144, 0
    v_mov_b32 v145, 0
    v_mov_b32 v146, 0
    v_mov_b32 v147, 0
    v_mov_b32 v148, 0
    v_mov_b32 v149, 0
    v_mov_b32 v150, 0
    v_mov_b32 v151, 0
    s_add_u32 s13, s2, s3
    s_cmp_lg_u32 s13, 0
    s_cbranch_scc1 L_pre_nononce_4
    s_memrealtime s[14:15]
    s_waitcnt lgkmcnt(0)
    v_mov_b32 v16, s14
    v_mov_b32 v17, s15
    v_or_b32 v16, 1, v16
    s_mov_b64 exec, 1
    buffer_store_dwordx2 v[16:17], v14, s[32:35], 0 offen offset:8 sc1
    s_mov_b64 exec, -1
    s_mov_b32 s14, 0
    s_mov_b32 s15, 0
L_pre_nononce_4:
    s_waitcnt vmcnt(10)
    s_barrier
    ds_read_b128 v[32:35], v224 offset:0
    ds_read_b64_tr_b16 v[20:21], v220 offset:0
    ds_read_b64_tr_b16 v[22:23], v220 offset:512
    ds_read_b128 v[36:39], v228 offset:0
    ds_read_b64_tr_b16 v[100:101], v222 offset:0
    ds_read_b64_tr_b16 v[102:103], v222 offset:256
    ds_read_b128 v[52:55], v225 offset:0
    ds_read_b64_tr_b16 v[40:41], v220 offset:2048
    ds_read_b64_tr_b16 v[42:43], v220 offset:2560
    ds_read_b128 v[56:59], v229 offset:0
    ds_read_b128 v[104:107], v232 offset:0
    s_waitcnt vmcnt(8) lgkmcnt(5)
    v_mfma_f32_32x32x16_bf16 v[116:131], v[20:23], v[32:35], v[116:131]
    s_barrier
    ds_read_b128 v[72:75], v226 offset:0
    ds_read_b64_tr_b16 v[60:61], v220 offset:20480
    ds_read_b64_tr_b16 v[62:63], v220 offset:20992
    s_add_u32 m0, s98, 81920
    s_nop 0
    buffer_load_dwordx4 v3, s[80:83], s90 offen  lds
    s_add_u32 s90, s90, s94
    s_lshl_b32 s13, s4, 7
    s_lshl_b32 s14, s5, 3
    s_add_u32 s13, s13, s14
    s_lshl_b32 s14, s6, 1
    s_add_u32 s23, s13, s14
    s_lshl_b32 s13, s23, 11
    buffer_load_dwordx4 v[24:27], v5, s[68:71], s13 offen
    buffer_load_dwordx4 v[28:31], v5, s[68:71], s13 offen offset:1024
    buffer_load_dwordx4 v[44:47], v5, s[68:71], s13 offen offset:2048
    buffer_load_dwordx4 v[48:51], v5, s[68:71], s13 offen offset:3072
    v_min_u32 v84, 39, v0
    s_and_b32 s20, s5, 1
    s_cmp_eq_u32 s20, 0
    s_cselect_b32 s15, s40, s42
    s_cselect_b32 s16, s41, s43
    s_lshl_b32 s13, s4, 6
    s_lshl_b32 s14, s6, 4
    s_add_u32 s13, s13, s14
    v_cmp_gt_u32 vcc, 8, v84
    v_cmp_lt_u32 s[26:27], 35, v84
    v_mov_b32 v86, s48
    v_mov_b32 v87, s49
    v_mov_b32 v88, s38
    v_mov_b32 v89, s39
    v_cndmask_b32 v86, v86, v88, vcc
    v_cndmask_b32 v87, v87, v89, vcc
    v_mov_b32 v88, s15
    v_mfma_f32_32x32x16_bf16 v[132:147], v[20:23], v[36:39], v[132:147]
    ds_read_b128 v[76:79], v230 offset:0
    ds_read_b64_tr_b16 v[108:109], v222 offset:20480
    ds_read_b64_tr_b16 v[110:111], v222 offset:20736
    s_add_u32 m0, s99, 81920
    s_nop 0
    buffer_load_dwordx4 v4, s[84:87], s91 offen  lds
    s_add_u32 s91, s91, s95
    v_mov_b32 v89, s16
    v_cndmask_b32 v86, v86, v88, s[26:27]
    v_cndmask_b32 v87, v87, v89, s[26:27]
    v_mov_b32 v90, 7168
    v_mov_b32 v88, 2048
    v_cndmask_b32 v90, v90, v88, vcc
    v_mov_b32 v88, 64
    v_cndmask_b32 v90, v90, v88, s[26:27]
    s_mul_i32 s14, s5, 448
    s_sub_u32 s14, s14, 128
    v_mov_b32 v91, s14
    s_lshl_b32 s14, s5, 7
    v_mov_b32 v88, s14
    v_cndmask_b32 v91, v91, v88, vcc
    v_mov_b32 v88, -576
    v_cndmask_b32 v91, v91, v88, s[26:27]
    v_lshl_add_u32 v91, v84, 4, v91
    v_mul_lo_u32 v88, v90, s13
    v_add_u32 v91, v91, v88
    v_add_co_u32 v86, vcc, v86, v91
    s_nop 1
    v_addc_co_u32 v87, vcc, 0, v87, vcc
    global_load_dwordx4 v[152:155], v[86:87], off
    v_add_co_u32 v86, vcc, v86, v90
    s_nop 1
    v_addc_co_u32 v87, vcc, 0, v87, vcc
    global_load_dwordx4 v[156:159], v[86:87], off
    v_add_co_u32 v86, vcc, v86, v90
    s_waitcnt lgkmcnt(6)
    v_mfma_f32_32x32x16_bf16 v[116:131], v[40:43], v[52:55], v[116:131]
    ds_read_b128 v[92:95], v227 offset:0
    s_add_u32 m0, s96, 135168
    s_add_u32 s92, s88, 256
    buffer_load_dwordx4 v1, s[72:75], s92 offen lds
    s_nop 1
    v_addc_co_u32 v87, vcc, 0, v87, vcc
    global_load_dwordx4 v[160:163], v[86:87], off
    v_add_co_u32 v86, vcc, v86, v90
    s_nop 1
    v_addc_co_u32 v87, vcc, 0, v87, vcc
    global_load_dwordx4 v[164:167], v[86:87], off
    v_add_co_u32 v86, vcc, v86, v90
    s_nop 1
    v_addc_co_u32 v87, vcc, 0, v87, vcc
    global_load_dwordx4 v[168:171], v[86:87], off
    v_add_co_u32 v86, vcc, v86, v90
    s_nop 1
    v_addc_co_u32 v87, vcc, 0, v87, vcc
    global_load_dwordx4 v[172:175], v[86:87], off
    v_add_co_u32 v86, vcc, v86, v90
    s_nop 1
    v_addc_co_u32 v87, vcc, 0, v87, vcc
    v_mfma_f32_32x32x16_bf16 v[132:147], v[40:43], v[56:59], v[132:147]
    ds_read_b64_tr_b16 v[80:81], v220 offset:22528
    ds_read_b64_tr_b16 v[82:83], v220 offset:23040
    s_add_u32 m0, s96, 136192
    s_add_u32 s92, s88, 16640
    buffer_load_dwordx4 v2, s[72:75], s92 offen lds
    global_load_dwordx4 v[176:179], v[86:87], off
    v_add_co_u32 v86, vcc, v86, v90
    s_nop 1
    v_addc_co_u32 v87, vcc, 0, v87, vcc
    global_load_dwordx4 v[180:183], v[86:87], off
    v_add_co_u32 v86, vcc, v86, v90
    s_nop 1
    v_addc_co_u32 v87, vcc, 0, v87, vcc
    global_load_dwordx4 v[184:187], v[86:87], off
    v_add_co_u32 v86, vcc, v86, v90
    s_nop 1
    v_addc_co_u32 v87, vcc, 0, v87, vcc
    global_load_dwordx4 v[188:191], v[86:87], off
    v_add_co_u32 v86, vcc, v86, v90
    s_nop 1
    v_addc_co_u32 v87, vcc, 0, v87, vcc
    global_load_dwordx4 v[192:195], v[86:87], off
    v_add_co_u32 v86, vcc, v86, v90
    s_cmp_eq_u32 s25, 1
    s_cbranch_scc1 L_kvv_1
    v_mfma_f32_16x16x32_bf16 v[148:151], v[100:103], v[104:107], v[148:151]
    s_branch L_kvd_1
L_kvv_1:
    v_mfma_f32_16x16x32_bf16 v[148:151], v[104:107], v[100:103], v[148:151]
L_kvd_1:
    ds_read_b128 v[96:99], v231 offset:0
    ds_read_b128 v[112:115], v233 offset:0
    s_add_u32 m0, s96, 143360
    s_add_u32 s92, s88, 131328
    buffer_load_dwordx4 v1, s[72:75], s92 offen lds
    s_add_u32 m0, s96, 144384
    s_add_u32 s92, s88, 147712
    buffer_load_dwordx4 v2, s[72:75], s92 offen lds
    s_nop 1
    v_addc_co_u32 v87, vcc, 0, v87, vcc
    global_load_dwordx4 v[196:199], v[86:87], off
    v_add_co_u32 v86, vcc, v86, v90
    s_nop 1
    v_addc_co_u32 v87, vcc, 0, v87, vcc
    global_load_dwordx4 v[200:203], v[86:87], off
    v_add_co_u32 v86, vcc, v86, v90
    s_nop 1
    v_addc_co_u32 v87, vcc, 0, v87, vcc
    global_load_dwordx4 v[204:207], v[86:87], off
    v_add_co_u32 v86, vcc, v86, v90
    s_nop 1
    v_addc_co_u32 v87, vcc, 0, v87, vcc
    global_load_dwordx4 v[208:211], v[86:87], off
    v_add_co_u32 v86, vcc, v86, v90
    s_nop 1
    v_addc_co_u32 v87, vcc, 0, v87, vcc
    global_load_dwordx4 v[212:215], v[86:87], off
    s_waitcnt vmcnt(28) lgkmcnt(5)
    v_mfma_f32_32x32x16_bf16 v[116:131], v[60:63], v[72:75], v[116:131]
    s_barrier
    ds_read_b128 v[32:35], v224 offset:16384
    ds_read_b64_tr_b16 v[20:21], v220 offset:40960
    ds_read_b64_tr_b16 v[22:23], v220 offset:41472
    v_mfma_f32_32x32x16_bf16 v[132:147], v[60:63], v[76:79], v[132:147]
    ds_read_b128 v[36:39], v228 offset:16384
    ds_read_b64_tr_b16 v[100:101], v222 offset:40960
    ds_read_b64_tr_b16 v[102:103], v222 offset:41216
    s_waitcnt lgkmcnt(6)
    v_mfma_f32_32x32x16_bf16 v[116:131], v[80:83], v[92:95], v[116:131]
    ds_read_b128 v[52:55], v225 offset:16384
    s_add_u32 m0, s98, 0
    s_nop 0
    buffer_load_dwordx4 v3, s[80:83], s90 offen  lds
    s_add_u32 s90, s90, s94
    v_mfma_f32_32x32x16_bf16 v[132:147], v[80:83], v[96:99], v[132:147]
    ds_read_b64_tr_b16 v[40:41], v220 offset:43008
    ds_read_b64_tr_b16 v[42:43], v220 offset:43520
    s_cmp_eq_u32 s25, 1
    s_cbranch_scc1 L_kvv_2
    v_mfma_f32_16x16x32_bf16 v[148:151], v[108:111], v[112:115], v[148:151]
    s_branch L_kvd_2
L_kvv_2:
    v_mfma_f32_16x16x32_bf16 v[148:151], v[112:115], v[108:111], v[148:151]
L_kvd_2:
    ds_read_b128 v[56:59], v229 offset:16384
    ds_read_b128 v[104:107], v232 offset:16384
    s_add_u32 m0, s99, 0
    s_nop 0
    buffer_load_dwordx4 v4, s[84:87], s91 offen  lds
    s_add_u32 s91, s91, s95
    s_waitcnt vmcnt(28) lgkmcnt(5)
    v_mfma_f32_32x32x16_bf16 v[116:131], v[20:23], v[32:35], v[116:131]
    s_barrier
    ds_read_b128 v[72:75], v226 offset:16384
    ds_read_b64_tr_b16 v[60:61], v221 offset:0
    ds_read_b64_tr_b16 v[62:63], v221 offset:512
    s_add_u32 m0, s98, 20480
    s_nop 0
    buffer_load_dwordx4 v3, s[80:83], s90 offen  lds
    s_add_u32 s90, s90, s94
    v_mfma_f32_32x32x16_bf16 v[132:147], v[20:23], v[36:39], v[132:147]
    ds_read_b128 v[76:79], v230 offset:16384
    ds_read_b64_tr_b16 v[108:109], v223 offset:0
    ds_read_b64_tr_b16 v[110:111], v223 offset:256
    s_add_u32 m0, s99, 20480
    s_nop 0
    buffer_load_dwordx4 v4, s[84:87], s91 offen  lds
    s_add_u32 s91, s91, s95
    s_waitcnt lgkmcnt(6)
    v_mfma_f32_32x32x16_bf16 v[116:131], v[40:43], v[52:55], v[116:131]
    ds_read_b128 v[92:95], v227 offset:16384
    s_add_u32 m0, s96, 102400
    s_add_u32 s92, s88, 384
    buffer_load_dwordx4 v1, s[72:75], s92 offen lds
    v_mfma_f32_32x32x16_bf16 v[132:147], v[40:43], v[56:59], v[132:147]
    ds_read_b64_tr_b16 v[80:81], v221 offset:2048
    ds_read_b64_tr_b16 v[82:83], v221 offset:2560
    s_add_u32 m0, s96, 103424
    s_add_u32 s92, s88, 16768
    buffer_load_dwordx4 v2, s[72:75], s92 offen lds
    s_cmp_eq_u32 s25, 1
    s_cbranch_scc1 L_kvv_3
    v_mfma_f32_16x16x32_bf16 v[148:151], v[100:103], v[104:107], v[148:151]
    s_branch L_kvd_3
L_kvv_3:
    v_mfma_f32_16x16x32_bf16 v[148:151], v[104:107], v[100:103], v[148:151]
L_kvd_3:
    ds_read_b128 v[96:99], v231 offset:16384
    ds_read_b128 v[112:115], v233 offset:16384
    s_add_u32 m0, s96, 110592
    s_add_u32 s92, s88, 131456
    buffer_load_dwordx4 v1, s[72:75], s92 offen lds
    s_add_u32 m0, s96, 111616
    s_add_u32 s92, s88, 147840
    buffer_load_dwordx4 v2, s[72:75], s92 offen lds
    s_waitcnt vmcnt(8)
    s_waitcnt vmcnt(13) lgkmcnt(5)
    v_mfma_f32_32x32x16_bf16 v[116:131], v[60:63], v[72:75], v[116:131]
    s_barrier
    ds_read_b128 v[32:35], v224 offset:32768
    ds_read_b64_tr_b16 v[20:21], v221 offset:20480
    ds_read_b64_tr_b16 v[22:23], v221 offset:20992
    v_lshlrev_b32 v64, 16, v152
    v_lshlrev_b32 v85, 16, v156
    v_add_f32 v64, v64, v85
    v_lshlrev_b32 v84, 16, v160
    v_add_f32 v64, v64, v84
    v_lshlrev_b32 v85, 16, v164
    v_add_f32 v64, v64, v85
    v_lshlrev_b32 v84, 16, v168
    v_add_f32 v64, v64, v84
    v_lshlrev_b32 v85, 16, v172
    v_add_f32 v64, v64, v85
    v_lshlrev_b32 v84, 16, v176
    v_mfma_f32_32x32x16_bf16 v[132:147], v[60:63], v[76:79], v[132:147]
    ds_read_b128 v[36:39], v228 offset:32768
    ds_read_b64_tr_b16 v[100:101], v223 offset:20480
    ds_read_b64_tr_b16 v[102:103], v223 offset:20736
    v_add_f32 v64, v64, v84
    v_lshlrev_b32 v85, 16, v180
    v_add_f32 v64, v64, v85
    v_lshlrev_b32 v84, 16, v184
    v_add_f32 v64, v64, v84
    v_lshlrev_b32 v85, 16, v188
    v_add_f32 v64, v64, v85
    v_lshlrev_b32 v84, 16, v192
    v_add_f32 v64, v64, v84
    v_lshlrev_b32 v85, 16, v196
    v_add_f32 v64, v64, v85
    v_lshlrev_b32 v84, 16, v200
    v_add_f32 v64, v64, v84
    s_waitcnt lgkmcnt(6)
    v_mfma_f32_32x32x16_bf16 v[116:131], v[80:83], v[92:95], v[116:131]
    ds_read_b128 v[52:55], v225 offset:32768
    s_add_u32 m0, s98, 40960
    s_nop 0
    buffer_load_dwordx4 v3, s[80:83], s90 offen  lds
    s_add_u32 s90, s90, s94
    v_lshlrev_b32 v85, 16, v204
    v_add_f32 v64, v64, v85
    v_lshlrev_b32 v84, 16, v208
    v_add_f32 v64, v64, v84
    v_lshlrev_b32 v85, 16, v212
    v_add_f32 v64, v64, v85
    v_and_b32 v65, 0xffff0000, v152
    v_and_b32 v85, 0xffff0000, v156
    v_mfma_f32_32x32x16_bf16 v[132:147], v[80:83], v[96:99], v[132:147]
    ds_read_b64_tr_b16 v[40:41], v221 offset:22528
    ds_read_b64_tr_b16 v[42:43], v221 offset:23040
    v_add_f32 v65, v65, v85
    v_and_b32 v84, 0xffff0000, v160
    v_add_f32 v65, v65, v84
    v_and_b32 v85, 0xffff0000, v164
    v_add_f32 v65, v65, v85
    v_and_b32 v84, 0xffff0000, v168
    v_add_f32 v65, v65, v84
    v_and_b32 v85, 0xffff0000, v172
    v_add_f32 v65, v65, v85
    s_cmp_eq_u32 s25, 1
    s_cbranch_scc1 L_kvv_4
    v_mfma_f32_16x16x32_bf16 v[148:151], v[108:111], v[112:115], v[148:151]
    s_branch L_kvd_4
L_kvv_4:
    v_mfma_f32_16x16x32_bf16 v[148:151], v[112:115], v[108:111], v[148:151]
L_kvd_4:
    ds_read_b128 v[56:59], v229 offset:32768
    ds_read_b128 v[104:107], v232 offset:32768
    s_add_u32 m0, s99, 40960
    s_nop 0
    buffer_load_dwordx4 v4, s[84:87], s91 offen  lds
    s_add_u32 s91, s91, s95
    v_and_b32 v84, 0xffff0000, v176
    v_add_f32 v65, v65, v84
    v_and_b32 v85, 0xffff0000, v180
    v_add_f32 v65, v65, v85
    v_and_b32 v84, 0xffff0000, v184
    v_add_f32 v65, v65, v84
    v_and_b32 v85, 0xffff0000, v188
    v_add_f32 v65, v65, v85
    v_and_b32 v84, 0xffff0000, v192
    s_waitcnt vmcnt(8) lgkmcnt(5)
    v_mfma_f32_32x32x16_bf16 v[116:131], v[20:23], v[32:35], v[116:131]
    s_barrier
    ds_read_b128 v[72:75], v226 offset:32768
    ds_read_b64_tr_b16 v[60:61], v220 offset:0
    ds_read_b64_tr_b16 v[62:63], v220 offset:512
    s_add_u32 m0, s98, 61440
    s_nop 0
    buffer_load_dwordx4 v3, s[80:83], s90 offen  lds
    s_add_u32 s90, s90, s94
    v_add_f32 v65, v65, v84
    v_and_b32 v85, 0xffff0000, v196
    v_add_f32 v65, v65, v85
    v_and_b32 v84, 0xffff0000, v200
    v_add_f32 v65, v65, v84
    v_and_b32 v85, 0xffff0000, v204
    v_add_f32 v65, v65, v85
    v_and_b32 v84, 0xffff0000, v208
    v_add_f32 v65, v65, v84
    v_and_b32 v85, 0xffff0000, v212
    v_add_f32 v65, v65, v85
    v_lshlrev_b32 v66, 16, v153
    v_mfma_f32_32x32x16_bf16 v[132:147], v[20:23], v[36:39], v[132:147]
    ds_read_b128 v[76:79], v230 offset:32768
    ds_read_b64_tr_b16 v[108:109], v222 offset:0
    ds_read_b64_tr_b16 v[110:111], v222 offset:256
    s_add_u32 m0, s99, 61440
    s_nop 0
    buffer_load_dwordx4 v4, s[84:87], s91 offen  lds
    s_add_u32 s91, s91, s95
    v_lshlrev_b32 v85, 16, v157
    v_add_f32 v66, v66, v85
    v_lshlrev_b32 v84, 16, v161
    v_add_f32 v66, v66, v84
    v_lshlrev_b32 v85, 16, v165
    v_add_f32 v66, v66, v85
    v_lshlrev_b32 v84, 16, v169
    v_add_f32 v66, v66, v84
    v_lshlrev_b32 v85, 16, v173
    v_add_f32 v66, v66, v85
    v_lshlrev_b32 v84, 16, v177
    v_add_f32 v66, v66, v84
    v_lshlrev_b32 v85, 16, v181
    s_waitcnt lgkmcnt(6)
    v_mfma_f32_32x32x16_bf16 v[116:131], v[40:43], v[52:55], v[116:131]
    ds_read_b128 v[92:95], v227 offset:32768
    s_add_u32 m0, s96, 118784
    s_add_u32 s92, s88, 512
    buffer_load_dwordx4 v1, s[72:75], s92 offen lds
    v_add_f32 v66, v66, v85
    v_lshlrev_b32 v84, 16, v185
    v_add_f32 v66, v66, v84
    v_lshlrev_b32 v85, 16, v189
    v_add_f32 v66, v66, v85
    v_lshlrev_b32 v84, 16, v193
    v_add_f32 v66, v66, v84
    v_lshlrev_b32 v85, 16, v197
    v_mfma_f32_32x32x16_bf16 v[132:147], v[40:43], v[56:59], v[132:147]
    ds_read_b64_tr_b16 v[80:81], v220 offset:2048
    ds_read_b64_tr_b16 v[82:83], v220 offset:2560
    s_add_u32 m0, s96, 119808
    s_add_u32 s92, s88, 16896
    buffer_load_dwordx4 v2, s[72:75], s92 offen lds
    v_add_f32 v66, v66, v85
    v_lshlrev_b32 v84, 16, v201
    v_add_f32 v66, v66, v84
    v_lshlrev_b32 v85, 16, v205
    v_add_f32 v66, v66, v85
    v_lshlrev_b32 v84, 16, v209
    v_add_f32 v66, v66, v84
    v_lshlrev_b32 v85, 16, v213
    v_add_f32 v66, v66, v85
    s_cmp_eq_u32 s25, 1
    s_cbranch_scc1 L_kvv_5
    v_mfma_f32_16x16x32_bf16 v[148:151], v[100:103], v[104:107], v[148:151]
    s_branch L_kvd_5
L_kvv_5:
    v_mfma_f32_16x16x32_bf16 v[148:151], v[104:107], v[100:103], v[148:151]
L_kvd_5:
    ds_read_b128 v[96:99], v231 offset:32768
    ds_read_b128 v[112:115], v233 offset:32768
    s_add_u32 m0, s96, 126976
    s_add_u32 s92, s88, 131584
    buffer_load_dwordx4 v1, s[72:75], s92 offen lds
    s_add_u32 m0, s96, 128000
    s_add_u32 s92, s88, 147968
    buffer_load_dwordx4 v2, s[72:75], s92 offen lds
    v_and_b32 v67, 0xffff0000, v153
    v_and_b32 v85, 0xffff0000, v157
    v_add_f32 v67, v67, v85
    v_and_b32 v84, 0xffff0000, v161
    v_add_f32 v67, v67, v84
    v_and_b32 v85, 0xffff0000, v165
    v_add_f32 v67, v67, v85
    v_and_b32 v84, 0xffff0000, v169
    v_add_f32 v67, v67, v84
    s_waitcnt vmcnt(8) lgkmcnt(5)
    v_mfma_f32_32x32x16_bf16 v[116:131], v[60:63], v[72:75], v[116:131]
    s_barrier
    ds_read_b128 v[32:35], v224 offset:0
    ds_read_b64_tr_b16 v[20:21], v220 offset:20480
    ds_read_b64_tr_b16 v[22:23], v220 offset:20992
    v_and_b32 v85, 0xffff0000, v173
    v_add_f32 v67, v67, v85
    v_and_b32 v84, 0xffff0000, v177
    v_add_f32 v67, v67, v84
    v_and_b32 v85, 0xffff0000, v181
    v_add_f32 v67, v67, v85
    v_and_b32 v84, 0xffff0000, v185
    v_add_f32 v67, v67, v84
    v_and_b32 v85, 0xffff0000, v189
    v_add_f32 v67, v67, v85
    v_and_b32 v84, 0xffff0000, v193
    v_add_f32 v67, v67, v84
    v_mfma_f32_32x32x16_bf16 v[132:147], v[60:63], v[76:79], v[132:147]
    ds_read_b128 v[36:39], v228 offset:0
    ds_read_b64_tr_b16 v[100:101], v222 offset:20480
    ds_read_b64_tr_b16 v[102:103], v222 offset:20736
    v_and_b32 v85, 0xffff0000, v197
    v_add_f32 v67, v67, v85
    v_and_b32 v84, 0xffff0000, v201
    v_add_f32 v67, v67, v84
    v_and_b32 v85, 0xffff0000, v205
    v_add_f32 v67, v67, v85
    v_and_b32 v84, 0xffff0000, v209
    v_add_f32 v67, v67, v84
    v_and_b32 v85, 0xffff0000, v213
    v_add_f32 v67, v67, v85
    v_lshlrev_b32 v68, 16, v154
    v_lshlrev_b32 v85, 16, v158
    v_add_f32 v68, v68, v85
    s_waitcnt lgkmcnt(6)
    v_mfma_f32_32x32x16_bf16 v[116:131], v[80:83], v[92:95], v[116:131]
    ds_read_b128 v[52:55], v225 offset:0
    s_add_u32 m0, s98, 81920
    s_nop 0
    buffer_load_dwordx4 v3, s[80:83], s90 offen  lds
    s_add_u32 s90, s90, s94
    v_lshlrev_b32 v84, 16, v162
    v_add_f32 v68, v68, v84
    v_lshlrev_b32 v85, 16, v166
    v_add_f32 v68, v68, v85
    v_lshlrev_b32 v84, 16, v170
    v_add_f32 v68, v68, v84
    v_lshlrev_b32 v85, 16, v174
    v_add_f32 v68, v68, v85
    v_mfma_f32_32x32x16_bf16 v[132:147], v[80:83], v[96:99], v[132:147]
    ds_read_b64_tr_b16 v[40:41], v220 offset:22528
    ds_read_b64_tr_b16 v[42:43], v220 offset:23040
    v_lshlrev_b32 v84, 16, v178
    v_add_f32 v68, v68, v84
    v_lshlrev_b32 v85, 16, v182
    v_add_f32 v68, v68, v85
    v_lshlrev_b32 v84, 16, v186
    v_add_f32 v68, v68, v84
    v_lshlrev_b32 v85, 16, v190
    v_add_f32 v68, v68, v85
    v_lshlrev_b32 v84, 16, v194
    s_cmp_eq_u32 s25, 1
    s_cbranch_scc1 L_kvv_6
    v_mfma_f32_16x16x32_bf16 v[148:151], v[108:111], v[112:115], v[148:151]
    s_branch L_kvd_6
L_kvv_6:
    v_mfma_f32_16x16x32_bf16 v[148:151], v[112:115], v[108:111], v[148:151]
L_kvd_6:
    ds_read_b128 v[56:59], v229 offset:0
    ds_read_b128 v[104:107], v232 offset:0
    s_add_u32 m0, s99, 81920
    s_nop 0
    buffer_load_dwordx4 v4, s[84:87], s91 offen  lds
    s_add_u32 s91, s91, s95
    v_add_f32 v68, v68, v84
    v_lshlrev_b32 v85, 16, v198
    v_add_f32 v68, v68, v85
    v_lshlrev_b32 v84, 16, v202
    v_add_f32 v68, v68, v84
    v_lshlrev_b32 v85, 16, v206
    v_add_f32 v68, v68, v85
    v_lshlrev_b32 v84, 16, v210
    v_add_f32 v68, v68, v84
    s_waitcnt vmcnt(8) lgkmcnt(5)
    v_mfma_f32_32x32x16_bf16 v[116:131], v[20:23], v[32:35], v[116:131]
    s_barrier
    ds_read_b128 v[72:75], v226 offset:0
    ds_read_b64_tr_b16 v[60:61], v220 offset:40960
    ds_read_b64_tr_b16 v[62:63], v220 offset:41472
    s_add_u32 m0, s98, 0
    s_nop 0
    buffer_load_dwordx4 v3, s[80:83], s90 offen  lds
    s_add_u32 s90, s90, s94
    v_lshlrev_b32 v85, 16, v214
    v_add_f32 v68, v68, v85
    v_and_b32 v69, 0xffff0000, v154
    v_and_b32 v85, 0xffff0000, v158
    v_add_f32 v69, v69, v85
    v_and_b32 v84, 0xffff0000, v162
    v_add_f32 v69, v69, v84
    v_and_b32 v85, 0xffff0000, v166
    v_add_f32 v69, v69, v85
    v_and_b32 v84, 0xffff0000, v170
    v_add_f32 v69, v69, v84
    v_and_b32 v85, 0xffff0000, v174
    v_mfma_f32_32x32x16_bf16 v[132:147], v[20:23], v[36:39], v[132:147]
    ds_read_b128 v[76:79], v230 offset:0
    ds_read_b64_tr_b16 v[108:109], v222 offset:40960
    ds_read_b64_tr_b16 v[110:111], v222 offset:41216
    s_add_u32 m0, s99, 0
    s_nop 0
    buffer_load_dwordx4 v4, s[84:87], s91 offen  lds
    s_add_u32 s91, s91, s95
    v_add_f32 v69, v69, v85
    v_and_b32 v84, 0xffff0000, v178
    v_add_f32 v69, v69, v84
    v_and_b32 v85, 0xffff0000, v182
    v_add_f32 v69, v69, v85
    v_and_b32 v84, 0xffff0000, v186
    v_add_f32 v69, v69, v84
    v_and_b32 v85, 0xffff0000, v190
    v_add_f32 v69, v69, v85
    v_and_b32 v84, 0xffff0000, v194
    v_add_f32 v69, v69, v84
    v_and_b32 v85, 0xffff0000, v198
    v_add_f32 v69, v69, v85
    s_waitcnt lgkmcnt(6)
    v_mfma_f32_32x32x16_bf16 v[116:131], v[40:43], v[52:55], v[116:131]
    ds_read_b128 v[92:95], v227 offset:0
    s_add_u32 m0, s96, 135168
    s_add_u32 s92, s88, 640
    buffer_load_dwordx4 v1, s[72:75], s92 offen lds
    v_and_b32 v84, 0xffff0000, v202
    v_add_f32 v69, v69, v84
    v_and_b32 v85, 0xffff0000, v206
    v_add_f32 v69, v69, v85
    v_and_b32 v84, 0xffff0000, v210
    v_add_f32 v69, v69, v84
    v_and_b32 v85, 0xffff0000, v214
    v_add_f32 v69, v69, v85
    v_mfma_f32_32x32x16_bf16 v[132:147], v[40:43], v[56:59], v[132:147]
    ds_read_b64_tr_b16 v[80:81], v220 offset:43008
    ds_read_b64_tr_b16 v[82:83], v220 offset:43520
    s_add_u32 m0, s96, 136192
    s_add_u32 s92, s88, 17024
    buffer_load_dwordx4 v2, s[72:75], s92 offen lds
    v_lshlrev_b32 v70, 16, v155
    v_lshlrev_b32 v85, 16, v159
    v_add_f32 v70, v70, v85
    v_lshlrev_b32 v84, 16, v163
    v_add_f32 v70, v70, v84
    v_lshlrev_b32 v85, 16, v167
    v_add_f32 v70, v70, v85
    v_lshlrev_b32 v84, 16, v171
    v_add_f32 v70, v70, v84
    s_cmp_eq_u32 s25, 1
    s_cbranch_scc1 L_kvv_7
    v_mfma_f32_16x16x32_bf16 v[148:151], v[100:103], v[104:107], v[148:151]
    s_branch L_kvd_7
L_kvv_7:
    v_mfma_f32_16x16x32_bf16 v[148:151], v[104:107], v[100:103], v[148:151]
L_kvd_7:
    ds_read_b128 v[96:99], v231 offset:0
    ds_read_b128 v[112:115], v233 offset:0
    s_add_u32 m0, s96, 143360
    s_add_u32 s92, s88, 131712
    buffer_load_dwordx4 v1, s[72:75], s92 offen lds
    s_add_u32 m0, s96, 144384
    s_add_u32 s92, s88, 148096
    buffer_load_dwordx4 v2, s[72:75], s92 offen lds
    v_lshlrev_b32 v85, 16, v175
    v_add_f32 v70, v70, v85
    v_lshlrev_b32 v84, 16, v179
    v_add_f32 v70, v70, v84
    v_lshlrev_b32 v85, 16, v183
    v_add_f32 v70, v70, v85
    v_lshlrev_b32 v84, 16, v187
    v_add_f32 v70, v70, v84
    v_lshlrev_b32 v85, 16, v191
    s_waitcnt vmcnt(8) lgkmcnt(5)
    v_mfma_f32_32x32x16_bf16 v[116:131], v[60:63], v[72:75], v[116:131]
    s_barrier
    ds_read_b128 v[32:35], v224 offset:16384
    ds_read_b64_tr_b16 v[20:21], v221 offset:0
    ds_read_b64_tr_b16 v[22:23], v221 offset:512
    v_add_f32 v70, v70, v85
    v_lshlrev_b32 v84, 16, v195
    v_add_f32 v70, v70, v84
    v_lshlrev_b32 v85, 16, v199
    v_add_f32 v70, v70, v85
    v_lshlrev_b32 v84, 16, v203
    v_add_f32 v70, v70, v84
    v_lshlrev_b32 v85, 16, v207
    v_add_f32 v70, v70, v85
    v_lshlrev_b32 v84, 16, v211
    v_add_f32 v70, v70, v84
    v_lshlrev_b32 v85, 16, v215
    v_mfma_f32_32x32x16_bf16 v[132:147], v[60:63], v[76:79], v[132:147]
    ds_read_b128 v[36:39], v228 offset:16384
    ds_read_b64_tr_b16 v[100:101], v223 offset:0
    ds_read_b64_tr_b16 v[102:103], v223 offset:256
    v_add_f32 v70, v70, v85
    v_and_b32 v71, 0xffff0000, v155
    v_and_b32 v85, 0xffff0000, v159
    v_add_f32 v71, v71, v85
    v_and_b32 v84, 0xffff0000, v163
    v_add_f32 v71, v71, v84
    v_and_b32 v85, 0xffff0000, v167
    v_add_f32 v71, v71, v85
    v_and_b32 v84, 0xffff0000, v171
    v_add_f32 v71, v71, v84
    v_and_b32 v85, 0xffff0000, v175
    v_add_f32 v71, v71, v85
    v_and_b32 v84, 0xffff0000, v179
    s_waitcnt lgkmcnt(6)
    v_mfma_f32_32x32x16_bf16 v[116:131], v[80:83], v[92:95], v[116:131]
    ds_read_b128 v[52:55], v225 offset:16384
    s_add_u32 m0, s98, 20480
    s_nop 0
    buffer_load_dwordx4 v3, s[80:83], s90 offen  lds
    s_add_u32 s90, s90, s94
    v_add_f32 v71, v71, v84
    v_and_b32 v85, 0xffff0000, v183
    v_add_f32 v71, v71, v85
    v_and_b32 v84, 0xffff0000, v187
    v_add_f32 v71, v71, v84
    v_and_b32 v85, 0xffff0000, v191
    v_add_f32 v71, v71, v85
    v_and_b32 v84, 0xffff0000, v195
    v_mfma_f32_32x32x16_bf16 v[132:147], v[80:83], v[96:99], v[132:147]
    ds_read_b64_tr_b16 v[40:41], v221 offset:2048
    ds_read_b64_tr_b16 v[42:43], v221 offset:2560
    v_add_f32 v71, v71, v84
    v_and_b32 v85, 0xffff0000, v199
    v_add_f32 v71, v71, v85
    v_and_b32 v84, 0xffff0000, v203
    v_add_f32 v71, v71, v84
    v_and_b32 v85, 0xffff0000, v207
    v_add_f32 v71, v71, v85
    v_and_b32 v84, 0xffff0000, v211
    v_add_f32 v71, v71, v84
    s_cmp_eq_u32 s25, 1
    s_cbranch_scc1 L_kvv_8
    v_mfma_f32_16x16x32_bf16 v[148:151], v[108:111], v[112:115], v[148:151]
    s_branch L_kvd_8
L_kvv_8:
    v_mfma_f32_16x16x32_bf16 v[148:151], v[112:115], v[108:111], v[148:151]
L_kvd_8:
    ds_read_b128 v[56:59], v229 offset:16384
    ds_read_b128 v[104:107], v232 offset:16384
    s_add_u32 m0, s99, 20480
    s_nop 0
    buffer_load_dwordx4 v4, s[84:87], s91 offen  lds
    s_add_u32 s91, s91, s95
    v_and_b32 v85, 0xffff0000, v215
    v_add_f32 v71, v71, v85
    v_min_u32 v84, 39, v0
    v_lshlrev_b32 v84, 5, v84
    s_mul_i32 s20, s6, 1280
    s_add_u32 s20, s20, 155392
    v_add_u32 v84, s20, v84
    ds_write_b128 v84, v[64:67]
    ds_write_b128 v84, v[68:71] offset:16
    s_waitcnt lgkmcnt(0)
    s_waitcnt vmcnt(8) lgkmcnt(5)
    v_mfma_f32_32x32x16_bf16 v[116:131], v[20:23], v[32:35], v[116:131]
    s_barrier
    ds_read_b128 v[72:75], v226 offset:16384
    ds_read_b64_tr_b16 v[60:61], v221 offset:20480
    ds_read_b64_tr_b16 v[62:63], v221 offset:20992
    s_add_u32 m0, s98, 40960
    s_nop 0
    buffer_load_dwordx4 v3, s[80:83], s90 offen  lds
    s_add_u32 s90, s90, s94
    v_min_u32 v85, 39, v0
    v_lshlrev_b32 v85, 3, v85
    s_mul_i32 s16, s6, 320
    s_add_u32 s20, s16, 155392
    v_add_u32 v84, s20, v85
    ds_read_b64 v[64:65], v84 offset:0
    ds_read_b64 v[66:67], v84 offset:1280
    ds_read_b64 v[68:69], v84 offset:2560
    ds_read_b64 v[70:71], v84 offset:3840
    v_lshlrev_b32 v152, 16, v24
    v_and_b32 v153, 0xffff0000, v24
    v_lshlrev_b32 v154, 16, v25
    v_and_b32 v155, 0xffff0000, v25
    v_lshlrev_b32 v156, 16, v26
    v_and_b32 v157, 0xffff0000, v26
    v_lshlrev_b32 v158, 16, v27
    v_mfma_f32_32x32x16_bf16 v[132:147], v[20:23], v[36:39], v[132:147]
    ds_read_b128 v[76:79], v230 offset:16384
    ds_read_b64_tr_b16 v[108:109], v223 offset:20480
    ds_read_b64_tr_b16 v[110:111], v223 offset:20736
    s_add_u32 m0, s99, 40960
    s_nop 0
    buffer_load_dwordx4 v4, s[84:87], s91 offen  lds
    s_add_u32 s91, s91, s95
    v_and_b32 v159, 0xffff0000, v27
    v_lshlrev_b32 v160, 16, v28
    v_and_b32 v161, 0xffff0000, v28
    v_lshlrev_b32 v162, 16, v29
    v_and_b32 v163, 0xffff0000, v29
    v_lshlrev_b32 v164, 16, v30
    v_and_b32 v165, 0xffff0000, v30
    v_lshlrev_b32 v166, 16, v31
    v_and_b32 v167, 0xffff0000, v31
    s_nop 0
    v_readfirstlane_b32 s21, v152
    s_nop 1
    v_mov_b32 v88, s21
    v_mov_b32 v86, 0
    v_mov_b32 v87, 0
    v_sub_f32 v152, v152, v88
    v_add_f32 v86, v86, v152
    v_fmac_f32 v87, v152, v152
    v_sub_f32 v153, v153, v88
    s_waitcnt lgkmcnt(6)
    v_mfma_f32_32x32x16_bf16 v[116:131], v[40:43], v[52:55], v[116:131]
    ds_read_b128 v[92:95], v227 offset:16384
    s_add_u32 m0, s96, 102400
    s_add_u32 s92, s88, 768
    buffer_load_dwordx4 v1, s[72:75], s92 offen lds
    v_add_f32 v86, v86, v153
    v_fmac_f32 v87, v153, v153
    v_sub_f32 v154, v154, v88
    v_add_f32 v86, v86, v154
    v_fmac_f32 v87, v154, v154
    v_sub_f32 v155, v155, v88
    v_add_f32 v86, v86, v155
    v_fmac_f32 v87, v155, v155
    v_mfma_f32_32x32x16_bf16 v[132:147], v[40:43], v[56:59], v[132:147]
    ds_read_b64_tr_b16 v[80:81], v221 offset:22528
    ds_read_b64_tr_b16 v[82:83], v221 offset:23040
    s_add_u32 m0, s96, 103424
    s_add_u32 s92, s88, 17152
    buffer_load_dwordx4 v2, s[72:75], s92 offen lds
    v_sub_f32 v156, v156, v88
    v_add_f32 v86, v86, v156
    v_fmac_f32 v87, v156, v156
    v_sub_f32 v157, v157, v88
    v_add_f32 v86, v86, v157
    v_fmac_f32 v87, v157, v157
    v_sub_f32 v158, v158, v88
    v_add_f32 v86, v86, v158
    s_cmp_eq_u32 s25, 1
    s_cbranch_scc1 L_kvv_9
    v_mfma_f32_16x16x32_bf16 v[148:151], v[100:103], v[104:107], v[148:151]
    s_branch L_kvd_9
L_kvv_9:
    v_mfma_f32_16x16x32_bf16 v[148:151], v[104:107], v[100:103], v[148:151]
L_kvd_9:
    ds_read_b128 v[96:99], v231 offset:16384
    ds_read_b128 v[112:115], v233 offset:16384
    s_add_u32 m0, s96, 110592
    s_add_u32 s92, s88, 131840
    buffer_load_dwordx4 v1, s[72:75], s92 offen lds
    s_add_u32 m0, s96, 111616
    s_add_u32 s92, s88, 148224
    buffer_load_dwordx4 v2, s[72:75], s92 offen lds
    v_fmac_f32 v87, v158, v158
    v_sub_f32 v159, v159, v88
    v_add_f32 v86, v86, v159
    v_fmac_f32 v87, v159, v159
    v_sub_f32 v160, v160, v88
    v_add_f32 v86, v86, v160
    v_fmac_f32 v87, v160, v160
    v_sub_f32 v161, v161, v88
    s_waitcnt vmcnt(8) lgkmcnt(5)
    v_mfma_f32_32x32x16_bf16 v[116:131], v[60:63], v[72:75], v[116:131]
    s_barrier
    ds_read_b128 v[32:35], v224 offset:32768
    ds_read_b64_tr_b16 v[20:21], v220 offset:0
    ds_read_b64_tr_b16 v[22:23], v220 offset:512
    v_add_f32 v64, v64, v66
    v_add_f32 v65, v65, v67
    v_add_f32 v64, v64, v68
    v_add_f32 v65, v65, v69
    v_add_f32 v64, v64, v70
    v_add_f32 v65, v65, v71
    s_lshl_b32 s20, s5, 4
    s_add_u32 s20, s20, s4
    s_mul_i32 s20, s20, 1280
    s_add_u32 s20, s20, s16
    s_add_u32 s20, s20, 17432576
    buffer_store_dwordx2 v[64:65], v85, s[64:67], s20 offen sc1
    v_add_f32 v86, v86, v161
    v_fmac_f32 v87, v161, v161
    v_sub_f32 v162, v162, v88
    v_add_f32 v86, v86, v162
    v_fmac_f32 v87, v162, v162
    v_mfma_f32_32x32x16_bf16 v[132:147], v[60:63], v[76:79], v[132:147]
    ds_read_b128 v[36:39], v228 offset:32768
    ds_read_b64_tr_b16 v[100:101], v222 offset:0
    ds_read_b64_tr_b16 v[102:103], v222 offset:256
    v_sub_f32 v163, v163, v88
    v_add_f32 v86, v86, v163
    v_fmac_f32 v87, v163, v163
    v_sub_f32 v164, v164, v88
    v_add_f32 v86, v86, v164
    v_fmac_f32 v87, v164, v164
    v_sub_f32 v165, v165, v88
    v_add_f32 v86, v86, v165
    v_fmac_f32 v87, v165, v165
    v_sub_f32 v166, v166, v88
    v_add_f32 v86, v86, v166
    v_fmac_f32 v87, v166, v166
    v_sub_f32 v167, v167, v88
    v_add_f32 v86, v86, v167
    v_fmac_f32 v87, v167, v167
    s_nop 1
    v_add_f32_dpp v86, v86, v86 row_shr:1 row_mask:0xf bank_mask:0xf bound_ctrl:0
    v_add_f32_dpp v87, v87, v87 row_shr:1 row_mask:0xf bank_mask:0xf bound_ctrl:0
    s_nop 0
    v_add_f32_dpp v86, v86, v86 row_shr:2 row_mask:0xf bank_mask:0xf bound_ctrl:0
    v_add_f32_dpp v87, v87, v87 row_shr:2 row_mask:0xf bank_mask:0xf bound_ctrl:0
    s_nop 0
    s_waitcnt lgkmcnt(6)
    v_mfma_f32_32x32x16_bf16 v[116:131], v[80:83], v[92:95], v[116:131]
    ds_read_b128 v[52:55], v225 offset:32768
    s_add_u32 m0, s98, 61440
    s_nop 0
    buffer_load_dwordx4 v3, s[80:83], s90 offen  lds
    s_add_u32 s90, s90, s94
    v_add_f32_dpp v86, v86, v86 row_shr:4 row_mask:0xf bank_mask:0xf bound_ctrl:0
    v_add_f32_dpp v87, v87, v87 row_shr:4 row_mask:0xf bank_mask:0xf bound_ctrl:0
    s_nop 0
    v_add_f32_dpp v86, v86, v86 row_shr:8 row_mask:0xf bank_mask:0xf bound_ctrl:0
    v_add_f32_dpp v87, v87, v87 row_shr:8 row_mask:0xf bank_mask:0xf bound_ctrl:0
    s_nop 0
    v_add_f32_dpp v86, v86, v86 row_bcast:15 row_mask:0xa bank_mask:0xf
    v_add_f32_dpp v87, v87, v87 row_bcast:15 row_mask:0xa bank_mask:0xf
    s_nop 0
    v_add_f32_dpp v86, v86, v86 row_bcast:31 row_mask:0xc bank_mask:0xf
    v_add_f32_dpp v87, v87, v87 row_bcast:31 row_mask:0xc bank_mask:0xf
    s_nop 0
    s_nop 0
    v_readlane_b32 s21, v86, 63
    v_readlane_b32 s22, v87, 63
    s_nop 1
    v_mov_b32 v86, s21
    v_mov_b32 v87, s22
    v_mul_f32 v86, 0x3a800000, v86
    v_mul_f32 v87, 0x3a800000, v87
    v_fma_f32 v87, -v86, v86, v87
    v_mfma_f32_32x32x16_bf16 v[132:147], v[80:83], v[96:99], v[132:147]
    ds_read_b64_tr_b16 v[40:41], v220 offset:2048
    ds_read_b64_tr_b16 v[42:43], v220 offset:2560
    v_max_f32 v87, 0, v87
    v_add_f32 v86, v86, v88
    v_cvt_pk_bf16_f32 v88, v86, v86
    v_lshlrev_b32 v88, 16, v88
    v_cvt_pk_bf16_f32 v87, v87, v87
    v_lshlrev_b32 v87, 16, v87
    v_add_f32 v87, 0x3727c5ac, v87
    v_cvt_pk_bf16_f32 v87, v87, v87
    s_cmp_eq_u32 s25, 1
    s_cbranch_scc1 L_kvv_10
    v_mfma_f32_16x16x32_bf16 v[148:151], v[108:111], v[112:115], v[148:151]
    s_branch L_kvd_10
L_kvv_10:
    v_mfma_f32_16x16x32_bf16 v[148:151], v[112:115], v[108:111], v[148:151]
L_kvd_10:
    ds_read_b128 v[56:59], v229 offset:32768
    ds_read_b128 v[104:107], v232 offset:32768
    s_add_u32 m0, s99, 61440
    s_nop 0
    buffer_load_dwordx4 v4, s[84:87], s91 offen  lds
    s_add_u32 s91, s91, s95
    v_lshlrev_b32 v87, 16, v87
    v_sqrt_f32 v87, v87
    s_nop 0
    v_cvt_pk_bf16_f32 v87, v87, v87
    v_lshlrev_b32 v87, 16, v87
    v_rcp_f32 v89, v87
    s_nop 0
    s_lshl_b32 s20, s23, 3
    s_add_u32 s20, s20, 17367040
    s_mov_b64 exec, 1
    buffer_store_dwordx2 v[88:89], v14, s[64:67], s20 offen sc1
    s_mov_b64 exec, -1
    s_nop 0
    s_waitcnt vmcnt(10) lgkmcnt(5)
    v_mfma_f32_32x32x16_bf16 v[116:131], v[20:23], v[32:35], v[116:131]
    s_barrier
    ds_read_b128 v[72:75], v226 offset:32768
    ds_read_b64_tr_b16 v[60:61], v220 offset:20480
    ds_read_b64_tr_b16 v[62:63], v220 offset:20992
    s_add_u32 m0, s98, 81920
    s_nop 0
    buffer_load_dwordx4 v3, s[80:83], s90 offen  lds
    s_add_u32 s90, s90, s94
    v_lshlrev_b32 v152, 16, v44
    v_and_b32 v153, 0xffff0000, v44
    v_lshlrev_b32 v154, 16, v45
    v_and_b32 v155, 0xffff0000, v45
    v_lshlrev_b32 v156, 16, v46
    v_and_b32 v157, 0xffff0000, v46
    v_lshlrev_b32 v158, 16, v47
    v_and_b32 v159, 0xffff0000, v47
    v_lshlrev_b32 v160, 16, v48
    v_and_b32 v161, 0xffff0000, v48
    v_lshlrev_b32 v162, 16, v49
    v_mfma_f32_32x32x16_bf16 v[132:147], v[20:23], v[36:39], v[132:147]
    ds_read_b128 v[76:79], v230 offset:32768
    ds_read_b64_tr_b16 v[108:109], v222 offset:20480
    ds_read_b64_tr_b16 v[110:111], v222 offset:20736
    s_add_u32 m0, s99, 81920
    s_nop 0
    buffer_load_dwordx4 v4, s[84:87], s91 offen  lds
    s_add_u32 s91, s91, s95
    v_and_b32 v163, 0xffff0000, v49
    v_lshlrev_b32 v164, 16, v50
    v_and_b32 v165, 0xffff0000, v50
    v_lshlrev_b32 v166, 16, v51
    v_and_b32 v167, 0xffff0000, v51
    s_nop 0
    v_readfirstlane_b32 s21, v152
    s_nop 1
    v_mov_b32 v88, s21
    v_mov_b32 v86, 0
    v_mov_b32 v87, 0
    v_sub_f32 v152, v152, v88
    v_add_f32 v86, v86, v152
    v_fmac_f32 v87, v152, v152
    v_sub_f32 v153, v153, v88
    s_waitcnt lgkmcnt(6)
    v_mfma_f32_32x32x16_bf16 v[116:131], v[40:43], v[52:55], v[116:131]
    ds_read_b128 v[92:95], v227 offset:32768
    s_add_u32 m0, s96, 118784
    s_add_u32 s92, s88, 896
    buffer_load_dwordx4 v1, s[72:75], s92 offen lds
    v_add_f32 v86, v86, v153
    v_fmac_f32 v87, v153, v153
    v_sub_f32 v154, v154, v88
    v_add_f32 v86, v86, v154
    v_fmac_f32 v87, v154, v154
    v_sub_f32 v155, v155, v88
    v_add_f32 v86, v86, v155
    v_fmac_f32 v87, v155, v155
    v_mfma_f32_32x32x16_bf16 v[132:147], v[40:43], v[56:59], v[132:147]
    ds_read_b64_tr_b16 v[80:81], v220 offset:22528
    ds_read_b64_tr_b16 v[82:83], v220 offset:23040
    s_add_u32 m0, s96, 119808
    s_add_u32 s92, s88, 17280
    buffer_load_dwordx4 v2, s[72:75], s92 offen lds
    v_sub_f32 v156, v156, v88
    v_add_f32 v86, v86, v156
    v_fmac_f32 v87, v156, v156
    v_sub_f32 v157, v157, v88
    v_add_f32 v86, v86, v157
    v_fmac_f32 v87, v157, v157
    v_sub_f32 v158, v158, v88
    v_add_f32 v86, v86, v158
    s_cmp_eq_u32 s25, 1
    s_cbranch_scc1 L_kvv_11
    v_mfma_f32_16x16x32_bf16 v[148:151], v[100:103], v[104:107], v[148:151]
    s_branch L_kvd_11
L_kvv_11:
    v_mfma_f32_16x16x32_bf16 v[148:151], v[104:107], v[100:103], v[148:151]
L_kvd_11:
    ds_read_b128 v[96:99], v231 offset:32768
    ds_read_b128 v[112:115], v233 offset:32768
    s_add_u32 m0, s96, 126976
    s_add_u32 s92, s88, 131968
    buffer_load_dwordx4 v1, s[72:75], s92 offen lds
    s_add_u32 m0, s96, 128000
    s_add_u32 s92, s88, 148352
    buffer_load_dwordx4 v2, s[72:75], s92 offen lds
    v_fmac_f32 v87, v158, v158
    v_sub_f32 v159, v159, v88
    v_add_f32 v86, v86, v159
    v_fmac_f32 v87, v159, v159
    v_sub_f32 v160, v160, v88
    v_add_f32 v86, v86, v160
    v_fmac_f32 v87, v160, v160
    v_sub_f32 v161, v161, v88
    s_waitcnt vmcnt(10) lgkmcnt(5)
    v_mfma_f32_32x32x16_bf16 v[116:131], v[60:63], v[72:75], v[116:131]
    s_barrier
    ds_read_b128 v[32:35], v224 offset:0
    ds_read_b64_tr_b16 v[20:21], v220 offset:40960
    ds_read_b64_tr_b16 v[22:23], v220 offset:41472
    buffer_load_dwordx2 v[18:19], v14, s[32:35], 0 offen offset:8 sc1
    v_add_f32 v86, v86, v161
    v_fmac_f32 v87, v161, v161
    v_sub_f32 v162, v162, v88
    v_add_f32 v86, v86, v162
    v_fmac_f32 v87, v162, v162
    v_sub_f32 v163, v163, v88
    v_add_f32 v86, v86, v163
    v_fmac_f32 v87, v163, v163
    v_sub_f32 v164, v164, v88
    v_add_f32 v86, v86, v164
    v_fmac_f32 v87, v164, v164
    v_mfma_f32_32x32x16_bf16 v[132:147], v[60:63], v[76:79], v[132:147]
    ds_read_b128 v[36:39], v228 offset:0
    ds_read_b64_tr_b16 v[100:101], v222 offset:40960
    ds_read_b64_tr_b16 v[102:103], v222 offset:41216
    v_sub_f32 v165, v165, v88
    v_add_f32 v86, v86, v165
    v_fmac_f32 v87, v165, v165
    v_sub_f32 v166, v166, v88
    v_add_f32 v86, v86, v166
    v_fmac_f32 v87, v166, v166
    v_sub_f32 v167, v167, v88
    v_add_f32 v86, v86, v167
    v_fmac_f32 v87, v167, v167
    s_nop 1
    v_add_f32_dpp v86, v86, v86 row_shr:1 row_mask:0xf bank_mask:0xf bound_ctrl:0
    v_add_f32_dpp v87, v87, v87 row_shr:1 row_mask:0xf bank_mask:0xf bound_ctrl:0
    s_nop 0
    v_add_f32_dpp v86, v86, v86 row_shr:2 row_mask:0xf bank_mask:0xf bound_ctrl:0
    v_add_f32_dpp v87, v87, v87 row_shr:2 row_mask:0xf bank_mask:0xf bound_ctrl:0
    s_nop 0
    s_waitcnt lgkmcnt(6)
    v_mfma_f32_32x32x16_bf16 v[116:131], v[80:83], v[92:95], v[116:131]
    ds_read_b128 v[52:55], v225 offset:0
    s_add_u32 m0, s98, 0
    s_nop 0
    buffer_load_dwordx4 v3, s[80:83], s90 offen  lds
    s_add_u32 s90, s90, s94
    v_add_f32_dpp v86, v86, v86 row_shr:4 row_mask:0xf bank_mask:0xf bound_ctrl:0
    v_add_f32_dpp v87, v87, v87 row_shr:4 row_mask:0xf bank_mask:0xf bound_ctrl:0
    s_nop 0
    v_add_f32_dpp v86, v86, v86 row_shr:8 row_mask:0xf bank_mask:0xf bound_ctrl:0
    v_add_f32_dpp v87, v87, v87 row_shr:8 row_mask:0xf bank_mask:0xf bound_ctrl:0
    s_nop 0
    v_add_f32_dpp v86, v86, v86 row_bcast:15 row_mask:0xa bank_mask:0xf
    v_add_f32_dpp v87, v87, v87 row_bcast:15 row_mask:0xa bank_mask:0xf
    s_nop 0
    v_add_f32_dpp v86, v86, v86 row_bcast:31 row_mask:0xc bank_mask:0xf
    v_add_f32_dpp v87, v87, v87 row_bcast:31 row_mask:0xc bank_mask:0xf
    s_nop 0
    s_nop 0
    v_readlane_b32 s21, v86, 63
    v_readlane_b32 s22, v87, 63
    s_nop 1
    v_mov_b32 v86, s21
    v_mov_b32 v87, s22
    v_mul_f32 v86, 0x3a800000, v86
    v_mul_f32 v87, 0x3a800000, v87
    v_fma_f32 v87, -v86, v86, v87
    v_mfma_f32_32x32x16_bf16 v[132:147], v[80:83], v[96:99], v[132:147]
    ds_read_b64_tr_b16 v[40:41], v220 offset:43008
    ds_read_b64_tr_b16 v[42:43], v220 offset:43520
    v_max_f32 v87, 0, v87
    v_add_f32 v86, v86, v88
    v_cvt_pk_bf16_f32 v88, v86, v86
    v_lshlrev_b32 v88, 16, v88
    v_cvt_pk_bf16_f32 v87, v87, v87
    v_lshlrev_b32 v87, 16, v87
    v_add_f32 v87, 0x3727c5ac, v87
    v_cvt_pk_bf16_f32 v87, v87, v87
    s_cmp_eq_u32 s25, 1
    s_cbranch_scc1 L_kvv_12
    v_mfma_f32_16x16x32_bf16 v[148:151], v[108:111], v[112:115], v[148:151]
    s_branch L_kvd_12
L_kvv_12:
    v_mfma_f32_16x16x32_bf16 v[148:151], v[112:115], v[108:111], v[148:151]
L_kvd_12:
    ds_read_b128 v[56:59], v229 offset:0
    ds_read_b128 v[104:107], v232 offset:0
    s_add_u32 m0, s99, 0
    s_nop 0
    buffer_load_dwordx4 v4, s[84:87], s91 offen  lds
    s_add_u32 s91, s91, s95
    v_lshlrev_b32 v87, 16, v87
    v_sqrt_f32 v87, v87
    s_nop 0
    v_cvt_pk_bf16_f32 v87, v87, v87
    v_lshlrev_b32 v87, 16, v87
    v_rcp_f32 v89, v87
    s_nop 0
    s_lshl_b32 s20, s23, 3
    s_add_u32 s20, s20, 17367048
    s_mov_b64 exec, 1
    buffer_store_dwordx2 v[88:89], v14, s[64:67], s20 offen sc1
    s_mov_b64 exec, -1
    s_nop 0
    s_waitcnt vmcnt(11) lgkmcnt(5)
    v_mfma_f32_32x32x16_bf16 v[116:131], v[20:23], v[32:35], v[116:131]
    s_barrier
    ds_read_b128 v[72:75], v226 offset:0
    ds_read_b64_tr_b16 v[60:61], v221 offset:0
    ds_read_b64_tr_b16 v[62:63], v221 offset:512
    s_add_u32 m0, s98, 20480
    s_nop 0
    buffer_load_dwordx4 v3, s[80:83], s90 offen  lds
    s_add_u32 s90, s90, s94
    v_mfma_f32_32x32x16_bf16 v[132:147], v[20:23], v[36:39], v[132:147]
    ds_read_b128 v[76:79], v230 offset:0
    ds_read_b64_tr_b16 v[108:109], v223 offset:0
    ds_read_b64_tr_b16 v[110:111], v223 offset:256
    s_add_u32 m0, s99, 20480
    s_nop 0
    buffer_load_dwordx4 v4, s[84:87], s91 offen  lds
    s_add_u32 s91, s91, s95
    s_waitcnt lgkmcnt(6)
    v_mfma_f32_32x32x16_bf16 v[116:131], v[40:43], v[52:55], v[116:131]
    ds_read_b128 v[92:95], v227 offset:0
    s_add_u32 m0, s96, 135168
    s_add_u32 s92, s88, 1024
    buffer_load_dwordx4 v1, s[72:75], s92 offen lds
    v_mfma_f32_32x32x16_bf16 v[132:147], v[40:43], v[56:59], v[132:147]
    ds_read_b64_tr_b16 v[80:81], v221 offset:2048
    ds_read_b64_tr_b16 v[82:83], v221 offset:2560
    s_add_u32 m0, s96, 136192
    s_add_u32 s92, s88, 17408
    buffer_load_dwordx4 v2, s[72:75], s92 offen lds
    s_cmp_eq_u32 s25, 1
    s_cbranch_scc1 L_kvv_13
    v_mfma_f32_16x16x32_bf16 v[148:151], v[100:103], v[104:107], v[148:151]
    s_branch L_kvd_13
L_kvv_13:
    v_mfma_f32_16x16x32_bf16 v[148:151], v[104:107], v[100:103], v[148:151]
L_kvd_13:
    ds_read_b128 v[96:99], v231 offset:0
    ds_read_b128 v[112:115], v233 offset:0
    s_add_u32 m0, s96, 143360
    s_add_u32 s92, s88, 132096
    buffer_load_dwordx4 v1, s[72:75], s92 offen lds
    s_add_u32 m0, s96, 144384
    s_add_u32 s92, s88, 148480
    buffer_load_dwordx4 v2, s[72:75], s92 offen lds
    s_waitcnt vmcnt(10) lgkmcnt(5)
    v_mfma_f32_32x32x16_bf16 v[116:131], v[60:63], v[72:75], v[116:131]
    s_barrier
    ds_read_b128 v[32:35], v224 offset:16384
    ds_read_b64_tr_b16 v[20:21], v221 offset:20480
    ds_read_b64_tr_b16 v[22:23], v221 offset:20992
    v_mfma_f32_32x32x16_bf16 v[132:147], v[60:63], v[76:79], v[132:147]
    ds_read_b128 v[36:39], v228 offset:16384
    ds_read_b64_tr_b16 v[100:101], v223 offset:20480
    ds_read_b64_tr_b16 v[102:103], v223 offset:20736
    s_waitcnt lgkmcnt(6)
    v_mfma_f32_32x32x16_bf16 v[116:131], v[80:83], v[92:95], v[116:131]
    ds_read_b128 v[52:55], v225 offset:16384
    s_add_u32 m0, s98, 40960
    s_nop 0
    buffer_load_dwordx4 v3, s[80:83], s90 offen  lds
    s_add_u32 s90, s90, s94
    v_mfma_f32_32x32x16_bf16 v[132:147], v[80:83], v[96:99], v[132:147]
    ds_read_b64_tr_b16 v[40:41], v221 offset:22528
    ds_read_b64_tr_b16 v[42:43], v221 offset:23040
    s_cmp_eq_u32 s25, 1
    s_cbranch_scc1 L_kvv_14
    v_mfma_f32_16x16x32_bf16 v[148:151], v[108:111], v[112:115], v[148:151]
    s_branch L_kvd_14
L_kvv_14:
    v_mfma_f32_16x16x32_bf16 v[148:151], v[112:115], v[108:111], v[148:151]
L_kvd_14:
    ds_read_b128 v[56:59], v229 offset:16384
    ds_read_b128 v[104:107], v232 offset:16384
    s_add_u32 m0, s99, 40960
    s_nop 0
    buffer_load_dwordx4 v4, s[84:87], s91 offen  lds
    s_add_u32 s91, s91, s95
    s_waitcnt vmcnt(9) lgkmcnt(5)
    v_mfma_f32_32x32x16_bf16 v[116:131], v[20:23], v[32:35], v[116:131]
    s_barrier
    ds_read_b128 v[72:75], v226 offset:16384
    ds_read_b64_tr_b16 v[60:61], v220 offset:0
    ds_read_b64_tr_b16 v[62:63], v220 offset:512
    s_add_u32 m0, s98, 61440
    s_nop 0
    buffer_load_dwordx4 v3, s[80:83], s90 offen  lds
    s_add_u32 s90, s90, s94
    v_mfma_f32_32x32x16_bf16 v[132:147], v[20:23], v[36:39], v[132:147]
    ds_read_b128 v[76:79], v230 offset:16384
    ds_read_b64_tr_b16 v[108:109], v222 offset:0
    ds_read_b64_tr_b16 v[110:111], v222 offset:256
    s_add_u32 m0, s99, 61440
    s_nop 0
    buffer_load_dwordx4 v4, s[84:87], s91 offen  lds
    s_add_u32 s91, s91, s95
    s_waitcnt lgkmcnt(6)
    v_mfma_f32_32x32x16_bf16 v[116:131], v[40:43], v[52:55], v[116:131]
    ds_read_b128 v[92:95], v227 offset:16384
    s_add_u32 m0, s96, 102400
    s_add_u32 s92, s88, 1152
    buffer_load_dwordx4 v1, s[72:75], s92 offen lds
    v_mfma_f32_32x32x16_bf16 v[132:147], v[40:43], v[56:59], v[132:147]
    ds_read_b64_tr_b16 v[80:81], v220 offset:2048
    ds_read_b64_tr_b16 v[82:83], v220 offset:2560
    s_add_u32 m0, s96, 103424
    s_add_u32 s92, s88, 17536
    buffer_load_dwordx4 v2, s[72:75], s92 offen lds
    s_cmp_eq_u32 s25, 1
    s_cbranch_scc1 L_kvv_15
    v_mfma_f32_16x16x32_bf16 v[148:151], v[100:103], v[104:107], v[148:151]
    s_branch L_kvd_15
L_kvv_15:
    v_mfma_f32_16x16x32_bf16 v[148:151], v[104:107], v[100:103], v[148:151]
L_kvd_15:
    ds_read_b128 v[96:99], v231 offset:16384
    ds_read_b128 v[112:115], v233 offset:16384
    s_add_u32 m0, s96, 110592
    s_add_u32 s92, s88, 132224
    buffer_load_dwordx4 v1, s[72:75], s92 offen lds
    s_add_u32 m0, s96, 111616
    s_add_u32 s92, s88, 148608
    buffer_load_dwordx4 v2, s[72:75], s92 offen lds
    s_waitcnt vmcnt(8) lgkmcnt(5)
    v_mfma_f32_32x32x16_bf16 v[116:131], v[60:63], v[72:75], v[116:131]
    s_barrier
    ds_read_b128 v[32:35], v224 offset:32768
    ds_read_b64_tr_b16 v[20:21], v220 offset:20480
    ds_read_b64_tr_b16 v[22:23], v220 offset:20992
    v_mfma_f32_32x32x16_bf16 v[132:147], v[60:63], v[76:79], v[132:147]
    ds_read_b128 v[36:39], v228 offset:32768
    ds_read_b64_tr_b16 v[100:101], v222 offset:20480
    ds_read_b64_tr_b16 v[102:103], v222 offset:20736
    s_waitcnt lgkmcnt(6)
    v_mfma_f32_32x32x16_bf16 v[116:131], v[80:83], v[92:95], v[116:131]
    ds_read_b128 v[52:55], v225 offset:32768
    s_add_u32 m0, s98, 81920
    s_nop 0
    buffer_load_dwordx4 v3, s[80:83], s90 offen  lds
    s_add_u32 s90, s90, s94
    v_mfma_f32_32x32x16_bf16 v[132:147], v[80:83], v[96:99], v[132:147]
    ds_read_b64_tr_b16 v[40:41], v220 offset:22528
    ds_read_b64_tr_b16 v[42:43], v220 offset:23040
    s_cmp_eq_u32 s25, 1
    s_cbranch_scc1 L_kvv_16
    v_mfma_f32_16x16x32_bf16 v[148:151], v[108:111], v[112:115], v[148:151]
    s_branch L_kvd_16
L_kvv_16:
    v_mfma_f32_16x16x32_bf16 v[148:151], v[112:115], v[108:111], v[148:151]
L_kvd_16:
    ds_read_b128 v[56:59], v229 offset:32768
    ds_read_b128 v[104:107], v232 offset:32768
    s_add_u32 m0, s99, 81920
    s_nop 0
    buffer_load_dwordx4 v4, s[84:87], s91 offen  lds
    s_add_u32 s91, s91, s95
    s_mov_b32 s17, 1048576
L_non_lp_6:
    v_readfirstlane_b32 s62, v18
    v_readfirstlane_b32 s63, v19
    s_cmp_lg_u32 s62, 0
    s_cbranch_scc1 L_non_dn_7
    s_sub_u32 s17, s17, 1
    s_cbranch_scc1 L_non_dn_7
    s_sleep 2
    buffer_load_dwordx2 v[18:19], v14, s[32:35], 0 offen offset:8 sc1
    s_waitcnt vmcnt(0)
    s_branch L_non_lp_6
L_non_dn_7:
    s_cmp_lg_u32 s3, 0
    s_cbranch_scc1 L_pre_sig_5
    s_lshl_b32 s13, s4, 4
    s_add_u32 s13, s13, s5
    s_lshl_b32 s13, s13, 3
    s_lshl_b32 s14, s5, 4
    s_add_u32 s14, s14, s4
    s_lshl_b32 s14, s14, 3
    s_add_u32 s14, s14, 2048
    v_mov_b32 v15, s13
    v_writelane_b32 v15, s14, 1
    s_mov_b32 s13, 17829888
    s_mov_b64 exec, 3
    buffer_store_dwordx2 v[18:19], v15, s[64:67], s13 offen sc1
    s_mov_b64 exec, -1
L_pre_sig_5:
    s_waitcnt vmcnt(8) lgkmcnt(5)
    v_mfma_f32_32x32x16_bf16 v[116:131], v[20:23], v[32:35], v[116:131]
    s_barrier
    ds_read_b128 v[72:75], v226 offset:32768
    ds_read_b64_tr_b16 v[60:61], v220 offset:40960
    ds_read_b64_tr_b16 v[62:63], v220 offset:41472
    s_add_u32 m0, s98, 0
    s_nop 0
    buffer_load_dwordx4 v3, s[80:83], s90 offen  lds
    s_add_u32 s90, s90, s94
    v_mfma_f32_32x32x16_bf16 v[132:147], v[20:23], v[36:39], v[132:147]
    ds_read_b128 v[76:79], v230 offset:32768
    ds_read_b64_tr_b16 v[108:109], v222 offset:40960
    ds_read_b64_tr_b16 v[110:111], v222 offset:41216
    s_add_u32 m0, s99, 0
    s_nop 0
    buffer_load_dwordx4 v4, s[84:87], s91 offen  lds
    s_add_u32 s91, s91, s95
    s_waitcnt lgkmcnt(6)
    v_mfma_f32_32x32x16_bf16 v[116:131], v[40:43], v[52:55], v[116:131]
    ds_read_b128 v[92:95], v227 offset:32768
    s_add_u32 m0, s96, 118784
    s_add_u32 s92, s88, 1280
    buffer_load_dwordx4 v1, s[72:75], s92 offen lds
    v_mfma_f32_32x32x16_bf16 v[132:147], v[40:43], v[56:59], v[132:147]
    ds_read_b64_tr_b16 v[80:81], v220 offset:43008
    ds_read_b64_tr_b16 v[82:83], v220 offset:43520
    s_add_u32 m0, s96, 119808
    s_add_u32 s92, s88, 17664
    buffer_load_dwordx4 v2, s[72:75], s92 offen lds
    s_cmp_eq_u32 s25, 1
    s_cbranch_scc1 L_kvv_17
    v_mfma_f32_16x16x32_bf16 v[148:151], v[100:103], v[104:107], v[148:151]
    s_branch L_kvd_17
L_kvv_17:
    v_mfma_f32_16x16x32_bf16 v[148:151], v[104:107], v[100:103], v[148:151]
L_kvd_17:
    ds_read_b128 v[96:99], v231 offset:32768
    ds_read_b128 v[112:115], v233 offset:32768
    s_add_u32 m0, s96, 126976
    s_add_u32 s92, s88, 132352
    buffer_load_dwordx4 v1, s[72:75], s92 offen lds
    s_add_u32 m0, s96, 128000
    s_add_u32 s92, s88, 148736
    buffer_load_dwordx4 v2, s[72:75], s92 offen lds
    s_waitcnt vmcnt(8) lgkmcnt(5)
    v_mfma_f32_32x32x16_bf16 v[116:131], v[60:63], v[72:75], v[116:131]
    s_barrier
    ds_read_b128 v[32:35], v224 offset:0
    ds_read_b64_tr_b16 v[20:21], v221 offset:0
    ds_read_b64_tr_b16 v[22:23], v221 offset:512
    v_mfma_f32_32x32x16_bf16 v[132:147], v[60:63], v[76:79], v[132:147]
    ds_read_b128 v[36:39], v228 offset:0
    ds_read_b64_tr_b16 v[100:101], v223 offset:0
    ds_read_b64_tr_b16 v[102:103], v223 offset:256
    s_waitcnt lgkmcnt(6)
    v_mfma_f32_32x32x16_bf16 v[116:131], v[80:83], v[92:95], v[116:131]
    ds_read_b128 v[52:55], v225 offset:0
    s_add_u32 m0, s98, 20480
    s_nop 0
    buffer_load_dwordx4 v3, s[80:83], s90 offen  lds
    s_add_u32 s90, s90, s94
    v_mfma_f32_32x32x16_bf16 v[132:147], v[80:83], v[96:99], v[132:147]
    ds_read_b64_tr_b16 v[40:41], v221 offset:2048
    ds_read_b64_tr_b16 v[42:43], v221 offset:2560
    s_cmp_eq_u32 s25, 1
    s_cbranch_scc1 L_kvv_18
    v_mfma_f32_16x16x32_bf16 v[148:151], v[108:111], v[112:115], v[148:151]
    s_branch L_kvd_18
L_kvv_18:
    v_mfma_f32_16x16x32_bf16 v[148:151], v[112:115], v[108:111], v[148:151]
L_kvd_18:
    ds_read_b128 v[56:59], v229 offset:0
    ds_read_b128 v[104:107], v232 offset:0
    s_add_u32 m0, s99, 20480
    s_nop 0
    buffer_load_dwordx4 v4, s[84:87], s91 offen  lds
    s_add_u32 s91, s91, s95
    s_waitcnt vmcnt(8) lgkmcnt(5)
    v_mfma_f32_32x32x16_bf16 v[116:131], v[20:23], v[32:35], v[116:131]
    s_barrier
    ds_read_b128 v[72:75], v226 offset:0
    ds_read_b64_tr_b16 v[60:61], v221 offset:20480
    ds_read_b64_tr_b16 v[62:63], v221 offset:20992
    s_add_u32 m0, s98, 40960
    s_nop 0
    buffer_load_dwordx4 v3, s[80:83], s90 offen  lds
    s_add_u32 s90, s90, s94
    v_mfma_f32_32x32x16_bf16 v[132:147], v[20:23], v[36:39], v[132:147]
    ds_read_b128 v[76:79], v230 offset:0
    ds_read_b64_tr_b16 v[108:109], v223 offset:20480
    ds_read_b64_tr_b16 v[110:111], v223 offset:20736
    s_add_u32 m0, s99, 40960
    s_nop 0
    buffer_load_dwordx4 v4, s[84:87], s91 offen  lds
    s_add_u32 s91, s91, s95
    s_waitcnt lgkmcnt(6)
    v_mfma_f32_32x32x16_bf16 v[116:131], v[40:43], v[52:55], v[116:131]
    ds_read_b128 v[92:95], v227 offset:0
    s_add_u32 m0, s96, 135168
    s_add_u32 s92, s88, 1408
    buffer_load_dwordx4 v1, s[72:75], s92 offen lds
    v_mfma_f32_32x32x16_bf16 v[132:147], v[40:43], v[56:59], v[132:147]
    ds_read_b64_tr_b16 v[80:81], v221 offset:22528
    ds_read_b64_tr_b16 v[82:83], v221 offset:23040
    s_add_u32 m0, s96, 136192
    s_add_u32 s92, s88, 17792
    buffer_load_dwordx4 v2, s[72:75], s92 offen lds
    s_cmp_eq_u32 s25, 1
    s_cbranch_scc1 L_kvv_19
    v_mfma_f32_16x16x32_bf16 v[148:151], v[100:103], v[104:107], v[148:151]
    s_branch L_kvd_19
L_kvv_19:
    v_mfma_f32_16x16x32_bf16 v[148:151], v[104:107], v[100:103], v[148:151]
L_kvd_19:
    ds_read_b128 v[96:99], v231 offset:0
    ds_read_b128 v[112:115], v233 offset:0
    s_add_u32 m0, s96, 143360
    s_add_u32 s92, s88, 132480
    buffer_load_dwordx4 v1, s[72:75], s92 offen lds
    s_add_u32 m0, s96, 144384
    s_add_u32 s92, s88, 148864
    buffer_load_dwordx4 v2, s[72:75], s92 offen lds
    s_waitcnt vmcnt(8) lgkmcnt(5)
    v_mfma_f32_32x32x16_bf16 v[116:131], v[60:63], v[72:75], v[116:131]
    s_barrier
    ds_read_b128 v[32:35], v224 offset:16384
    ds_read_b64_tr_b16 v[20:21], v220 offset:0
    ds_read_b64_tr_b16 v[22:23], v220 offset:512
    v_mfma_f32_32x32x16_bf16 v[132:147], v[60:63], v[76:79], v[132:147]
    ds_read_b128 v[36:39], v228 offset:16384
    ds_read_b64_tr_b16 v[100:101], v222 offset:0
    ds_read_b64_tr_b16 v[102:103], v222 offset:256
    s_waitcnt lgkmcnt(6)
    v_mfma_f32_32x32x16_bf16 v[116:131], v[80:83], v[92:95], v[116:131]
    ds_read_b128 v[52:55], v225 offset:16384
    s_add_u32 m0, s98, 61440
    s_nop 0
    buffer_load_dwordx4 v3, s[80:83], s90 offen  lds
    s_add_u32 s90, s90, s94
    v_mfma_f32_32x32x16_bf16 v[132:147], v[80:83], v[96:99], v[132:147]
    ds_read_b64_tr_b16 v[40:41], v220 offset:2048
    ds_read_b64_tr_b16 v[42:43], v220 offset:2560
    s_cmp_eq_u32 s25, 1
    s_cbranch_scc1 L_kvv_20
    v_mfma_f32_16x16x32_bf16 v[148:151], v[108:111], v[112:115], v[148:151]
    s_branch L_kvd_20
L_kvv_20:
    v_mfma_f32_16x16x32_bf16 v[148:151], v[112:115], v[108:111], v[148:151]
L_kvd_20:
    ds_read_b128 v[56:59], v229 offset:16384
    ds_read_b128 v[104:107], v232 offset:16384
    s_add_u32 m0, s99, 61440
    s_nop 0
    buffer_load_dwordx4 v4, s[84:87], s91 offen  lds
    s_add_u32 s91, s91, s95
    v_and_b32 v15, 15, v0
    v_lshlrev_b32 v15, 3, v15
    s_lshl_b32 s13, s4, 7
    s_lshl_b32 s14, s5, 7
    s_add_u32 s14, s14, 2048
    v_mov_b32 v16, s13
    v_mov_b32 v17, s14
    v_and_b32 v18, 16, v0
    v_cmp_eq_u32 vcc, 0, v18
    s_mov_b32 s22, 17829888
    s_nop 0
    v_cndmask_b32 v16, v17, v16, vcc
    v_add_u32 v15, v15, v16
    buffer_load_dwordx2 v[16:17], v15, s[64:67], s22 offen sc1
    s_waitcnt vmcnt(9) lgkmcnt(5)
    v_mfma_f32_32x32x16_bf16 v[116:131], v[20:23], v[32:35], v[116:131]
    s_barrier
    ds_read_b128 v[72:75], v226 offset:16384
    ds_read_b64_tr_b16 v[60:61], v220 offset:20480
    ds_read_b64_tr_b16 v[62:63], v220 offset:20992
    s_add_u32 m0, s98, 81920
    s_nop 0
    buffer_load_dwordx4 v3, s[80:83], s90 offen  lds
    s_add_u32 s90, s90, s94
    v_mfma_f32_32x32x16_bf16 v[132:147], v[20:23], v[36:39], v[132:147]
    ds_read_b128 v[76:79], v230 offset:16384
    ds_read_b64_tr_b16 v[108:109], v222 offset:20480
    ds_read_b64_tr_b16 v[110:111], v222 offset:20736
    s_add_u32 m0, s99, 81920
    s_nop 0
    buffer_load_dwordx4 v4, s[84:87], s91 offen  lds
    s_add_u32 s91, s91, s95
    s_waitcnt lgkmcnt(6)
    v_mfma_f32_32x32x16_bf16 v[116:131], v[40:43], v[52:55], v[116:131]
    ds_read_b128 v[92:95], v227 offset:16384
    s_add_u32 m0, s96, 102400
    s_add_u32 s92, s88, 1536
    buffer_load_dwordx4 v1, s[72:75], s92 offen lds
    v_mfma_f32_32x32x16_bf16 v[132:147], v[40:43], v[56:59], v[132:147]
    ds_read_b64_tr_b16 v[80:81], v220 offset:22528
    ds_read_b64_tr_b16 v[82:83], v220 offset:23040
    s_add_u32 m0, s96, 103424
    s_add_u32 s92, s88, 17920
    buffer_load_dwordx4 v2, s[72:75], s92 offen lds
    s_cmp_eq_u32 s25, 1
    s_cbranch_scc1 L_kvv_21
    v_mfma_f32_16x16x32_bf16 v[148:151], v[100:103], v[104:107], v[148:151]
    s_branch L_kvd_21
L_kvv_21:
    v_mfma_f32_16x16x32_bf16 v[148:151], v[104:107], v[100:103], v[148:151]
L_kvd_21:
    ds_read_b128 v[96:99], v231 offset:16384
    ds_read_b128 v[112:115], v233 offset:16384
    s_add_u32 m0, s96, 110592
    s_add_u32 s92, s88, 132608
    buffer_load_dwordx4 v1, s[72:75], s92 offen lds
    s_add_u32 m0, s96, 111616
    s_add_u32 s92, s88, 148992
    buffer_load_dwordx4 v2, s[72:75], s92 offen lds
    s_waitcnt vmcnt(9) lgkmcnt(5)
    v_mfma_f32_32x32x16_bf16 v[116:131], v[60:63], v[72:75], v[116:131]
    s_barrier
    ds_read_b128 v[32:35], v224 offset:32768
    ds_read_b64_tr_b16 v[20:21], v220 offset:40960
    ds_read_b64_tr_b16 v[22:23], v220 offset:41472
    v_mfma_f32_32x32x16_bf16 v[132:147], v[60:63], v[76:79], v[132:147]
    ds_read_b128 v[36:39], v228 offset:32768
    ds_read_b64_tr_b16 v[100:101], v222 offset:40960
    ds_read_b64_tr_b16 v[102:103], v222 offset:41216
    s_waitcnt lgkmcnt(6)
    v_mfma_f32_32x32x16_bf16 v[116:131], v[80:83], v[92:95], v[116:131]
    ds_read_b128 v[52:55], v225 offset:32768
    s_add_u32 m0, s98, 0
    s_nop 0
    buffer_load_dwordx4 v3, s[80:83], s90 offen  lds
    s_add_u32 s90, s90, s94
    v_mfma_f32_32x32x16_bf16 v[132:147], v[80:83], v[96:99], v[132:147]
    ds_read_b64_tr_b16 v[40:41], v220 offset:43008
    ds_read_b64_tr_b16 v[42:43], v220 offset:43520
    s_cmp_eq_u32 s25, 1
    s_cbranch_scc1 L_kvv_22
    v_mfma_f32_16x16x32_bf16 v[148:151], v[108:111], v[112:115], v[148:151]
    s_branch L_kvd_22
L_kvv_22:
    v_mfma_f32_16x16x32_bf16 v[148:151], v[112:115], v[108:111], v[148:151]
L_kvd_22:
    ds_read_b128 v[56:59], v229 offset:32768
    ds_read_b128 v[104:107], v232 offset:32768
    s_add_u32 m0, s99, 0
    s_nop 0
    buffer_load_dwordx4 v4, s[84:87], s91 offen  lds
    s_add_u32 s91, s91, s95
    s_waitcnt vmcnt(8)
    s_mov_b32 s17, 1048576
    s_branch L_pollc_10
L_poll_8:
    buffer_load_dwordx2 v[16:17], v15, s[64:67], s22 offen sc1
    s_waitcnt vmcnt(0)
L_pollc_10:
    v_cmp_ne_u64 vcc, s[62:63], v[16:17]
    s_sub_u32 s17, s17, 1
    s_cbranch_scc1 L_polld_9
    s_cmp_eq_u64 vcc, 0
    s_cbranch_scc1 L_polld_9
    s_sleep 1
    s_branch L_poll_8
L_polld_9:
    s_waitcnt vmcnt(9) lgkmcnt(5)
    v_mfma_f32_32x32x16_bf16 v[116:131], v[20:23], v[32:35], v[116:131]
    s_barrier
    ds_read_b128 v[72:75], v226 offset:32768
    ds_read_b64_tr_b16 v[60:61], v221 offset:0
    ds_read_b64_tr_b16 v[62:63], v221 offset:512
    s_add_u32 m0, s98, 20480
    s_nop 0
    buffer_load_dwordx4 v3, s[80:83], s90 offen  lds
    s_add_u32 s90, s90, s94
    v_and_b32 v15, 31, v0
    v_lshlrev_b32 v15, 3, v15
    s_lshl_b32 s20, s4, 2
    s_add_u32 s14, s20, s6
    s_lshl_b32 s14, s14, 8
    s_add_u32 s14, s14, 17367040
    buffer_load_dwordx2 v[184:185], v15, s[64:67], s14 offen sc1
    v_mfma_f32_32x32x16_bf16 v[132:147], v[20:23], v[36:39], v[132:147]
    ds_read_b128 v[76:79], v230 offset:32768
    ds_read_b64_tr_b16 v[108:109], v223 offset:0
    ds_read_b64_tr_b16 v[110:111], v223 offset:256
    s_add_u32 m0, s99, 20480
    s_nop 0
    buffer_load_dwordx4 v4, s[84:87], s91 offen  lds
    s_add_u32 s91, s91, s95
    v_min_u32 v17, 39, v0
    v_lshlrev_b32 v16, 1, v17
    v_lshlrev_b32 v17, 3, v17
    s_mul_i32 s14, s5, 20480
    s_mul_i32 s20, s6, 320
    s_add_u32 s14, s14, s20
    s_add_u32 s14, s14, 17432576
    s_waitcnt lgkmcnt(6)
    v_mfma_f32_32x32x16_bf16 v[116:131], v[40:43], v[52:55], v[116:131]
    ds_read_b128 v[92:95], v227 offset:32768
    s_add_u32 m0, s96, 118784
    s_add_u32 s92, s88, 1664
    buffer_load_dwordx4 v1, s[72:75], s92 offen lds
    buffer_load_dwordx2 v[152:153], v17, s[64:67], s14 offen sc1
    s_add_u32 s14, s14, 1280
    buffer_load_dwordx2 v[154:155], v17, s[64:67], s14 offen sc1
    s_add_u32 s14, s14, 1280
    buffer_load_dwordx2 v[156:157], v17, s[64:67], s14 offen sc1
    v_mfma_f32_32x32x16_bf16 v[132:147], v[40:43], v[56:59], v[132:147]
    ds_read_b64_tr_b16 v[80:81], v221 offset:2048
    ds_read_b64_tr_b16 v[82:83], v221 offset:2560
    s_add_u32 m0, s96, 119808
    s_add_u32 s92, s88, 18048
    buffer_load_dwordx4 v2, s[72:75], s92 offen lds
    s_add_u32 s14, s14, 1280
    buffer_load_dwordx2 v[158:159], v17, s[64:67], s14 offen sc1
    s_add_u32 s14, s14, 1280
    buffer_load_dwordx2 v[160:161], v17, s[64:67], s14 offen sc1
    s_add_u32 s14, s14, 1280
    s_cmp_eq_u32 s25, 1
    s_cbranch_scc1 L_kvv_23
    v_mfma_f32_16x16x32_bf16 v[148:151], v[100:103], v[104:107], v[148:151]
    s_branch L_kvd_23
L_kvv_23:
    v_mfma_f32_16x16x32_bf16 v[148:151], v[104:107], v[100:103], v[148:151]
L_kvd_23:
    ds_read_b128 v[96:99], v231 offset:32768
    ds_read_b128 v[112:115], v233 offset:32768
    s_add_u32 m0, s96, 126976
    s_add_u32 s92, s88, 132736
    buffer_load_dwordx4 v1, s[72:75], s92 offen lds
    s_add_u32 m0, s96, 128000
    s_add_u32 s92, s88, 149120
    buffer_load_dwordx4 v2, s[72:75], s92 offen lds
    buffer_load_dwordx2 v[162:163], v17, s[64:67], s14 offen sc1
    s_add_u32 s14, s14, 1280
    buffer_load_dwordx2 v[164:165], v17, s[64:67], s14 offen sc1
    s_add_u32 s14, s14, 1280
    buffer_load_dwordx2 v[166:167], v17, s[64:67], s14 offen sc1
    s_waitcnt vmcnt(17) lgkmcnt(5)
    v_mfma_f32_32x32x16_bf16 v[116:131], v[60:63], v[72:75], v[116:131]
    s_barrier
    ds_read_b128 v[32:35], v224 offset:0
    ds_read_b64_tr_b16 v[20:21], v221 offset:20480
    ds_read_b64_tr_b16 v[22:23], v221 offset:20992
    s_add_u32 s14, s14, 1280
    buffer_load_dwordx2 v[168:169], v17, s[64:67], s14 offen sc1
    s_add_u32 s14, s14, 1280
    buffer_load_dwordx2 v[170:171], v17, s[64:67], s14 offen sc1
    s_add_u32 s14, s14, 1280
    buffer_load_dwordx2 v[172:173], v17, s[64:67], s14 offen sc1
    s_add_u32 s14, s14, 1280
    v_mfma_f32_32x32x16_bf16 v[132:147], v[60:63], v[76:79], v[132:147]
    ds_read_b128 v[36:39], v228 offset:0
    ds_read_b64_tr_b16 v[100:101], v223 offset:20480
    ds_read_b64_tr_b16 v[102:103], v223 offset:20736
    buffer_load_dwordx2 v[174:175], v17, s[64:67], s14 offen sc1
    s_add_u32 s14, s14, 1280
    buffer_load_dwordx2 v[176:177], v17, s[64:67], s14 offen sc1
    s_add_u32 s14, s14, 1280
    buffer_load_dwordx2 v[178:179], v17, s[64:67], s14 offen sc1
    s_add_u32 s14, s14, 1280
    buffer_load_dwordx2 v[180:181], v17, s[64:67], s14 offen sc1
    s_add_u32 s14, s14, 1280
    s_waitcnt lgkmcnt(6)
    v_mfma_f32_32x32x16_bf16 v[116:131], v[80:83], v[92:95], v[116:131]
    ds_read_b128 v[52:55], v225 offset:0
    s_add_u32 m0, s98, 40960
    s_nop 0
    buffer_load_dwordx4 v3, s[80:83], s90 offen  lds
    s_add_u32 s90, s90, s94
    buffer_load_dwordx2 v[182:183], v17, s[64:67], s14 offen sc1
    s_mov_b32 s28, s50
    s_and_b32 s29, s51, 0xffff
    s_mov_b32 s30, 0x1c00
    s_mov_b32 s31, 0x00020000
    v_mfma_f32_32x32x16_bf16 v[132:147], v[80:83], v[96:99], v[132:147]
    ds_read_b64_tr_b16 v[40:41], v221 offset:22528
    ds_read_b64_tr_b16 v[42:43], v221 offset:23040
    s_mul_i32 s20, s6, 80
    v_add_u32 v16, s20, v16
    v_subrev_u32 v16, 64, v16
    v_cmp_gt_u32 vcc, 224, v16
    s_mul_i32 s20, s5, 224
    s_cmp_eq_u32 s25, 1
    s_cbranch_scc1 L_kvv_24
    v_mfma_f32_16x16x32_bf16 v[148:151], v[108:111], v[112:115], v[148:151]
    s_branch L_kvd_24
L_kvv_24:
    v_mfma_f32_16x16x32_bf16 v[148:151], v[112:115], v[108:111], v[148:151]
L_kvd_24:
    ds_read_b128 v[56:59], v229 offset:0
    ds_read_b128 v[104:107], v232 offset:0
    s_add_u32 m0, s99, 40960
    s_nop 0
    buffer_load_dwordx4 v4, s[84:87], s91 offen  lds
    s_add_u32 s91, s91, s95
    v_add_u32 v16, s20, v16
    v_lshlrev_b32 v16, 1, v16
    v_mov_b32 v15, 0x7ffffff0
    v_cndmask_b32 v16, v15, v16, vcc
    buffer_load_dword v186, v16, s[28:31], 0 offen
    s_waitcnt vmcnt(26) lgkmcnt(5)
    v_mfma_f32_32x32x16_bf16 v[116:131], v[20:23], v[32:35], v[116:131]
    s_barrier
    ds_read_b128 v[72:75], v226 offset:0
    ds_read_b64_tr_b16 v[60:61], v220 offset:0
    ds_read_b64_tr_b16 v[62:63], v220 offset:512
    s_add_u32 m0, s98, 61440
    s_nop 0
    buffer_load_dwordx4 v3, s[80:83], s90 offen  lds
    s_add_u32 s90, s90, s94
    v_mfma_f32_32x32x16_bf16 v[132:147], v[20:23], v[36:39], v[132:147]
    ds_read_b128 v[76:79], v230 offset:0
    ds_read_b64_tr_b16 v[108:109], v222 offset:0
    ds_read_b64_tr_b16 v[110:111], v222 offset:256
    s_add_u32 m0, s99, 61440
    s_nop 0
    buffer_load_dwordx4 v4, s[84:87], s91 offen  lds
    s_add_u32 s91, s91, s95
    s_waitcnt lgkmcnt(6)
    v_mfma_f32_32x32x16_bf16 v[116:131], v[40:43], v[52:55], v[116:131]
    ds_read_b128 v[92:95], v227 offset:0
    s_add_u32 m0, s96, 135168
    s_add_u32 s92, s88, 1792
    buffer_load_dwordx4 v1, s[72:75], s92 offen lds
    v_mfma_f32_32x32x16_bf16 v[132:147], v[40:43], v[56:59], v[132:147]
    ds_read_b64_tr_b16 v[80:81], v220 offset:2048
    ds_read_b64_tr_b16 v[82:83], v220 offset:2560
    s_add_u32 m0, s96, 136192
    s_add_u32 s92, s88, 18176
    buffer_load_dwordx4 v2, s[72:75], s92 offen lds
    s_cmp_eq_u32 s25, 1
    s_cbranch_scc1 L_kvv_25
    v_mfma_f32_16x16x32_bf16 v[148:151], v[100:103], v[104:107], v[148:151]
    s_branch L_kvd_25
L_kvv_25:
    v_mfma_f32_16x16x32_bf16 v[148:151], v[104:107], v[100:103], v[148:151]
L_kvd_25:
    ds_read_b128 v[96:99], v231 offset:0
    ds_read_b128 v[112:115], v233 offset:0
    s_add_u32 m0, s96, 143360
    s_add_u32 s92, s88, 132864
    buffer_load_dwordx4 v1, s[72:75], s92 offen lds
    s_add_u32 m0, s96, 144384
    s_add_u32 s92, s88, 149248
    buffer_load_dwordx4 v2, s[72:75], s92 offen lds
    s_waitcnt vmcnt(20) lgkmcnt(5)
    v_mfma_f32_32x32x16_bf16 v[116:131], v[60:63], v[72:75], v[116:131]
    s_barrier
    ds_read_b128 v[32:35], v224 offset:16384
    ds_read_b64_tr_b16 v[20:21], v220 offset:20480
    ds_read_b64_tr_b16 v[22:23], v220 offset:20992
    v_mfma_f32_32x32x16_bf16 v[132:147], v[60:63], v[76:79], v[132:147]
    ds_read_b128 v[36:39], v228 offset:16384
    ds_read_b64_tr_b16 v[100:101], v222 offset:20480
    ds_read_b64_tr_b16 v[102:103], v222 offset:20736
    s_waitcnt lgkmcnt(6)
    v_mfma_f32_32x32x16_bf16 v[116:131], v[80:83], v[92:95], v[116:131]
    ds_read_b128 v[52:55], v225 offset:16384
    s_add_u32 m0, s98, 81920
    s_nop 0
    buffer_load_dwordx4 v3, s[80:83], s90 offen  lds
    s_add_u32 s90, s90, s94
    v_mfma_f32_32x32x16_bf16 v[132:147], v[80:83], v[96:99], v[132:147]
    ds_read_b64_tr_b16 v[40:41], v220 offset:22528
    ds_read_b64_tr_b16 v[42:43], v220 offset:23040
    s_cmp_eq_u32 s25, 1
    s_cbranch_scc1 L_kvv_26
    v_mfma_f32_16x16x32_bf16 v[148:151], v[108:111], v[112:115], v[148:151]
    s_branch L_kvd_26
L_kvv_26:
    v_mfma_f32_16x16x32_bf16 v[148:151], v[112:115], v[108:111], v[148:151]
L_kvd_26:
    ds_read_b128 v[56:59], v229 offset:16384
    ds_read_b128 v[104:107], v232 offset:16384
    s_add_u32 m0, s99, 81920
    s_nop 0
    buffer_load_dwordx4 v4, s[84:87], s91 offen  lds
    s_add_u32 s91, s91, s95
    s_waitcnt vmcnt(9) lgkmcnt(5)
    v_mfma_f32_32x32x16_bf16 v[116:131], v[20:23], v[32:35], v[116:131]
    s_barrier
    ds_read_b128 v[72:75], v226 offset:16384
    ds_read_b64_tr_b16 v[60:61], v220 offset:40960
    ds_read_b64_tr_b16 v[62:63], v220 offset:41472
    s_add_u32 m0, s98, 0
    s_nop 0
    buffer_load_dwordx4 v3, s[80:83], s90 offen  lds
    s_add_u32 s90, s90, s94
    v_mfma_f32_32x32x16_bf16 v[132:147], v[20:23], v[36:39], v[132:147]
    ds_read_b128 v[76:79], v230 offset:16384
    ds_read_b64_tr_b16 v[108:109], v222 offset:40960
    ds_read_b64_tr_b16 v[110:111], v222 offset:41216
    s_add_u32 m0, s99, 0
    s_nop 0
    buffer_load_dwordx4 v4, s[84:87], s91 offen  lds
    s_add_u32 s91, s91, s95
    s_waitcnt lgkmcnt(6)
    v_mfma_f32_32x32x16_bf16 v[116:131], v[40:43], v[52:55], v[116:131]
    ds_read_b128 v[92:95], v227 offset:16384
    s_add_u32 m0, s96, 102400
    s_add_u32 s92, s88, 1920
    buffer_load_dwordx4 v1, s[72:75], s92 offen lds
    v_mfma_f32_32x32x16_bf16 v[132:147], v[40:43], v[56:59], v[132:147]
    ds_read_b64_tr_b16 v[80:81], v220 offset:43008
    ds_read_b64_tr_b16 v[82:83], v220 offset:43520
    s_add_u32 m0, s96, 103424
    s_add_u32 s92, s88, 18304
    buffer_load_dwordx4 v2, s[72:75], s92 offen lds
    s_cmp_eq_u32 s25, 1
    s_cbranch_scc1 L_kvv_27
    v_mfma_f32_16x16x32_bf16 v[148:151], v[100:103], v[104:107], v[148:151]
    s_branch L_kvd_27
L_kvv_27:
    v_mfma_f32_16x16x32_bf16 v[148:151], v[104:107], v[100:103], v[148:151]
L_kvd_27:
    ds_read_b128 v[96:99], v231 offset:16384
    ds_read_b128 v[112:115], v233 offset:16384
    s_add_u32 m0, s96, 110592
    s_add_u32 s92, s88, 132992
    buffer_load_dwordx4 v1, s[72:75], s92 offen lds
    s_add_u32 m0, s96, 111616
    s_add_u32 s92, s88, 149376
    buffer_load_dwordx4 v2, s[72:75], s92 offen lds
    s_waitcnt vmcnt(8) lgkmcnt(5)
    v_mfma_f32_32x32x16_bf16 v[116:131], v[60:63], v[72:75], v[116:131]
    s_barrier
    ds_read_b128 v[32:35], v224 offset:32768
    ds_read_b64_tr_b16 v[20:21], v221 offset:0
    ds_read_b64_tr_b16 v[22:23], v221 offset:512
    v_mfma_f32_32x32x16_bf16 v[132:147], v[60:63], v[76:79], v[132:147]
    ds_read_b128 v[36:39], v228 offset:32768
    ds_read_b64_tr_b16 v[100:101], v223 offset:0
    ds_read_b64_tr_b16 v[102:103], v223 offset:256
    s_waitcnt lgkmcnt(6)
    v_mfma_f32_32x32x16_bf16 v[116:131], v[80:83], v[92:95], v[116:131]
    ds_read_b128 v[52:55], v225 offset:32768
    s_add_u32 m0, s98, 20480
    s_nop 0
    buffer_load_dwordx4 v3, s[80:83], s90 offen  lds
    s_add_u32 s90, s90, s94
    v_mfma_f32_32x32x16_bf16 v[132:147], v[80:83], v[96:99], v[132:147]
    ds_read_b64_tr_b16 v[40:41], v221 offset:2048
    ds_read_b64_tr_b16 v[42:43], v221 offset:2560
    s_cmp_eq_u32 s25, 1
    s_cbranch_scc1 L_kvv_28
    v_mfma_f32_16x16x32_bf16 v[148:151], v[108:111], v[112:115], v[148:151]
    s_branch L_kvd_28
L_kvv_28:
    v_mfma_f32_16x16x32_bf16 v[148:151], v[112:115], v[108:111], v[148:151]
L_kvd_28:
    ds_read_b128 v[56:59], v229 offset:32768
    ds_read_b128 v[104:107], v232 offset:32768
    s_add_u32 m0, s99, 20480
    s_nop 0
    buffer_load_dwordx4 v4, s[84:87], s91 offen  lds
    s_add_u32 s91, s91, s95
    s_waitcnt vmcnt(16)
    s_waitcnt vmcnt(8) lgkmcnt(5)
    v_mfma_f32_32x32x16_bf16 v[116:131], v[20:23], v[32:35], v[116:131]
    s_barrier
    ds_read_b128 v[72:75], v226 offset:32768
    ds_read_b64_tr_b16 v[60:61], v221 offset:20480
    ds_read_b64_tr_b16 v[62:63], v221 offset:20992
    v_add_f32 v152, v152, v154
    v_add_f32 v153, v153, v155
    v_add_f32 v152, v152, v156
    v_add_f32 v153, v153, v157
    v_add_f32 v152, v152, v158
    v_add_f32 v153, v153, v159
    v_add_f32 v152, v152, v160
    v_mfma_f32_32x32x16_bf16 v[132:147], v[20:23], v[36:39], v[132:147]
    ds_read_b128 v[76:79], v230 offset:32768
    ds_read_b64_tr_b16 v[108:109], v223 offset:20480
    ds_read_b64_tr_b16 v[110:111], v223 offset:20736
    v_add_f32 v153, v153, v161
    v_add_f32 v152, v152, v162
    v_add_f32 v153, v153, v163
    v_add_f32 v152, v152, v164
    v_add_f32 v153, v153, v165
    v_add_f32 v152, v152, v166
    v_add_f32 v153, v153, v167
    s_waitcnt lgkmcnt(6)
    v_mfma_f32_32x32x16_bf16 v[116:131], v[40:43], v[52:55], v[116:131]
    ds_read_b128 v[92:95], v227 offset:32768
    v_add_f32 v152, v152, v168
    v_add_f32 v153, v153, v169
    v_add_f32 v152, v152, v170
    v_add_f32 v153, v153, v171
    v_mfma_f32_32x32x16_bf16 v[132:147], v[40:43], v[56:59], v[132:147]
    ds_read_b64_tr_b16 v[80:81], v221 offset:22528
    ds_read_b64_tr_b16 v[82:83], v221 offset:23040
    v_add_f32 v152, v152, v172
    v_add_f32 v153, v153, v173
    v_add_f32 v152, v152, v174
    v_add_f32 v153, v153, v175
    v_add_f32 v152, v152, v176
    s_cmp_eq_u32 s25, 1
    s_cbranch_scc1 L_kvv_29
    v_mfma_f32_16x16x32_bf16 v[148:151], v[100:103], v[104:107], v[148:151]
    s_branch L_kvd_29
L_kvv_29:
    v_mfma_f32_16x16x32_bf16 v[148:151], v[104:107], v[100:103], v[148:151]
L_kvd_29:
    ds_read_b128 v[96:99], v231 offset:32768
    ds_read_b128 v[112:115], v233 offset:32768
    v_add_f32 v153, v153, v177
    v_add_f32 v152, v152, v178
    v_add_f32 v153, v153, v179
    v_add_f32 v152, v152, v180
    v_add_f32 v153, v153, v181
    s_waitcnt vmcnt(2) lgkmcnt(5)
    v_mfma_f32_32x32x16_bf16 v[116:131], v[60:63], v[72:75], v[116:131]
    s_barrier
    ds_read_b128 v[32:35], v224 offset:0
    ds_read_b64_tr_b16 v[20:21], v220 offset:0
    ds_read_b64_tr_b16 v[22:23], v220 offset:512
    v_add_f32 v152, v152, v182
    v_add_f32 v153, v153, v183
    v_and_b32 v187, 0xffff0000, v186
    v_lshlrev_b32 v186, 16, v186
    v_min_u32 v16, 39, v0
    v_lshlrev_b32 v16, 1, v16
    s_mul_i32 s20, s6, 80
    v_mfma_f32_32x32x16_bf16 v[132:147], v[60:63], v[76:79], v[132:147]
    ds_read_b128 v[36:39], v228 offset:0
    ds_read_b64_tr_b16 v[100:101], v222 offset:0
    ds_read_b64_tr_b16 v[102:103], v222 offset:256
    v_add_u32 v16, s20, v16
    v_lshrrev_b32 v17, 5, v16
    v_and_b32 v16, 31, v16
    v_lshlrev_b32 v16, 2, v16
    v_lshl_add_u32 v16, v17, 8, v16
    v_add_u32 v16, 151552, v16
    ds_write_b64 v16, v[152:153]
    s_waitcnt lgkmcnt(6)
    v_mfma_f32_32x32x16_bf16 v[116:131], v[80:83], v[92:95], v[116:131]
    ds_read_b128 v[52:55], v225 offset:0
    ds_write_b64 v16, v[186:187] offset:128
    v_and_b32 v16, 31, v0
    v_lshlrev_b32 v16, 3, v16
    s_lshl_b32 s20, s6, 8
    v_mfma_f32_32x32x16_bf16 v[132:147], v[80:83], v[96:99], v[132:147]
    ds_read_b64_tr_b16 v[40:41], v220 offset:2048
    ds_read_b64_tr_b16 v[42:43], v220 offset:2560
    s_add_u32 s20, s20, 154112
    v_add_u32 v16, s20, v16
    ds_write_b64 v16, v[184:185]
    v_mov_b32 v16, 155136
    v_mov_b32 v18, s62
    s_cmp_eq_u32 s25, 1
    s_cbranch_scc1 L_kvv_30
    v_mfma_f32_16x16x32_bf16 v[148:151], v[108:111], v[112:115], v[148:151]
    s_branch L_kvd_30
L_kvv_30:
    v_mfma_f32_16x16x32_bf16 v[148:151], v[112:115], v[108:111], v[148:151]
L_kvd_30:
    ds_read_b128 v[56:59], v229 offset:0
    ds_read_b128 v[104:107], v232 offset:0
    v_mov_b32 v19, s63
    ds_write_b64 v16, v[18:19]
    v_lshlrev_b32 v16, 2, v0
    v_add_u32 v16, 163584, v16
    ds_write_b32 v16, v14
    s_waitcnt lgkmcnt(0)
    s_waitcnt vmcnt(0) lgkmcnt(5)
    v_mfma_f32_32x32x16_bf16 v[116:131], v[20:23], v[32:35], v[116:131]
    s_barrier
    ds_read_b128 v[72:75], v226 offset:0
    ds_read_b64_tr_b16 v[60:61], v220 offset:20480
    ds_read_b64_tr_b16 v[62:63], v220 offset:20992
    v_mfma_f32_32x32x16_bf16 v[132:147], v[20:23], v[36:39], v[132:147]
    ds_read_b128 v[76:79], v230 offset:0
    ds_read_b64_tr_b16 v[108:109], v222 offset:20480
    ds_read_b64_tr_b16 v[110:111], v222 offset:20736
    s_waitcnt lgkmcnt(6)
    v_mfma_f32_32x32x16_bf16 v[116:131], v[40:43], v[52:55], v[116:131]
    ds_read_b128 v[92:95], v227 offset:0
    v_mfma_f32_32x32x16_bf16 v[132:147], v[40:43], v[56:59], v[132:147]
    ds_read_b64_tr_b16 v[80:81], v220 offset:22528
    ds_read_b64_tr_b16 v[82:83], v220 offset:23040
    s_cmp_eq_u32 s25, 1
    s_cbranch_scc1 L_kvv_31
    v_mfma_f32_16x16x32_bf16 v[148:151], v[100:103], v[104:107], v[148:151]
    s_branch L_kvd_31
L_kvv_31:
    v_mfma_f32_16x16x32_bf16 v[148:151], v[104:107], v[100:103], v[148:151]
L_kvd_31:
    ds_read_b128 v[96:99], v231 offset:0
    ds_read_b128 v[112:115], v233 offset:0
    s_waitcnt lgkmcnt(5)
    v_mfma_f32_32x32x16_bf16 v[116:131], v[60:63], v[72:75], v[116:131]
    v_mfma_f32_32x32x16_bf16 v[132:147], v[60:63], v[76:79], v[132:147]
    s_waitcnt lgkmcnt(0)
    v_mfma_f32_32x32x16_bf16 v[116:131], v[80:83], v[92:95], v[116:131]
    v_mfma_f32_32x32x16_bf16 v[132:147], v[80:83], v[96:99], v[132:147]
    s_cmp_eq_u32 s25, 1
    s_cbranch_scc1 L_kvv_32
    v_mfma_f32_16x16x32_bf16 v[148:151], v[108:111], v[112:115], v[148:151]
    s_branch L_kvd_32
L_kvv_32:
    v_mfma_f32_16x16x32_bf16 v[148:151], v[112:115], v[108:111], v[148:151]
L_kvd_32:
    v_and_b32 v20, 31, v0
    v_lshlrev_b32 v20, 3, v20
    s_lshl_b32 s13, s18, 8
    s_lshl_b32 s14, s19, 8
    v_add_u32 v21, s13, v20
    v_add_u32 v22, s14, v20
    v_mov_b32 v23, 155136
    v_add_u32 v21, 154112, v21
    v_add_u32 v22, 154112, v22
    ds_read_b64 v[32:33], v21
    ds_read_b64 v[34:35], v22
    ds_read_b64 v[36:37], v23
    v_lshrrev_b32 v21, 5, v0
    v_lshlrev_b32 v21, 4, v21
    v_add_u32 v21, 151552, v21
    s_lshl_b32 s15, s4, 2
    s_add_u32 s16, s15, s19
    s_add_u32 s15, s15, s18
    s_waitcnt lgkmcnt(0)
    v_readfirstlane_b32 s62, v36
    v_readfirstlane_b32 s63, v37
    v_mov_b32 v24, v33
    v_mul_f32 v26, v32, v33
    v_sub_f32 v26, 0, v26
    v_mov_b32 v28, v35
    v_mul_f32 v30, v34, v35
    v_sub_f32 v30, 0, v30
    s_cmp_eq_u32 s12, 0
    s_cbranch_scc1 L_ae_nokv2_11
    v_lshrrev_b32 v22, 4, v0
    v_and_b32 v23, 15, v0
    s_lshr_b32 s21, s5, 1
    s_lshl_b32 s13, s7, 6
    s_add_u32 s13, s13, 153856
    s_lshl_b32 s14, s21, 8
    s_lshl_b32 s20, s8, 7
    s_add_u32 s14, s14, s20
    s_add_u32 s14, s14, 154112
    s_lshl_b32 s20, s4, 2
    s_add_u32 s21, s21, s20
    v_and_b32 v20, 1, v22
    v_lshlrev_b32 v20, 9, v20
    v_lshl_add_u32 v20, v23, 4, v20
    v_lshrrev_b32 v34, 1, v22
    v_lshl_add_u32 v20, v34, 3, v20
    s_cmp_eq_u32 s25, 1
    s_cbranch_scc1 L_ae_isv_12
    v_lshlrev_b32 v38, 4, v22
    v_add_u32 v38, s13, v38
    ds_read_b128 v[32:35], v38
    v_lshlrev_b32 v38, 3, v23
    v_add_u32 v38, s14, v38
    ds_read_b64 v[36:37], v38
    s_lshl_b32 s13, s21, 12
    s_add_u32 s13, s13, 16777216
    s_lshl_b32 s20, s7, 10
    s_add_u32 s13, s13, s20
    s_lshl_b32 s20, s8, 8
    s_add_u32 s13, s13, s20
    s_waitcnt lgkmcnt(0)
    v_fma_f32 v148, -v36, v32, v148
    v_mul_f32 v148, v37, v148
    v_fma_f32 v149, -v36, v33, v149
    v_mul_f32 v149, v37, v149
    v_fma_f32 v150, -v36, v34, v150
    v_mul_f32 v150, v37, v150
    v_fma_f32 v151, -v36, v35, v151
    v_mul_f32 v151, v37, v151
    v_cvt_pk_bf16_f32 v32, v148, v149
    v_cvt_pk_bf16_f32 v33, v150, v151
    buffer_store_dwordx2 v[32:33], v20, s[64:67], s13 offen sc1
    v_lshlrev_b32 v34, 16, v32
    v_and_b32 v35, 0xffff0000, v32
    v_mul_f32 v40, v34, v34
    v_fmac_f32 v40, v35, v35
    v_lshlrev_b32 v34, 16, v33
    v_and_b32 v35, 0xffff0000, v33
    v_fmac_f32 v40, v34, v34
    v_fmac_f32 v40, v35, v35
    s_nop 1
    v_mov_b32 v41, v40
    s_nop 1
    v_permlane16_swap_b32 v40, v41
    s_nop 1
    v_add_f32 v40, v40, v41
    v_mov_b32 v41, v40
    s_nop 1
    v_permlane32_swap_b32 v40, v41
    s_nop 1
    v_add_f32 v40, v40, v41
    s_nop 1
    v_max_f32_dpp v40, v40, v40 row_shr:1 row_mask:0xf bank_mask:0xf bound_ctrl:0
    s_nop 1
    v_max_f32_dpp v40, v40, v40 row_shr:2 row_mask:0xf bank_mask:0xf bound_ctrl:0
    s_nop 1
    v_max_f32_dpp v40, v40, v40 row_shr:4 row_mask:0xf bank_mask:0xf bound_ctrl:0
    s_nop 1
    v_max_f32_dpp v40, v40, v40 row_shr:8 row_mask:0xf bank_mask:0xf bound_ctrl:0
    s_nop 1
    v_max_f32_dpp v40, v40, v40 row_bcast:15 row_mask:0xa bank_mask:0xf
    s_nop 1
    v_max_f32_dpp v40, v40, v40 row_bcast:31 row_mask:0xc bank_mask:0xf
    s_nop 1
    v_readlane_b32 s20, v40, 63
    s_nop 3
    s_lshl_b32 s13, s21, 2
    s_add_u32 s13, s13, s6
    s_lshl_b32 s13, s13, 2
    s_add_u32 s13, s13, 17301504
    v_mov_b32 v40, s20
    s_mov_b64 exec, 1
    buffer_store_dword v40, v14, s[64:67], s13 offen sc1
    s_mov_b64 exec, -1
    s_branch L_ae_nokv2_11
L_ae_isv_12:
    v_lshlrev_b32 v38, 2, v23
    v_add_u32 v38, s13, v38
    ds_read_b32 v40, v38
    v_lshlrev_b32 v38, 5, v22
    v_add_u32 v38, s14, v38
    ds_read_b128 v[32:35], v38
    ds_read_b128 v[36:39], v38 offset:16
    s_lshl_b32 s13, s21, 12
    s_add_u32 s13, s13, 16779264
    s_lshl_b32 s20, s8, 10
    s_add_u32 s13, s13, s20
    s_lshl_b32 s20, s7, 8
    s_add_u32 s13, s13, s20
    s_waitcnt lgkmcnt(0)
    v_fma_f32 v148, -v32, v40, v148
    v_mul_f32 v148, v33, v148
    v_fma_f32 v149, -v34, v40, v149
    v_mul_f32 v149, v35, v149
    v_fma_f32 v150, -v36, v40, v150
    v_mul_f32 v150, v37, v150
    v_fma_f32 v151, -v38, v40, v151
    v_mul_f32 v151, v39, v151
    v_cvt_pk_bf16_f32 v32, v148, v149
    v_cvt_pk_bf16_f32 v33, v150, v151
    buffer_store_dwordx2 v[32:33], v20, s[64:67], s13 offen sc1
L_ae_nokv2_11:
    s_barrier
    s_mov_b32 s13, 0x3e8293ee
    v_mul_f32 v40, s13, v24
    v_mul_f32 v42, s13, v26
    v_mul_f32 v44, s13, v28
    v_mul_f32 v46, s13, v30
    s_lshl_b32 s21, s8, 8
    v_add_u32 v22, s21, v21
    ds_read_b128 v[48:51], v22 offset:0
    ds_read_b128 v[52:55], v22 offset:32
    ds_read_b128 v[56:59], v22 offset:64
    ds_read_b128 v[60:63], v22 offset:96
    s_waitcnt lgkmcnt(0)
    v_mul_f32 v32, v48, v42
    v_fma_f32 v116, v116, v40, v32
    v_mul_f32 v32, v49, v42
    v_fma_f32 v117, v117, v40, v32
    v_cvt_pk_bf16_f32 v116, v116, v117
    v_mul_f32 v32, v50, v42
    v_fma_f32 v118, v118, v40, v32
    v_mul_f32 v32, v51, v42
    v_fma_f32 v119, v119, v40, v32
    v_cvt_pk_bf16_f32 v117, v118, v119
    v_mul_f32 v32, v52, v42
    v_fma_f32 v120, v120, v40, v32
    v_mul_f32 v32, v53, v42
    v_fma_f32 v121, v121, v40, v32
    v_cvt_pk_bf16_f32 v118, v120, v121
    v_mul_f32 v32, v54, v42
    v_fma_f32 v122, v122, v40, v32
    v_mul_f32 v32, v55, v42
    v_fma_f32 v123, v123, v40, v32
    v_cvt_pk_bf16_f32 v119, v122, v123
    v_mul_f32 v32, v56, v42
    v_fma_f32 v124, v124, v40, v32
    v_mul_f32 v32, v57, v42
    v_fma_f32 v125, v125, v40, v32
    v_cvt_pk_bf16_f32 v120, v124, v125
    v_mul_f32 v32, v58, v42
    v_fma_f32 v126, v126, v40, v32
    v_mul_f32 v32, v59, v42
    v_fma_f32 v127, v127, v40, v32
    v_cvt_pk_bf16_f32 v121, v126, v127
    v_mul_f32 v32, v60, v42
    v_fma_f32 v128, v128, v40, v32
    v_mul_f32 v32, v61, v42
    v_fma_f32 v129, v129, v40, v32
    v_cvt_pk_bf16_f32 v122, v128, v129
    v_mul_f32 v32, v62, v42
    v_fma_f32 v130, v130, v40, v32
    v_mul_f32 v32, v63, v42
    v_fma_f32 v131, v131, v40, v32
    v_cvt_pk_bf16_f32 v123, v130, v131
    v_mul_f32 v32, v48, v46
    v_fma_f32 v132, v132, v44, v32
    v_mul_f32 v32, v49, v46
    v_fma_f32 v133, v133, v44, v32
    v_cvt_pk_bf16_f32 v132, v132, v133
    v_mul_f32 v32, v50, v46
    v_fma_f32 v134, v134, v44, v32
    v_mul_f32 v32, v51, v46
    v_fma_f32 v135, v135, v44, v32
    v_cvt_pk_bf16_f32 v133, v134, v135
    v_mul_f32 v32, v52, v46
    v_fma_f32 v136, v136, v44, v32
    v_mul_f32 v32, v53, v46
    v_fma_f32 v137, v137, v44, v32
    v_cvt_pk_bf16_f32 v134, v136, v137
    v_mul_f32 v32, v54, v46
    v_fma_f32 v138, v138, v44, v32
    v_mul_f32 v32, v55, v46
    v_fma_f32 v139, v139, v44, v32
    v_cvt_pk_bf16_f32 v135, v138, v139
    v_mul_f32 v32, v56, v46
    v_fma_f32 v140, v140, v44, v32
    v_mul_f32 v32, v57, v46
    v_fma_f32 v141, v141, v44, v32
    v_cvt_pk_bf16_f32 v136, v140, v141
    v_mul_f32 v32, v58, v46
    v_fma_f32 v142, v142, v44, v32
    v_mul_f32 v32, v59, v46
    v_fma_f32 v143, v143, v44, v32
    v_cvt_pk_bf16_f32 v137, v142, v143
    v_mul_f32 v32, v60, v46
    v_fma_f32 v144, v144, v44, v32
    v_mul_f32 v32, v61, v46
    v_fma_f32 v145, v145, v44, v32
    v_cvt_pk_bf16_f32 v138, v144, v145
    v_mul_f32 v32, v62, v46
    v_fma_f32 v146, v146, v44, v32
    v_mul_f32 v32, v63, v46
    v_fma_f32 v147, v147, v44, v32
    v_cvt_pk_bf16_f32 v139, v146, v147
    s_waitcnt vmcnt(0)
    v_mov_b32 v32, 163820
    v_mov_b32 v33, 1
    s_mov_b64 exec, 1
    ds_add_rtn_u32 v34, v32, v33
    s_mov_b64 exec, -1
    s_waitcnt lgkmcnt(0)
    v_readfirstlane_b32 s13, v34
    s_cmp_lg_u32 s13, 3
    s_cbranch_scc1 L_nopost_13
    s_cmp_eq_u32 s12, 0
    s_cbranch_scc1 L_nokvf_14
    s_lshl_b32 s13, s4, 3
    s_add_u32 s13, s13, s5
    s_lshl_b32 s13, s13, 2
    s_add_u32 s13, s13, 17838080
    v_mov_b32 v32, s62
    s_mov_b64 exec, 1
    buffer_store_dword v32, v14, s[64:67], s13 offen sc1
    s_mov_b64 exec, -1
    s_waitcnt vmcnt(0)
L_nokvf_14:
    v_mov_b32 v32, 163820
    s_mov_b64 exec, 1
    ds_add_u32 v32, v33
    s_mov_b64 exec, -1
L_nopost_13:
    v_mov_b32 v172, 0
    v_lshlrev_b32 v16, 16, v116
    v_and_b32 v17, 0xffff0000, v116
    v_fmac_f32 v172, v16, v16
    v_fmac_f32 v172, v17, v17
    v_lshlrev_b32 v16, 16, v117
    v_and_b32 v17, 0xffff0000, v117
    v_fmac_f32 v172, v16, v16
    v_fmac_f32 v172, v17, v17
    v_lshlrev_b32 v16, 16, v118
    v_and_b32 v17, 0xffff0000, v118
    v_fmac_f32 v172, v16, v16
    v_fmac_f32 v172, v17, v17
    v_lshlrev_b32 v16, 16, v119
    v_and_b32 v17, 0xffff0000, v119
    v_fmac_f32 v172, v16, v16
    v_fmac_f32 v172, v17, v17
    v_lshlrev_b32 v16, 16, v120
    v_and_b32 v17, 0xffff0000, v120
    v_fmac_f32 v172, v16, v16
    v_fmac_f32 v172, v17, v17
    v_lshlrev_b32 v16, 16, v121
    v_and_b32 v17, 0xffff0000, v121
    v_fmac_f32 v172, v16, v16
    v_fmac_f32 v172, v17, v17
    v_lshlrev_b32 v16, 16, v122
    v_and_b32 v17, 0xffff0000, v122
    v_fmac_f32 v172, v16, v16
    v_fmac_f32 v172, v17, v17
    v_lshlrev_b32 v16, 16, v123
    v_and_b32 v17, 0xffff0000, v123
    v_fmac_f32 v172, v16, v16
    v_fmac_f32 v172, v17, v17
    v_mov_b32 v16, v172
    s_nop 1
    v_permlane32_swap_b32 v172, v16
    s_nop 1
    v_add_f32 v172, v172, v16
    v_mov_b32 v176, 0
    v_lshlrev_b32 v16, 16, v132
    v_and_b32 v17, 0xffff0000, v132
    v_fmac_f32 v176, v16, v16
    v_fmac_f32 v176, v17, v17
    v_lshlrev_b32 v16, 16, v133
    v_and_b32 v17, 0xffff0000, v133
    v_fmac_f32 v176, v16, v16
    v_fmac_f32 v176, v17, v17
    v_lshlrev_b32 v16, 16, v134
    v_and_b32 v17, 0xffff0000, v134
    v_fmac_f32 v176, v16, v16
    v_fmac_f32 v176, v17, v17
    v_lshlrev_b32 v16, 16, v135
    v_and_b32 v17, 0xffff0000, v135
    v_fmac_f32 v176, v16, v16
    v_fmac_f32 v176, v17, v17
    v_lshlrev_b32 v16, 16, v136
    v_and_b32 v17, 0xffff0000, v136
    v_fmac_f32 v176, v16, v16
    v_fmac_f32 v176, v17, v17
    v_lshlrev_b32 v16, 16, v137
    v_and_b32 v17, 0xffff0000, v137
    v_fmac_f32 v176, v16, v16
    v_fmac_f32 v176, v17, v17
    v_lshlrev_b32 v16, 16, v138
    v_and_b32 v17, 0xffff0000, v138
    v_fmac_f32 v176, v16, v16
    v_fmac_f32 v176, v17, v17
    v_lshlrev_b32 v16, 16, v139
    v_and_b32 v17, 0xffff0000, v139
    v_fmac_f32 v176, v16, v16
    v_fmac_f32 v176, v17, v17
    v_mov_b32 v16, v176
    s_nop 1
    v_permlane32_swap_b32 v176, v16
    s_nop 1
    v_add_f32 v176, v176, v16
    v_max_f32 v186, v172, v176
    v_add_u32 v184, 0x18800, v5
    v_bfe_u32 v16, v0, 4, 1
    v_bfe_u32 v17, v0, 2, 1
    v_cmp_eq_u32 vcc, v16, v17
    v_mov_b32 v16, 0x3f803f80
    s_nop 0
    v_cndmask_b32 v180, 0, v16, vcc
    v_mov_b32 v181, v180
    v_mov_b32 v182, v180
    v_mov_b32 v183, v180
    v_mov_b32 v84, 0
    v_mov_b32 v85, 0
    v_mov_b32 v86, 0
    v_mov_b32 v87, 0
    v_mov_b32 v88, 0
    v_mov_b32 v89, 0
    v_mov_b32 v90, 0
    v_mov_b32 v91, 0
    v_mov_b32 v92, 0
    v_mov_b32 v93, 0
    v_mov_b32 v94, 0
    v_mov_b32 v95, 0
    v_mov_b32 v96, 0
    v_mov_b32 v97, 0
    v_mov_b32 v98, 0
    v_mov_b32 v99, 0
    v_mov_b32 v100, 0
    v_mov_b32 v101, 0
    v_mov_b32 v102, 0
    v_mov_b32 v103, 0
    v_mov_b32 v104, 0
    v_mov_b32 v105, 0
    v_mov_b32 v106, 0
    v_mov_b32 v107, 0
    v_mov_b32 v108, 0
    v_mov_b32 v109, 0
    v_mov_b32 v110, 0
    v_mov_b32 v111, 0
    v_mov_b32 v112, 0
    v_mov_b32 v113, 0
    v_mov_b32 v114, 0
    v_mov_b32 v115, 0
    v_mov_b32 v68, 0
    v_mov_b32 v69, 0
    v_mov_b32 v70, 0
    v_mov_b32 v71, 0
    v_mov_b32 v72, 0
    v_mov_b32 v73, 0
    v_mov_b32 v74, 0
    v_mov_b32 v75, 0
    v_mov_b32 v76, 0
    v_mov_b32 v77, 0
    v_mov_b32 v78, 0
    v_mov_b32 v79, 0
    v_mov_b32 v80, 0
    v_mov_b32 v81, 0
    v_mov_b32 v82, 0
    v_mov_b32 v83, 0
    v_mov_b32 v172, 0
    v_mov_b32 v173, 0
    v_mov_b32 v174, 0
    v_mov_b32 v175, 0
    v_mov_b32 v176, 0
    v_mov_b32 v177, 0
    v_mov_b32 v178, 0
    v_mov_b32 v179, 0
    v_mov_b32 v164, 0
    v_mov_b32 v165, 0
    v_mov_b32 v166, 0
    v_mov_b32 v167, 0
    v_mov_b32 v168, 0
    v_mov_b32 v169, 0
    v_mov_b32 v170, 0
    v_mov_b32 v171, 0
    v_mov_b32 v15, 163832
    v_mov_b32 v4, 1
    s_mov_b32 s10, 0
    s_lshl_b32 s24, s8, 12
    s_cmp_eq_u32 s7, 0
    s_mov_b32 s13, 2048
    s_cmov_b32 s13, 4096
    s_add_u32 s24, s24, s13
    s_add_u32 s24, s24, 16777216
    s_lshl_b32 s11, s6, 11
    s_add_u32 s11, s11, 100352
    s_cmp_lg_u32 s6, 0
    s_cbranch_scc1 L_sp_o_15
    v_lshlrev_b32 v16, 3, v0
    s_mov_b32 s22, 17838080
    s_mov_b32 s17, 1048576
L_kvp_17:
    buffer_load_dwordx2 v[36:37], v16, s[64:67], s22 offen sc1
    s_waitcnt vmcnt(0)
    v_cmp_ne_u32 vcc, s62, v36
    v_cmp_ne_u32 s[26:27], s62, v37
    s_or_b64 vcc, vcc, s[26:27]
    s_sub_u32 s17, s17, 1
    s_cbranch_scc1 L_kvpd_18
    s_cmp_eq_u64 vcc, 0
    s_cbranch_scc1 L_kvpd_18
    s_sleep 1
    s_branch L_kvp_17
L_kvpd_18:
    v_mov_b32 v16, 163816
    v_mov_b32 v36, 1
    s_mov_b64 exec, 1
    ds_add_u32 v16, v36
    s_mov_b64 exec, -1
    s_branch L_sp_d_16
L_sp_o_15:
    v_mov_b32 v36, 163816
L_ow_19:
    ds_read_b32 v37, v36
    s_waitcnt lgkmcnt(0)
    v_readfirstlane_b32 s13, v37
    s_cmp_ge_u32 s13, 1
    s_cbranch_scc1 L_owok_20
    s_sleep 1
    s_branch L_ow_19
L_owok_20:
    s_waitcnt vmcnt(0)
L_sp_d_16:
    s_mov_b32 s13, 17301504
    buffer_load_dwordx4 v[36:39], v5, s[64:67], s13 offen sc1
    s_mov_b32 s13, 16777216
    buffer_load_dwordx4 v[156:159], v5, s[64:67], s13 offen sc1
    buffer_load_dwordx4 v[160:163], v5, s[64:67], s13 offen offset:1024 sc1
    s_add_u32 m0, s11, 0
    s_nop 0
    buffer_load_dwordx4 v5, s[64:67], s24 offen offset:0 sc1 lds
    s_add_u32 m0, s11, 0
    s_nop 0
    buffer_load_dwordx4 v5, s[64:67], s24 offen offset:1024 sc1 lds
    s_add_u32 s24, s24, 8192
    s_add_u32 m0, s11, 8192
    s_nop 0
    buffer_load_dwordx4 v5, s[64:67], s24 offen offset:0 sc1 lds
    s_add_u32 m0, s11, 8192
    s_nop 0
    buffer_load_dwordx4 v5, s[64:67], s24 offen offset:1024 sc1 lds
    s_add_u32 s24, s24, 8192
    s_add_u32 m0, s11, 16384
    s_nop 0
    buffer_load_dwordx4 v5, s[64:67], s24 offen offset:0 sc1 lds
    s_add_u32 m0, s11, 16384
    s_nop 0
    buffer_load_dwordx4 v5, s[64:67], s24 offen offset:1024 sc1 lds
    s_add_u32 s24, s24, 8192
    s_waitcnt vmcnt(8)
    v_max_f32 v36, v36, v38
    v_max_f32 v37, v37, v39
    s_nop 1
    v_max_f32_dpp v36, v36, v36 row_shr:1 row_mask:0xf bank_mask:0xf bound_ctrl:0
    s_nop 1
    v_max_f32_dpp v36, v36, v36 row_shr:2 row_mask:0xf bank_mask:0xf bound_ctrl:0
    s_nop 1
    v_max_f32_dpp v36, v36, v36 row_shr:4 row_mask:0xf bank_mask:0xf bound_ctrl:0
    s_nop 1
    v_max_f32_dpp v36, v36, v36 row_shr:8 row_mask:0xf bank_mask:0xf bound_ctrl:0
    s_nop 1
    v_max_f32_dpp v36, v36, v36 row_bcast:15 row_mask:0xa bank_mask:0xf
    s_nop 1
    v_max_f32_dpp v36, v36, v36 row_bcast:31 row_mask:0xc bank_mask:0xf
    s_nop 1
    v_readlane_b32 s13, v36, 63
    s_nop 3
    s_nop 1
    v_max_f32_dpp v37, v37, v37 row_shr:1 row_mask:0xf bank_mask:0xf bound_ctrl:0
    s_nop 1
    v_max_f32_dpp v37, v37, v37 row_shr:2 row_mask:0xf bank_mask:0xf bound_ctrl:0
    s_nop 1
    v_max_f32_dpp v37, v37, v37 row_shr:4 row_mask:0xf bank_mask:0xf bound_ctrl:0
    s_nop 1
    v_max_f32_dpp v37, v37, v37 row_shr:8 row_mask:0xf bank_mask:0xf bound_ctrl:0
    s_nop 1
    v_max_f32_dpp v37, v37, v37 row_bcast:15 row_mask:0xa bank_mask:0xf
    s_nop 1
    v_max_f32_dpp v37, v37, v37 row_bcast:31 row_mask:0xc bank_mask:0xf
    s_nop 1
    v_readlane_b32 s14, v37, 63
    s_nop 3
    v_mov_b32 v16, s13
    v_add_f32 v16, s14, v16
    v_mul_f32 v16, v16, v186
    v_sqrt_f32 v16, v16
    s_nop 0
    v_mul_f32 v20, 0xbf8020c5, v16
    v_mov_b32 v21, v20
    v_mov_b32 v22, v20
    v_mov_b32 v23, v20
    v_mov_b32 v24, v20
    v_mov_b32 v25, v20
    v_mov_b32 v26, v20
    v_mov_b32 v27, v20
    v_mov_b32 v28, v20
    v_mov_b32 v29, v20
    v_mov_b32 v30, v20
    v_mov_b32 v31, v20
    v_mov_b32 v32, v20
    v_mov_b32 v33, v20
    v_mov_b32 v34, v20
    v_mov_b32 v35, v20
    s_waitcnt vmcnt(4)
    v_mfma_f32_32x32x16_bf16 v[36:51], v[156:159], v[116:119], v[20:35]
    v_mfma_f32_32x32x16_bf16 v[36:51], v[160:163], v[120:123], v[36:51]
    s_mov_b64 exec, 1
    ds_add_u32 v15, v4
    s_mov_b64 exec, -1
    s_add_u32 s10, s10, 4
    ds_read_b32 v3, v15
    s_waitcnt lgkmcnt(0)
L_sw_21:
    v_readfirstlane_b32 s13, v3
    s_cmp_ge_u32 s13, s10
    s_cbranch_scc1 L_swok_22
    ds_read_b32 v3, v15
    s_waitcnt lgkmcnt(0)
    s_branch L_sw_21
L_swok_22:
    s_nop 7
    s_mov_b32 s9, 0
    s_setprio 1
.p2align 6
L_ba_loop_23:
    v_mfma_f32_32x32x16_bf16 v[52:67], v[156:159], v[132:135], v[20:35]
    v_exp_f32 v36, v36
    v_exp_f32 v37, v37
    v_exp_f32 v38, v38
    v_mfma_f32_32x32x16_bf16 v[100:115], v[164:167], v[76:79], v[100:115]
    s_add_u32 m0, s11, 24576
    s_nop 0
    buffer_load_dwordx4 v5, s[64:67], s24 offen offset:0 sc1 lds
    v_exp_f32 v39, v39
    v_exp_f32 v40, v40
    v_exp_f32 v41, v41
    v_mfma_f32_32x32x16_bf16 v[52:67], v[160:163], v[136:139], v[52:67]
    v_exp_f32 v42, v42
    v_exp_f32 v43, v43
    v_exp_f32 v44, v44
    v_mfma_f32_32x32x16_bf16 v[100:115], v[168:171], v[80:83], v[100:115]
    s_add_u32 m0, s11, 24576
    s_nop 0
    buffer_load_dwordx4 v5, s[64:67], s24 offen offset:1024 sc1 lds
    s_add_u32 s24, s24, 8192
    v_exp_f32 v45, v45
    v_exp_f32 v46, v46
    v_exp_f32 v47, v47
    v_mfma_f32_16x16x32_bf16 v[176:179], v[180:183], v[76:79], v[176:179]
    v_exp_f32 v48, v48
    v_mfma_f32_16x16x32_bf16 v[176:179], v[180:183], v[80:83], v[176:179]
    ds_read_b128 v[140:143], v184 offset:0
    ds_read_b128 v[144:147], v184 offset:1024
    ds_read_b128 v[148:151], v184 offset:2048
    ds_read_b128 v[152:155], v184 offset:3072
    v_exp_f32 v49, v49
    v_exp_f32 v50, v50
    v_exp_f32 v51, v51
    v_cvt_pk_bf16_f32 v68, v36, v37
    v_cvt_pk_bf16_f32 v69, v38, v39
    v_cvt_pk_bf16_f32 v70, v40, v41
    v_cvt_pk_bf16_f32 v71, v42, v43
    v_cvt_pk_bf16_f32 v72, v44, v45
    v_cvt_pk_bf16_f32 v73, v46, v47
    v_cvt_pk_bf16_f32 v74, v48, v49
    v_cvt_pk_bf16_f32 v75, v50, v51
    s_waitcnt lgkmcnt(0)
    v_mfma_f32_32x32x16_bf16 v[36:51], v[140:143], v[116:119], v[20:35]
    v_exp_f32 v52, v52
    v_exp_f32 v53, v53
    v_exp_f32 v54, v54
    v_mfma_f32_32x32x16_bf16 v[84:99], v[148:151], v[68:71], v[84:99]
    v_exp_f32 v55, v55
    v_exp_f32 v56, v56
    v_exp_f32 v57, v57
    v_mfma_f32_32x32x16_bf16 v[36:51], v[144:147], v[120:123], v[36:51]
    v_exp_f32 v58, v58
    v_exp_f32 v59, v59
    v_exp_f32 v60, v60
    v_mfma_f32_32x32x16_bf16 v[84:99], v[152:155], v[72:75], v[84:99]
    v_exp_f32 v61, v61
    v_exp_f32 v62, v62
    v_exp_f32 v63, v63
    v_mfma_f32_16x16x32_bf16 v[172:175], v[180:183], v[68:71], v[172:175]
    v_exp_f32 v64, v64
    v_mfma_f32_16x16x32_bf16 v[172:175], v[180:183], v[72:75], v[172:175]
    v_exp_f32 v65, v65
    v_exp_f32 v66, v66
    v_exp_f32 v67, v67
    v_cvt_pk_bf16_f32 v76, v52, v53
    v_cvt_pk_bf16_f32 v77, v54, v55
    v_cvt_pk_bf16_f32 v78, v56, v57
    v_cvt_pk_bf16_f32 v79, v58, v59
    v_cvt_pk_bf16_f32 v80, v60, v61
    v_cvt_pk_bf16_f32 v81, v62, v63
    v_cvt_pk_bf16_f32 v82, v64, v65
    v_cvt_pk_bf16_f32 v83, v66, v67
    v_mfma_f32_32x32x16_bf16 v[52:67], v[140:143], v[132:135], v[20:35]
    v_exp_f32 v36, v36
    v_exp_f32 v37, v37
    v_exp_f32 v38, v38
    v_mfma_f32_32x32x16_bf16 v[100:115], v[148:151], v[76:79], v[100:115]
    v_exp_f32 v39, v39
    v_exp_f32 v40, v40
    v_exp_f32 v41, v41
    v_mfma_f32_32x32x16_bf16 v[52:67], v[144:147], v[136:139], v[52:67]
    v_exp_f32 v42, v42
    v_exp_f32 v43, v43
    v_exp_f32 v44, v44
    v_mfma_f32_32x32x16_bf16 v[100:115], v[152:155], v[80:83], v[100:115]
    v_exp_f32 v45, v45
    v_exp_f32 v46, v46
    v_exp_f32 v47, v47
    v_mfma_f32_16x16x32_bf16 v[176:179], v[180:183], v[76:79], v[176:179]
    v_exp_f32 v48, v48
    v_mfma_f32_16x16x32_bf16 v[176:179], v[180:183], v[80:83], v[176:179]
    ds_read_b128 v[156:159], v184 offset:4096
    ds_read_b128 v[160:163], v184 offset:5120
    ds_read_b128 v[164:167], v184 offset:6144
    ds_read_b128 v[168:171], v184 offset:7168
    v_exp_f32 v49, v49
    v_exp_f32 v50, v50
    v_exp_f32 v51, v51
    v_cvt_pk_bf16_f32 v68, v36, v37
    v_cvt_pk_bf16_f32 v69, v38, v39
    v_cvt_pk_bf16_f32 v70, v40, v41
    v_cvt_pk_bf16_f32 v71, v42, v43
    v_cvt_pk_bf16_f32 v72, v44, v45
    v_cvt_pk_bf16_f32 v73, v46, v47
    v_cvt_pk_bf16_f32 v74, v48, v49
    v_cvt_pk_bf16_f32 v75, v50, v51
    s_waitcnt vmcnt(4) lgkmcnt(0)
    v_mfma_f32_32x32x16_bf16 v[36:51], v[156:159], v[116:119], v[20:35]
    s_mov_b64 exec, 1
    ds_add_u32 v15, v4
    s_mov_b64 exec, -1
    s_add_u32 s10, s10, 4
    v_exp_f32 v52, v52
    v_exp_f32 v53, v53
    v_exp_f32 v54, v54
    v_mfma_f32_32x32x16_bf16 v[84:99], v[164:167], v[68:71], v[84:99]
    v_exp_f32 v55, v55
    v_exp_f32 v56, v56
    v_exp_f32 v57, v57
    v_mfma_f32_32x32x16_bf16 v[36:51], v[160:163], v[120:123], v[36:51]
    v_exp_f32 v58, v58
    v_exp_f32 v59, v59
    v_exp_f32 v60, v60
    v_mfma_f32_32x32x16_bf16 v[84:99], v[168:171], v[72:75], v[84:99]
    v_exp_f32 v61, v61
    v_exp_f32 v62, v62
    v_exp_f32 v63, v63
    v_mfma_f32_16x16x32_bf16 v[172:175], v[180:183], v[68:71], v[172:175]
    v_exp_f32 v64, v64
    v_mfma_f32_16x16x32_bf16 v[172:175], v[180:183], v[72:75], v[172:175]
    ds_read_b32 v3, v15
    v_exp_f32 v65, v65
    v_exp_f32 v66, v66
    v_exp_f32 v67, v67
    v_cvt_pk_bf16_f32 v76, v52, v53
    v_cvt_pk_bf16_f32 v77, v54, v55
    v_cvt_pk_bf16_f32 v78, v56, v57
    v_cvt_pk_bf16_f32 v79, v58, v59
    v_cvt_pk_bf16_f32 v80, v60, v61
    v_cvt_pk_bf16_f32 v81, v62, v63
    v_cvt_pk_bf16_f32 v82, v64, v65
    v_cvt_pk_bf16_f32 v83, v66, v67
    s_waitcnt lgkmcnt(0)
L_sw_24:
    v_readfirstlane_b32 s13, v3
    s_cmp_ge_u32 s13, s10
    s_cbranch_scc1 L_swok_25
    ds_read_b32 v3, v15
    s_waitcnt lgkmcnt(0)
    s_branch L_sw_24
L_swok_25:
    v_mfma_f32_32x32x16_bf16 v[52:67], v[156:159], v[132:135], v[20:35]
    v_exp_f32 v36, v36
    v_exp_f32 v37, v37
    v_exp_f32 v38, v38
    v_mfma_f32_32x32x16_bf16 v[100:115], v[164:167], v[76:79], v[100:115]
    s_add_u32 m0, s11, 0
    s_nop 0
    buffer_load_dwordx4 v5, s[64:67], s24 offen offset:0 sc1 lds
    v_exp_f32 v39, v39
    v_exp_f32 v40, v40
    v_exp_f32 v41, v41
    v_mfma_f32_32x32x16_bf16 v[52:67], v[160:163], v[136:139], v[52:67]
    v_exp_f32 v42, v42
    v_exp_f32 v43, v43
    v_exp_f32 v44, v44
    v_mfma_f32_32x32x16_bf16 v[100:115], v[168:171], v[80:83], v[100:115]
    s_add_u32 m0, s11, 0
    s_nop 0
    buffer_load_dwordx4 v5, s[64:67], s24 offen offset:1024 sc1 lds
    s_add_u32 s24, s24, 8192
    v_exp_f32 v45, v45
    v_exp_f32 v46, v46
    v_exp_f32 v47, v47
    v_mfma_f32_16x16x32_bf16 v[176:179], v[180:183], v[76:79], v[176:179]
    v_exp_f32 v48, v48
    v_mfma_f32_16x16x32_bf16 v[176:179], v[180:183], v[80:83], v[176:179]
    ds_read_b128 v[140:143], v184 offset:8192
    ds_read_b128 v[144:147], v184 offset:9216
    ds_read_b128 v[148:151], v184 offset:10240
    ds_read_b128 v[152:155], v184 offset:11264
    v_exp_f32 v49, v49
    v_exp_f32 v50, v50
    v_exp_f32 v51, v51
    v_cvt_pk_bf16_f32 v68, v36, v37
    v_cvt_pk_bf16_f32 v69, v38, v39
    v_cvt_pk_bf16_f32 v70, v40, v41
    v_cvt_pk_bf16_f32 v71, v42, v43
    v_cvt_pk_bf16_f32 v72, v44, v45
    v_cvt_pk_bf16_f32 v73, v46, v47
    v_cvt_pk_bf16_f32 v74, v48, v49
    v_cvt_pk_bf16_f32 v75, v50, v51
    s_waitcnt lgkmcnt(0)
    v_mfma_f32_32x32x16_bf16 v[36:51], v[140:143], v[116:119], v[20:35]
    v_exp_f32 v52, v52
    v_exp_f32 v53, v53
    v_exp_f32 v54, v54
    v_mfma_f32_32x32x16_bf16 v[84:99], v[148:151], v[68:71], v[84:99]
    v_exp_f32 v55, v55
    v_exp_f32 v56, v56
    v_exp_f32 v57, v57
    v_mfma_f32_32x32x16_bf16 v[36:51], v[144:147], v[120:123], v[36:51]
    v_exp_f32 v58, v58
    v_exp_f32 v59, v59
    v_exp_f32 v60, v60
    v_mfma_f32_32x32x16_bf16 v[84:99], v[152:155], v[72:75], v[84:99]
    v_exp_f32 v61, v61
    v_exp_f32 v62, v62
    v_exp_f32 v63, v63
    v_mfma_f32_16x16x32_bf16 v[172:175], v[180:183], v[68:71], v[172:175]
    v_exp_f32 v64, v64
    v_mfma_f32_16x16x32_bf16 v[172:175], v[180:183], v[72:75], v[172:175]
    v_exp_f32 v65, v65
    v_exp_f32 v66, v66
    v_exp_f32 v67, v67
    v_cvt_pk_bf16_f32 v76, v52, v53
    v_cvt_pk_bf16_f32 v77, v54, v55
    v_cvt_pk_bf16_f32 v78, v56, v57
    v_cvt_pk_bf16_f32 v79, v58, v59
    v_cvt_pk_bf16_f32 v80, v60, v61
    v_cvt_pk_bf16_f32 v81, v62, v63
    v_cvt_pk_bf16_f32 v82, v64, v65
    v_cvt_pk_bf16_f32 v83, v66, v67
    v_mfma_f32_32x32x16_bf16 v[52:67], v[140:143], v[132:135], v[20:35]
    v_exp_f32 v36, v36
    v_exp_f32 v37, v37
    v_exp_f32 v38, v38
    v_mfma_f32_32x32x16_bf16 v[100:115], v[148:151], v[76:79], v[100:115]
    v_exp_f32 v39, v39
    v_exp_f32 v40, v40
    v_exp_f32 v41, v41
    v_mfma_f32_32x32x16_bf16 v[52:67], v[144:147], v[136:139], v[52:67]
    v_exp_f32 v42, v42
    v_exp_f32 v43, v43
    v_exp_f32 v44, v44
    v_mfma_f32_32x32x16_bf16 v[100:115], v[152:155], v[80:83], v[100:115]
    v_exp_f32 v45, v45
    v_exp_f32 v46, v46
    v_exp_f32 v47, v47
    v_mfma_f32_16x16x32_bf16 v[176:179], v[180:183], v[76:79], v[176:179]
    v_exp_f32 v48, v48
    v_mfma_f32_16x16x32_bf16 v[176:179], v[180:183], v[80:83], v[176:179]
    ds_read_b128 v[156:159], v184 offset:12288
    ds_read_b128 v[160:163], v184 offset:13312
    ds_read_b128 v[164:167], v184 offset:14336
    ds_read_b128 v[168:171], v184 offset:15360
    v_exp_f32 v49, v49
    v_exp_f32 v50, v50
    v_exp_f32 v51, v51
    v_cvt_pk_bf16_f32 v68, v36, v37
    v_cvt_pk_bf16_f32 v69, v38, v39
    v_cvt_pk_bf16_f32 v70, v40, v41
    v_cvt_pk_bf16_f32 v71, v42, v43
    v_cvt_pk_bf16_f32 v72, v44, v45
    v_cvt_pk_bf16_f32 v73, v46, v47
    v_cvt_pk_bf16_f32 v74, v48, v49
    v_cvt_pk_bf16_f32 v75, v50, v51
    s_waitcnt vmcnt(4) lgkmcnt(0)
    v_mfma_f32_32x32x16_bf16 v[36:51], v[156:159], v[116:119], v[20:35]
    s_mov_b64 exec, 1
    ds_add_u32 v15, v4
    s_mov_b64 exec, -1
    s_add_u32 s10, s10, 4
    v_exp_f32 v52, v52
    v_exp_f32 v53, v53
    v_exp_f32 v54, v54
    v_mfma_f32_32x32x16_bf16 v[84:99], v[164:167], v[68:71], v[84:99]
    v_exp_f32 v55, v55
    v_exp_f32 v56, v56
    v_exp_f32 v57, v57
    v_mfma_f32_32x32x16_bf16 v[36:51], v[160:163], v[120:123], v[36:51]
    v_exp_f32 v58, v58
    v_exp_f32 v59, v59
    v_exp_f32 v60, v60
    v_mfma_f32_32x32x16_bf16 v[84:99], v[168:171], v[72:75], v[84:99]
    v_exp_f32 v61, v61
    v_exp_f32 v62, v62
    v_exp_f32 v63, v63
    v_mfma_f32_16x16x32_bf16 v[172:175], v[180:183], v[68:71], v[172:175]
    v_exp_f32 v64, v64
    v_mfma_f32_16x16x32_bf16 v[172:175], v[180:183], v[72:75], v[172:175]
    ds_read_b32 v3, v15
    v_exp_f32 v65, v65
    v_exp_f32 v66, v66
    v_exp_f32 v67, v67
    v_cvt_pk_bf16_f32 v76, v52, v53
    v_cvt_pk_bf16_f32 v77, v54, v55
    v_cvt_pk_bf16_f32 v78, v56, v57
    v_cvt_pk_bf16_f32 v79, v58, v59
    v_cvt_pk_bf16_f32 v80, v60, v61
    v_cvt_pk_bf16_f32 v81, v62, v63
    v_cvt_pk_bf16_f32 v82, v64, v65
    v_cvt_pk_bf16_f32 v83, v66, v67
    s_waitcnt lgkmcnt(0)
L_sw_26:
    v_readfirstlane_b32 s13, v3
    s_cmp_ge_u32 s13, s10
    s_cbranch_scc1 L_swok_27
    ds_read_b32 v3, v15
    s_waitcnt lgkmcnt(0)
    s_branch L_sw_26
L_swok_27:
    v_mfma_f32_32x32x16_bf16 v[52:67], v[156:159], v[132:135], v[20:35]
    v_exp_f32 v36, v36
    v_exp_f32 v37, v37
    v_exp_f32 v38, v38
    v_mfma_f32_32x32x16_bf16 v[100:115], v[164:167], v[76:79], v[100:115]
    s_add_u32 m0, s11, 8192
    s_nop 0
    buffer_load_dwordx4 v5, s[64:67], s24 offen offset:0 sc1 lds
    v_exp_f32 v39, v39
    v_exp_f32 v40, v40
    v_exp_f32 v41, v41
    v_mfma_f32_32x32x16_bf16 v[52:67], v[160:163], v[136:139], v[52:67]
    v_exp_f32 v42, v42
    v_exp_f32 v43, v43
    v_exp_f32 v44, v44
    v_mfma_f32_32x32x16_bf16 v[100:115], v[168:171], v[80:83], v[100:115]
    s_add_u32 m0, s11, 8192
    s_nop 0
    buffer_load_dwordx4 v5, s[64:67], s24 offen offset:1024 sc1 lds
    s_add_u32 s24, s24, 8192
    v_exp_f32 v45, v45
    v_exp_f32 v46, v46
    v_exp_f32 v47, v47
    v_mfma_f32_16x16x32_bf16 v[176:179], v[180:183], v[76:79], v[176:179]
    v_exp_f32 v48, v48
    v_mfma_f32_16x16x32_bf16 v[176:179], v[180:183], v[80:83], v[176:179]
    ds_read_b128 v[140:143], v184 offset:16384
    ds_read_b128 v[144:147], v184 offset:17408
    ds_read_b128 v[148:151], v184 offset:18432
    ds_read_b128 v[152:155], v184 offset:19456
    v_exp_f32 v49, v49
    v_exp_f32 v50, v50
    v_exp_f32 v51, v51
    v_cvt_pk_bf16_f32 v68, v36, v37
    v_cvt_pk_bf16_f32 v69, v38, v39
    v_cvt_pk_bf16_f32 v70, v40, v41
    v_cvt_pk_bf16_f32 v71, v42, v43
    v_cvt_pk_bf16_f32 v72, v44, v45
    v_cvt_pk_bf16_f32 v73, v46, v47
    v_cvt_pk_bf16_f32 v74, v48, v49
    v_cvt_pk_bf16_f32 v75, v50, v51
    s_waitcnt lgkmcnt(0)
    v_mfma_f32_32x32x16_bf16 v[36:51], v[140:143], v[116:119], v[20:35]
    v_exp_f32 v52, v52
    v_exp_f32 v53, v53
    v_exp_f32 v54, v54
    v_mfma_f32_32x32x16_bf16 v[84:99], v[148:151], v[68:71], v[84:99]
    v_exp_f32 v55, v55
    v_exp_f32 v56, v56
    v_exp_f32 v57, v57
    v_mfma_f32_32x32x16_bf16 v[36:51], v[144:147], v[120:123], v[36:51]
    v_exp_f32 v58, v58
    v_exp_f32 v59, v59
    v_exp_f32 v60, v60
    v_mfma_f32_32x32x16_bf16 v[84:99], v[152:155], v[72:75], v[84:99]
    v_exp_f32 v61, v61
    v_exp_f32 v62, v62
    v_exp_f32 v63, v63
    v_mfma_f32_16x16x32_bf16 v[172:175], v[180:183], v[68:71], v[172:175]
    v_exp_f32 v64, v64
    v_mfma_f32_16x16x32_bf16 v[172:175], v[180:183], v[72:75], v[172:175]
    v_exp_f32 v65, v65
    v_exp_f32 v66, v66
    v_exp_f32 v67, v67
    v_cvt_pk_bf16_f32 v76, v52, v53
    v_cvt_pk_bf16_f32 v77, v54, v55
    v_cvt_pk_bf16_f32 v78, v56, v57
    v_cvt_pk_bf16_f32 v79, v58, v59
    v_cvt_pk_bf16_f32 v80, v60, v61
    v_cvt_pk_bf16_f32 v81, v62, v63
    v_cvt_pk_bf16_f32 v82, v64, v65
    v_cvt_pk_bf16_f32 v83, v66, v67
    v_mfma_f32_32x32x16_bf16 v[52:67], v[140:143], v[132:135], v[20:35]
    v_exp_f32 v36, v36
    v_exp_f32 v37, v37
    v_exp_f32 v38, v38
    v_mfma_f32_32x32x16_bf16 v[100:115], v[148:151], v[76:79], v[100:115]
    v_exp_f32 v39, v39
    v_exp_f32 v40, v40
    v_exp_f32 v41, v41
    v_mfma_f32_32x32x16_bf16 v[52:67], v[144:147], v[136:139], v[52:67]
    v_exp_f32 v42, v42
    v_exp_f32 v43, v43
    v_exp_f32 v44, v44
    v_mfma_f32_32x32x16_bf16 v[100:115], v[152:155], v[80:83], v[100:115]
    v_exp_f32 v45, v45
    v_exp_f32 v46, v46
    v_exp_f32 v47, v47
    v_mfma_f32_16x16x32_bf16 v[176:179], v[180:183], v[76:79], v[176:179]
    v_exp_f32 v48, v48
    v_mfma_f32_16x16x32_bf16 v[176:179], v[180:183], v[80:83], v[176:179]
    ds_read_b128 v[156:159], v184 offset:20480
    ds_read_b128 v[160:163], v184 offset:21504
    ds_read_b128 v[164:167], v184 offset:22528
    ds_read_b128 v[168:171], v184 offset:23552
    v_exp_f32 v49, v49
    v_exp_f32 v50, v50
    v_exp_f32 v51, v51
    v_cvt_pk_bf16_f32 v68, v36, v37
    v_cvt_pk_bf16_f32 v69, v38, v39
    v_cvt_pk_bf16_f32 v70, v40, v41
    v_cvt_pk_bf16_f32 v71, v42, v43
    v_cvt_pk_bf16_f32 v72, v44, v45
    v_cvt_pk_bf16_f32 v73, v46, v47
    v_cvt_pk_bf16_f32 v74, v48, v49
    v_cvt_pk_bf16_f32 v75, v50, v51
    s_waitcnt vmcnt(4) lgkmcnt(0)
    v_mfma_f32_32x32x16_bf16 v[36:51], v[156:159], v[116:119], v[20:35]
    s_mov_b64 exec, 1
    ds_add_u32 v15, v4
    s_mov_b64 exec, -1
    s_add_u32 s10, s10, 4
    v_exp_f32 v52, v52
    v_exp_f32 v53, v53
    v_exp_f32 v54, v54
    v_mfma_f32_32x32x16_bf16 v[84:99], v[164:167], v[68:71], v[84:99]
    v_exp_f32 v55, v55
    v_exp_f32 v56, v56
    v_exp_f32 v57, v57
    v_mfma_f32_32x32x16_bf16 v[36:51], v[160:163], v[120:123], v[36:51]
    v_exp_f32 v58, v58
    v_exp_f32 v59, v59
    v_exp_f32 v60, v60
    v_mfma_f32_32x32x16_bf16 v[84:99], v[168:171], v[72:75], v[84:99]
    v_exp_f32 v61, v61
    v_exp_f32 v62, v62
    v_exp_f32 v63, v63
    v_mfma_f32_16x16x32_bf16 v[172:175], v[180:183], v[68:71], v[172:175]
    v_exp_f32 v64, v64
    v_mfma_f32_16x16x32_bf16 v[172:175], v[180:183], v[72:75], v[172:175]
    ds_read_b32 v3, v15
    v_exp_f32 v65, v65
    v_exp_f32 v66, v66
    v_exp_f32 v67, v67
    v_cvt_pk_bf16_f32 v76, v52, v53
    v_cvt_pk_bf16_f32 v77, v54, v55
    v_cvt_pk_bf16_f32 v78, v56, v57
    v_cvt_pk_bf16_f32 v79, v58, v59
    v_cvt_pk_bf16_f32 v80, v60, v61
    v_cvt_pk_bf16_f32 v81, v62, v63
    v_cvt_pk_bf16_f32 v82, v64, v65
    v_cvt_pk_bf16_f32 v83, v66, v67
    s_waitcnt lgkmcnt(0)
L_sw_28:
    v_readfirstlane_b32 s13, v3
    s_cmp_ge_u32 s13, s10
    s_cbranch_scc1 L_swok_29
    ds_read_b32 v3, v15
    s_waitcnt lgkmcnt(0)
    s_branch L_sw_28
L_swok_29:
    v_mfma_f32_32x32x16_bf16 v[52:67], v[156:159], v[132:135], v[20:35]
    v_exp_f32 v36, v36
    v_exp_f32 v37, v37
    v_exp_f32 v38, v38
    v_mfma_f32_32x32x16_bf16 v[100:115], v[164:167], v[76:79], v[100:115]
    s_add_u32 m0, s11, 16384
    s_nop 0
    buffer_load_dwordx4 v5, s[64:67], s24 offen offset:0 sc1 lds
    v_exp_f32 v39, v39
    v_exp_f32 v40, v40
    v_exp_f32 v41, v41
    v_mfma_f32_32x32x16_bf16 v[52:67], v[160:163], v[136:139], v[52:67]
    v_exp_f32 v42, v42
    v_exp_f32 v43, v43
    v_exp_f32 v44, v44
    v_mfma_f32_32x32x16_bf16 v[100:115], v[168:171], v[80:83], v[100:115]
    s_add_u32 m0, s11, 16384
    s_nop 0
    buffer_load_dwordx4 v5, s[64:67], s24 offen offset:1024 sc1 lds
    s_add_u32 s24, s24, 8192
    v_exp_f32 v45, v45
    v_exp_f32 v46, v46
    v_exp_f32 v47, v47
    v_mfma_f32_16x16x32_bf16 v[176:179], v[180:183], v[76:79], v[176:179]
    v_exp_f32 v48, v48
    v_mfma_f32_16x16x32_bf16 v[176:179], v[180:183], v[80:83], v[176:179]
    ds_read_b128 v[140:143], v184 offset:24576
    ds_read_b128 v[144:147], v184 offset:25600
    ds_read_b128 v[148:151], v184 offset:26624
    ds_read_b128 v[152:155], v184 offset:27648
    v_exp_f32 v49, v49
    v_exp_f32 v50, v50
    v_exp_f32 v51, v51
    v_cvt_pk_bf16_f32 v68, v36, v37
    v_cvt_pk_bf16_f32 v69, v38, v39
    v_cvt_pk_bf16_f32 v70, v40, v41
    v_cvt_pk_bf16_f32 v71, v42, v43
    v_cvt_pk_bf16_f32 v72, v44, v45
    v_cvt_pk_bf16_f32 v73, v46, v47
    v_cvt_pk_bf16_f32 v74, v48, v49
    v_cvt_pk_bf16_f32 v75, v50, v51
    s_waitcnt lgkmcnt(0)
    v_mfma_f32_32x32x16_bf16 v[36:51], v[140:143], v[116:119], v[20:35]
    v_exp_f32 v52, v52
    v_exp_f32 v53, v53
    v_exp_f32 v54, v54
    v_mfma_f32_32x32x16_bf16 v[84:99], v[148:151], v[68:71], v[84:99]
    v_exp_f32 v55, v55
    v_exp_f32 v56, v56
    v_exp_f32 v57, v57
    v_mfma_f32_32x32x16_bf16 v[36:51], v[144:147], v[120:123], v[36:51]
    v_exp_f32 v58, v58
    v_exp_f32 v59, v59
    v_exp_f32 v60, v60
    v_mfma_f32_32x32x16_bf16 v[84:99], v[152:155], v[72:75], v[84:99]
    v_exp_f32 v61, v61
    v_exp_f32 v62, v62
    v_exp_f32 v63, v63
    v_mfma_f32_16x16x32_bf16 v[172:175], v[180:183], v[68:71], v[172:175]
    v_exp_f32 v64, v64
    v_mfma_f32_16x16x32_bf16 v[172:175], v[180:183], v[72:75], v[172:175]
    v_exp_f32 v65, v65
    v_exp_f32 v66, v66
    v_exp_f32 v67, v67
    v_cvt_pk_bf16_f32 v76, v52, v53
    v_cvt_pk_bf16_f32 v77, v54, v55
    v_cvt_pk_bf16_f32 v78, v56, v57
    v_cvt_pk_bf16_f32 v79, v58, v59
    v_cvt_pk_bf16_f32 v80, v60, v61
    v_cvt_pk_bf16_f32 v81, v62, v63
    v_cvt_pk_bf16_f32 v82, v64, v65
    v_cvt_pk_bf16_f32 v83, v66, v67
    v_mfma_f32_32x32x16_bf16 v[52:67], v[140:143], v[132:135], v[20:35]
    v_exp_f32 v36, v36
    v_exp_f32 v37, v37
    v_exp_f32 v38, v38
    v_mfma_f32_32x32x16_bf16 v[100:115], v[148:151], v[76:79], v[100:115]
    v_exp_f32 v39, v39
    v_exp_f32 v40, v40
    v_exp_f32 v41, v41
    v_mfma_f32_32x32x16_bf16 v[52:67], v[144:147], v[136:139], v[52:67]
    v_exp_f32 v42, v42
    v_exp_f32 v43, v43
    v_exp_f32 v44, v44
    v_mfma_f32_32x32x16_bf16 v[100:115], v[152:155], v[80:83], v[100:115]
    v_exp_f32 v45, v45
    v_exp_f32 v46, v46
    v_exp_f32 v47, v47
    v_mfma_f32_16x16x32_bf16 v[176:179], v[180:183], v[76:79], v[176:179]
    v_exp_f32 v48, v48
    v_mfma_f32_16x16x32_bf16 v[176:179], v[180:183], v[80:83], v[176:179]
    ds_read_b128 v[156:159], v184 offset:28672
    ds_read_b128 v[160:163], v184 offset:29696
    ds_read_b128 v[164:167], v184 offset:30720
    ds_read_b128 v[168:171], v184 offset:31744
    v_exp_f32 v49, v49
    v_exp_f32 v50, v50
    v_exp_f32 v51, v51
    v_cvt_pk_bf16_f32 v68, v36, v37
    v_cvt_pk_bf16_f32 v69, v38, v39
    v_cvt_pk_bf16_f32 v70, v40, v41
    v_cvt_pk_bf16_f32 v71, v42, v43
    v_cvt_pk_bf16_f32 v72, v44, v45
    v_cvt_pk_bf16_f32 v73, v46, v47
    v_cvt_pk_bf16_f32 v74, v48, v49
    v_cvt_pk_bf16_f32 v75, v50, v51
    s_waitcnt vmcnt(4) lgkmcnt(0)
    v_mfma_f32_32x32x16_bf16 v[36:51], v[156:159], v[116:119], v[20:35]
    s_mov_b64 exec, 1
    ds_add_u32 v15, v4
    s_mov_b64 exec, -1
    s_add_u32 s10, s10, 4
    v_exp_f32 v52, v52
    v_exp_f32 v53, v53
    v_exp_f32 v54, v54
    v_mfma_f32_32x32x16_bf16 v[84:99], v[164:167], v[68:71], v[84:99]
    v_exp_f32 v55, v55
    v_exp_f32 v56, v56
    v_exp_f32 v57, v57
    v_mfma_f32_32x32x16_bf16 v[36:51], v[160:163], v[120:123], v[36:51]
    v_exp_f32 v58, v58
    v_exp_f32 v59, v59
    v_exp_f32 v60, v60
    v_mfma_f32_32x32x16_bf16 v[84:99], v[168:171], v[72:75], v[84:99]
    v_exp_f32 v61, v61
    v_exp_f32 v62, v62
    v_exp_f32 v63, v63
    v_mfma_f32_16x16x32_bf16 v[172:175], v[180:183], v[68:71], v[172:175]
    v_exp_f32 v64, v64
    v_mfma_f32_16x16x32_bf16 v[172:175], v[180:183], v[72:75], v[172:175]
    ds_read_b32 v3, v15
    v_exp_f32 v65, v65
    v_exp_f32 v66, v66
    v_exp_f32 v67, v67
    v_cvt_pk_bf16_f32 v76, v52, v53
    v_cvt_pk_bf16_f32 v77, v54, v55
    v_cvt_pk_bf16_f32 v78, v56, v57
    v_cvt_pk_bf16_f32 v79, v58, v59
    v_cvt_pk_bf16_f32 v80, v60, v61
    v_cvt_pk_bf16_f32 v81, v62, v63
    v_cvt_pk_bf16_f32 v82, v64, v65
    v_cvt_pk_bf16_f32 v83, v66, v67
    s_waitcnt lgkmcnt(0)
L_sw_30:
    v_readfirstlane_b32 s13, v3
    s_cmp_ge_u32 s13, s10
    s_cbranch_scc1 L_swok_31
    ds_read_b32 v3, v15
    s_waitcnt lgkmcnt(0)
    s_branch L_sw_30
L_swok_31:
    s_add_u32 s9, s9, 1
    s_cmp_lt_u32 s9, 8
    s_cbranch_scc1 L_ba_loop_23
    s_nop 1
    v_mfma_f32_32x32x16_bf16 v[100:115], v[164:167], v[76:79], v[100:115]
    v_mfma_f32_32x32x16_bf16 v[100:115], v[168:171], v[80:83], v[100:115]
    v_mfma_f32_16x16x32_bf16 v[176:179], v[180:183], v[76:79], v[176:179]
    v_mfma_f32_16x16x32_bf16 v[176:179], v[180:183], v[80:83], v[176:179]
    s_nop 15
    s_nop 3
    v_min_f32 v16, v172, v176
    v_mov_b32 v17, 0x21800000
    v_cmp_nge_f32 vcc, v16, v17
    v_cmp_u_f32 s[26:27], v172, v176
    s_or_b64 vcc, vcc, s[26:27]
    s_cmp_eq_u64 vcc, 0
    s_cbranch_scc1 L_sm_ok_32
    v_mov_b32 v20, 0xff800000
    s_mov_b32 s13, 16777216
    s_mov_b32 s9, 0
L_fb1_33:
    buffer_load_dwordx4 v[140:143], v5, s[64:67], s13 offen sc1
    buffer_load_dwordx4 v[144:147], v5, s[64:67], s13 offen offset:1024 sc1
    s_waitcnt vmcnt(0)
    v_mfma_f32_32x32x16_bf16 v[36:51], v[140:143], v[116:119], 0
    v_mfma_f32_32x32x16_bf16 v[36:51], v[144:147], v[120:123], v[36:51]
    s_nop 15
    s_nop 3
    v_max3_f32 v20, v20, v36, v37
    v_max3_f32 v20, v20, v38, v39
    v_max3_f32 v20, v20, v40, v41
    v_max3_f32 v20, v20, v42, v43
    v_max3_f32 v20, v20, v44, v45
    v_max3_f32 v20, v20, v46, v47
    v_max3_f32 v20, v20, v48, v49
    v_max3_f32 v20, v20, v50, v51
    s_add_u32 s13, s13, 4096
    s_add_u32 s9, s9, 1
    s_cmp_lt_u32 s9, 64
    s_cbranch_scc1 L_fb1_33
    v_mov_b32 v21, v20
    s_nop 1
    v_permlane32_swap_b32 v20, v21
    s_nop 1
    v_max_f32 v20, v20, v21
    v_sub_f32 v20, 0, v20
    v_mov_b32 v21, v20
    v_mov_b32 v22, v20
    v_mov_b32 v23, v20
    v_mov_b32 v24, v20
    v_mov_b32 v25, v20
    v_mov_b32 v26, v20
    v_mov_b32 v27, v20
    v_mov_b32 v28, v20
    v_mov_b32 v29, v20
    v_mov_b32 v30, v20
    v_mov_b32 v31, v20
    v_mov_b32 v32, v20
    v_mov_b32 v33, v20
    v_mov_b32 v34, v20
    v_mov_b32 v35, v20
    v_mov_b32 v84, 0
    v_mov_b32 v85, 0
    v_mov_b32 v86, 0
    v_mov_b32 v87, 0
    v_mov_b32 v88, 0
    v_mov_b32 v89, 0
    v_mov_b32 v90, 0
    v_mov_b32 v91, 0
    v_mov_b32 v92, 0
    v_mov_b32 v93, 0
    v_mov_b32 v94, 0
    v_mov_b32 v95, 0
    v_mov_b32 v96, 0
    v_mov_b32 v97, 0
    v_mov_b32 v98, 0
    v_mov_b32 v99, 0
    v_mov_b32 v172, 0
    s_mov_b32 s13, 16777216
    s_mov_b32 s9, 0
L_fb2_34:
    buffer_load_dwordx4 v[140:143], v5, s[64:67], s13 offen offset:0 sc1
    buffer_load_dwordx4 v[144:147], v5, s[64:67], s13 offen offset:1024 sc1
    buffer_load_dwordx4 v[148:151], v5, s[64:67], s13 offen offset:2048 sc1
    buffer_load_dwordx4 v[152:155], v5, s[64:67], s13 offen offset:3072 sc1
    s_waitcnt vmcnt(0)
    v_mfma_f32_32x32x16_bf16 v[36:51], v[140:143], v[116:119], v[20:35]
    v_mfma_f32_32x32x16_bf16 v[36:51], v[144:147], v[120:123], v[36:51]
    s_nop 15
    s_nop 3
    v_exp_f32 v36, v36
    v_exp_f32 v37, v37
    v_exp_f32 v38, v38
    v_exp_f32 v39, v39
    v_exp_f32 v40, v40
    v_exp_f32 v41, v41
    v_exp_f32 v42, v42
    v_exp_f32 v43, v43
    v_exp_f32 v44, v44
    v_exp_f32 v45, v45
    v_exp_f32 v46, v46
    v_exp_f32 v47, v47
    v_exp_f32 v48, v48
    v_exp_f32 v49, v49
    v_exp_f32 v50, v50
    v_exp_f32 v51, v51
    s_nop 0
    v_add_f32 v172, v172, v36
    v_add_f32 v172, v172, v37
    v_add_f32 v172, v172, v38
    v_add_f32 v172, v172, v39
    v_add_f32 v172, v172, v40
    v_add_f32 v172, v172, v41
    v_add_f32 v172, v172, v42
    v_add_f32 v172, v172, v43
    v_add_f32 v172, v172, v44
    v_add_f32 v172, v172, v45
    v_add_f32 v172, v172, v46
    v_add_f32 v172, v172, v47
    v_add_f32 v172, v172, v48
    v_add_f32 v172, v172, v49
    v_add_f32 v172, v172, v50
    v_add_f32 v172, v172, v51
    v_cvt_pk_bf16_f32 v68, v36, v37
    v_cvt_pk_bf16_f32 v69, v38, v39
    v_cvt_pk_bf16_f32 v70, v40, v41
    v_cvt_pk_bf16_f32 v71, v42, v43
    v_cvt_pk_bf16_f32 v72, v44, v45
    v_cvt_pk_bf16_f32 v73, v46, v47
    v_cvt_pk_bf16_f32 v74, v48, v49
    v_cvt_pk_bf16_f32 v75, v50, v51
    s_nop 1
    v_mfma_f32_32x32x16_bf16 v[84:99], v[148:151], v[68:71], v[84:99]
    v_mfma_f32_32x32x16_bf16 v[84:99], v[152:155], v[72:75], v[84:99]
    s_nop 15
    s_nop 3
    s_add_u32 s13, s13, 4096
    s_add_u32 s9, s9, 1
    s_cmp_lt_u32 s9, 64
    s_cbranch_scc1 L_fb2_34
    v_mov_b32 v173, v172
    s_nop 1
    v_permlane32_swap_b32 v172, v173
    s_nop 1
    v_add_f32 v172, v172, v173
    v_mov_b32 v20, 0xff800000
    s_mov_b32 s13, 16777216
    s_mov_b32 s9, 0
L_fb1_35:
    buffer_load_dwordx4 v[140:143], v5, s[64:67], s13 offen sc1
    buffer_load_dwordx4 v[144:147], v5, s[64:67], s13 offen offset:1024 sc1
    s_waitcnt vmcnt(0)
    v_mfma_f32_32x32x16_bf16 v[36:51], v[140:143], v[132:135], 0
    v_mfma_f32_32x32x16_bf16 v[36:51], v[144:147], v[136:139], v[36:51]
    s_nop 15
    s_nop 3
    v_max3_f32 v20, v20, v36, v37
    v_max3_f32 v20, v20, v38, v39
    v_max3_f32 v20, v20, v40, v41
    v_max3_f32 v20, v20, v42, v43
    v_max3_f32 v20, v20, v44, v45
    v_max3_f32 v20, v20, v46, v47
    v_max3_f32 v20, v20, v48, v49
    v_max3_f32 v20, v20, v50, v51
    s_add_u32 s13, s13, 4096
    s_add_u32 s9, s9, 1
    s_cmp_lt_u32 s9, 64
    s_cbranch_scc1 L_fb1_35
    v_mov_b32 v21, v20
    s_nop 1
    v_permlane32_swap_b32 v20, v21
    s_nop 1
    v_max_f32 v20, v20, v21
    v_sub_f32 v20, 0, v20
    v_mov_b32 v21, v20
    v_mov_b32 v22, v20
    v_mov_b32 v23, v20
    v_mov_b32 v24, v20
    v_mov_b32 v25, v20
    v_mov_b32 v26, v20
    v_mov_b32 v27, v20
    v_mov_b32 v28, v20
    v_mov_b32 v29, v20
    v_mov_b32 v30, v20
    v_mov_b32 v31, v20
    v_mov_b32 v32, v20
    v_mov_b32 v33, v20
    v_mov_b32 v34, v20
    v_mov_b32 v35, v20
    v_mov_b32 v100, 0
    v_mov_b32 v101, 0
    v_mov_b32 v102, 0
    v_mov_b32 v103, 0
    v_mov_b32 v104, 0
    v_mov_b32 v105, 0
    v_mov_b32 v106, 0
    v_mov_b32 v107, 0
    v_mov_b32 v108, 0
    v_mov_b32 v109, 0
    v_mov_b32 v110, 0
    v_mov_b32 v111, 0
    v_mov_b32 v112, 0
    v_mov_b32 v113, 0
    v_mov_b32 v114, 0
    v_mov_b32 v115, 0
    v_mov_b32 v176, 0
    s_mov_b32 s13, 16777216
    s_mov_b32 s9, 0
L_fb2_36:
    buffer_load_dwordx4 v[140:143], v5, s[64:67], s13 offen offset:0 sc1
    buffer_load_dwordx4 v[144:147], v5, s[64:67], s13 offen offset:1024 sc1
    buffer_load_dwordx4 v[148:151], v5, s[64:67], s13 offen offset:2048 sc1
    buffer_load_dwordx4 v[152:155], v5, s[64:67], s13 offen offset:3072 sc1
    s_waitcnt vmcnt(0)
    v_mfma_f32_32x32x16_bf16 v[36:51], v[140:143], v[132:135], v[20:35]
    v_mfma_f32_32x32x16_bf16 v[36:51], v[144:147], v[136:139], v[36:51]
    s_nop 15
    s_nop 3
    v_exp_f32 v36, v36
    v_exp_f32 v37, v37
    v_exp_f32 v38, v38
    v_exp_f32 v39, v39
    v_exp_f32 v40, v40
    v_exp_f32 v41, v41
    v_exp_f32 v42, v42
    v_exp_f32 v43, v43
    v_exp_f32 v44, v44
    v_exp_f32 v45, v45
    v_exp_f32 v46, v46
    v_exp_f32 v47, v47
    v_exp_f32 v48, v48
    v_exp_f32 v49, v49
    v_exp_f32 v50, v50
    v_exp_f32 v51, v51
    s_nop 0
    v_add_f32 v176, v176, v36
    v_add_f32 v176, v176, v37
    v_add_f32 v176, v176, v38
    v_add_f32 v176, v176, v39
    v_add_f32 v176, v176, v40
    v_add_f32 v176, v176, v41
    v_add_f32 v176, v176, v42
    v_add_f32 v176, v176, v43
    v_add_f32 v176, v176, v44
    v_add_f32 v176, v176, v45
    v_add_f32 v176, v176, v46
    v_add_f32 v176, v176, v47
    v_add_f32 v176, v176, v48
    v_add_f32 v176, v176, v49
    v_add_f32 v176, v176, v50
    v_add_f32 v176, v176, v51
    v_cvt_pk_bf16_f32 v68, v36, v37
    v_cvt_pk_bf16_f32 v69, v38, v39
    v_cvt_pk_bf16_f32 v70, v40, v41
    v_cvt_pk_bf16_f32 v71, v42, v43
    v_cvt_pk_bf16_f32 v72, v44, v45
    v_cvt_pk_bf16_f32 v73, v46, v47
    v_cvt_pk_bf16_f32 v74, v48, v49
    v_cvt_pk_bf16_f32 v75, v50, v51
    s_nop 1
    v_mfma_f32_32x32x16_bf16 v[100:115], v[148:151], v[68:71], v[100:115]
    v_mfma_f32_32x32x16_bf16 v[100:115], v[152:155], v[72:75], v[100:115]
    s_nop 15
    s_nop 3
    s_add_u32 s13, s13, 4096
    s_add_u32 s9, s9, 1
    s_cmp_lt_u32 s9, 64
    s_cbranch_scc1 L_fb2_36
    v_mov_b32 v177, v176
    s_nop 1
    v_permlane32_swap_b32 v176, v177
    s_nop 1
    v_add_f32 v176, v176, v177
L_sm_ok_32:
    v_rcp_f32 v16, v172
    v_rcp_f32 v17, v176
    s_nop 0
    v_mul_f32 v84, v84, v16
    v_mul_f32 v85, v85, v16
    v_mul_f32 v86, v86, v16
    v_mul_f32 v87, v87, v16
    v_mul_f32 v88, v88, v16
    v_mul_f32 v89, v89, v16
    v_mul_f32 v90, v90, v16
    v_mul_f32 v91, v91, v16
    v_mul_f32 v92, v92, v16
    v_mul_f32 v93, v93, v16
    v_mul_f32 v94, v94, v16
    v_mul_f32 v95, v95, v16
    v_mul_f32 v96, v96, v16
    v_mul_f32 v97, v97, v16
    v_mul_f32 v98, v98, v16
    v_mul_f32 v99, v99, v16
    v_cvt_pk_bf16_f32 v84, v84, v85
    v_cvt_pk_bf16_f32 v85, v86, v87
    v_cvt_pk_bf16_f32 v86, v88, v89
    v_cvt_pk_bf16_f32 v87, v90, v91
    v_cvt_pk_bf16_f32 v88, v92, v93
    v_cvt_pk_bf16_f32 v89, v94, v95
    v_cvt_pk_bf16_f32 v90, v96, v97
    v_cvt_pk_bf16_f32 v91, v98, v99
    s_lshl_b32 s13, s4, 2
    s_add_u32 s13, s13, s18
    s_lshl_b32 s13, s13, 5
    s_lshl_b32 s14, s5, 1
    s_add_u32 s13, s13, s14
    s_add_u32 s13, s13, s8
    s_lshl_b32 s13, s13, 11
    s_add_u32 s13, s13, 18874368
    buffer_store_dwordx4 v[84:87], v5, s[64:67], s13 offen sc1
    buffer_store_dwordx4 v[88:91], v5, s[64:67], s13 offen offset:1024 sc1
    v_mul_f32 v100, v100, v17
    v_mul_f32 v101, v101, v17
    v_mul_f32 v102, v102, v17
    v_mul_f32 v103, v103, v17
    v_mul_f32 v104, v104, v17
    v_mul_f32 v105, v105, v17
    v_mul_f32 v106, v106, v17
    v_mul_f32 v107, v107, v17
    v_mul_f32 v108, v108, v17
    v_mul_f32 v109, v109, v17
    v_mul_f32 v110, v110, v17
    v_mul_f32 v111, v111, v17
    v_mul_f32 v112, v112, v17
    v_mul_f32 v113, v113, v17
    v_mul_f32 v114, v114, v17
    v_mul_f32 v115, v115, v17
    v_cvt_pk_bf16_f32 v100, v100, v101
    v_cvt_pk_bf16_f32 v101, v102, v103
    v_cvt_pk_bf16_f32 v102, v104, v105
    v_cvt_pk_bf16_f32 v103, v106, v107
    v_cvt_pk_bf16_f32 v104, v108, v109
    v_cvt_pk_bf16_f32 v105, v110, v111
    v_cvt_pk_bf16_f32 v106, v112, v113
    v_cvt_pk_bf16_f32 v107, v114, v115
    s_lshl_b32 s13, s4, 2
    s_add_u32 s13, s13, s19
    s_lshl_b32 s13, s13, 5
    s_lshl_b32 s14, s5, 1
    s_add_u32 s13, s13, s14
    s_add_u32 s13, s13, s8
    s_lshl_b32 s13, s13, 11
    s_add_u32 s13, s13, 18874368
    buffer_store_dwordx4 v[100:103], v5, s[64:67], s13 offen sc1
    buffer_store_dwordx4 v[104:107], v5, s[64:67], s13 offen offset:1024 sc1
    s_waitcnt vmcnt(0)
    v_mov_b32 v16, 163836
    v_mov_b32 v17, 1
    s_mov_b64 exec, 1
    ds_add_rtn_u32 v18, v16, v17
    s_mov_b64 exec, -1
    s_waitcnt lgkmcnt(0)
    v_readfirstlane_b32 s13, v18
    s_cmp_lg_u32 s13, 3
    s_cbranch_scc1 L_nopost_37
    s_lshl_b32 s13, s4, 4
    s_add_u32 s13, s13, s5
    s_lshl_b32 s13, s13, 3
    s_add_u32 s13, s13, 17833984
    v_mov_b32 v16, s62
    v_mov_b32 v17, s63
    s_mov_b64 exec, 1
    buffer_store_dwordx2 v[16:17], v14, s[64:67], s13 offen sc1
    s_mov_b64 exec, -1
L_nopost_37:
    s_mov_b64 exec, 1
    ds_add_u32 v15, v4
    s_mov_b64 exec, -1
    s_add_u32 s10, s10, 4
    ds_read_b32 v3, v15
    s_waitcnt lgkmcnt(0)
L_sw_38:
    v_readfirstlane_b32 s13, v3
    s_cmp_ge_u32 s13, s10
    s_cbranch_scc1 L_swok_39
    ds_read_b32 v3, v15
    s_waitcnt lgkmcnt(0)
    s_branch L_sw_38
L_swok_39:
    v_lshrrev_b32 v16, 3, v0
    v_and_b32 v17, 7, v0
    v_and_b32 v1, 2, v16
    v_xor_b32 v17, v17, v1
    v_lshlrev_b32 v17, 4, v17
    v_lshl_add_u32 v1, v16, 11, v17
    s_mov_b32 s72, s44
    s_and_b32 s73, s45, 0xffff
    s_mov_b32 s74, 0x200000
    s_mov_b32 s75, 0x00020000
    s_lshl_b32 s20, s6, 18
    s_lshl_b32 s14, s5, 7
    s_add_u32 s20, s20, s14
    s_add_u32 s20, s20, 0
    s_lshl_b32 s21, s6, 14
    s_add_u32 m0, s21, 65536
    s_nop 0
    buffer_load_dwordx4 v1, s[72:75], s20 offen lds
    s_add_u32 s20, s20, 16384
    s_add_u32 m0, s21, 66560
    s_nop 0
    buffer_load_dwordx4 v1, s[72:75], s20 offen lds
    s_add_u32 s20, s20, 16384
    s_add_u32 m0, s21, 67584
    s_nop 0
    buffer_load_dwordx4 v1, s[72:75], s20 offen lds
    s_add_u32 s20, s20, 16384
    s_add_u32 m0, s21, 68608
    s_nop 0
    buffer_load_dwordx4 v1, s[72:75], s20 offen lds
    s_add_u32 s20, s20, 16384
    s_add_u32 m0, s21, 69632
    s_nop 0
    buffer_load_dwordx4 v1, s[72:75], s20 offen lds
    s_add_u32 s20, s20, 16384
    s_add_u32 m0, s21, 70656
    s_nop 0
    buffer_load_dwordx4 v1, s[72:75], s20 offen lds
    s_add_u32 s20, s20, 16384
    s_add_u32 m0, s21, 71680
    s_nop 0
    buffer_load_dwordx4 v1, s[72:75], s20 offen lds
    s_add_u32 s20, s20, 16384
    s_add_u32 m0, s21, 72704
    s_nop 0
    buffer_load_dwordx4 v1, s[72:75], s20 offen lds
    s_add_u32 s20, s20, 16384
    s_add_u32 m0, s21, 73728
    s_nop 0
    buffer_load_dwordx4 v1, s[72:75], s20 offen lds
    s_add_u32 s20, s20, 16384
    s_add_u32 m0, s21, 74752
    s_nop 0
    buffer_load_dwordx4 v1, s[72:75], s20 offen lds
    s_add_u32 s20, s20, 16384
    s_add_u32 m0, s21, 75776
    s_nop 0
    buffer_load_dwordx4 v1, s[72:75], s20 offen lds
    s_add_u32 s20, s20, 16384
    s_add_u32 m0, s21, 76800
    s_nop 0
    buffer_load_dwordx4 v1, s[72:75], s20 offen lds
    s_add_u32 s20, s20, 16384
    s_add_u32 m0, s21, 77824
    s_nop 0
    buffer_load_dwordx4 v1, s[72:75], s20 offen lds
    s_add_u32 s20, s20, 16384
    s_add_u32 m0, s21, 78848
    s_nop 0
    buffer_load_dwordx4 v1, s[72:75], s20 offen lds
    s_add_u32 s20, s20, 16384
    s_add_u32 m0, s21, 79872
    s_nop 0
    buffer_load_dwordx4 v1, s[72:75], s20 offen lds
    s_add_u32 s20, s20, 16384
    s_add_u32 m0, s21, 80896
    s_nop 0
    buffer_load_dwordx4 v1, s[72:75], s20 offen lds
    s_add_u32 s20, s20, 16384
    v_lshrrev_b32 v16, 5, v0
    v_lshlrev_b32 v6, 9, v16
    v_bfe_u32 v16, v0, 2, 2
    v_lshl_add_u32 v6, v16, 7, v6
    v_lshrrev_b32 v16, 1, v16
    v_lshl_add_u32 v6, v16, 5, v6
    v_and_b32 v16, 1, v0
    v_lshl_add_u32 v6, v16, 6, v6
    v_bfe_u32 v16, v0, 4, 1
    v_lshl_add_u32 v6, v16, 4, v6
    v_bfe_u32 v16, v0, 1, 1
    v_lshl_add_u32 v6, v16, 3, v6
    v_xor_b32 v7, 32, v6
    v_add_u32 v6, 0x10000, v6
    v_add_u32 v7, 0x10000, v7
    v_mov_b32 v184, 0
    v_mov_b32 v185, 0
    v_mov_b32 v186, 0
    v_mov_b32 v187, 0
    v_mov_b32 v188, 0
    v_mov_b32 v189, 0
    v_mov_b32 v190, 0
    v_mov_b32 v191, 0
    v_mov_b32 v192, 0
    v_mov_b32 v193, 0
    v_mov_b32 v194, 0
    v_mov_b32 v195, 0
    v_mov_b32 v196, 0
    v_mov_b32 v197, 0
    v_mov_b32 v198, 0
    v_mov_b32 v199, 0
    v_mov_b32 v200, 0
    v_mov_b32 v201, 0
    v_mov_b32 v202, 0
    v_mov_b32 v203, 0
    v_mov_b32 v204, 0
    v_mov_b32 v205, 0
    v_mov_b32 v206, 0
    v_mov_b32 v207, 0
    v_mov_b32 v208, 0
    v_mov_b32 v209, 0
    v_mov_b32 v210, 0
    v_mov_b32 v211, 0
    v_mov_b32 v212, 0
    v_mov_b32 v213, 0
    v_mov_b32 v214, 0
    v_mov_b32 v215, 0
    s_cmp_lg_u32 s6, 0
    s_cbranch_scc1 L_sp_o_40
    v_and_b32 v16, 15, v0
    v_lshlrev_b32 v16, 3, v16
    s_lshl_b32 s22, s4, 7
    s_add_u32 s22, s22, 17833984
    s_mov_b32 s17, 1048576
L_poll_42:
    buffer_load_dwordx2 v[20:21], v16, s[64:67], s22 offen sc1
    s_waitcnt vmcnt(0)
L_pollc_44:
    v_cmp_ne_u64 vcc, s[62:63], v[20:21]
    s_sub_u32 s17, s17, 1
    s_cbranch_scc1 L_polld_43
    s_cmp_eq_u64 vcc, 0
    s_cbranch_scc1 L_polld_43
    s_sleep 1
    s_branch L_poll_42
L_polld_43:
    v_mov_b32 v16, 163808
    v_mov_b32 v20, 1
    s_mov_b64 exec, 1
    ds_add_u32 v16, v20
    s_mov_b64 exec, -1
    s_branch L_sp_d_41
L_sp_o_40:
    v_mov_b32 v20, 163808
L_ow_45:
    ds_read_b32 v21, v20
    s_waitcnt lgkmcnt(0)
    v_readfirstlane_b32 s13, v21
    s_cmp_ge_u32 s13, 1
    s_cbranch_scc1 L_owok_46
    s_sleep 1
    s_branch L_ow_45
L_owok_46:
    s_waitcnt vmcnt(0)
L_sp_d_41:
    s_mov_b64 exec, 1
    ds_add_u32 v15, v4
    s_mov_b64 exec, -1
    s_add_u32 s10, s10, 4
    s_lshl_b32 s25, s4, 2
    s_add_u32 s25, s25, s6
    s_lshl_b32 s25, s25, 16
    s_add_u32 s25, s25, 18874368
    buffer_load_dwordx4 v[52:55], v5, s[64:67], s25 offen sc1
    s_add_u32 s25, s25, 1024
    buffer_load_dwordx4 v[56:59], v5, s[64:67], s25 offen sc1
    s_add_u32 s25, s25, 1024
    buffer_load_dwordx4 v[60:63], v5, s[64:67], s25 offen sc1
    s_add_u32 s25, s25, 1024
    buffer_load_dwordx4 v[64:67], v5, s[64:67], s25 offen sc1
    s_add_u32 s25, s25, 1024
    buffer_load_dwordx4 v[68:71], v5, s[64:67], s25 offen sc1
    s_add_u32 s25, s25, 1024
    buffer_load_dwordx4 v[72:75], v5, s[64:67], s25 offen sc1
    s_add_u32 s25, s25, 1024
    buffer_load_dwordx4 v[76:79], v5, s[64:67], s25 offen sc1
    s_add_u32 s25, s25, 1024
    buffer_load_dwordx4 v[80:83], v5, s[64:67], s25 offen sc1
    s_add_u32 s25, s25, 1024
    buffer_load_dwordx4 v[84:87], v5, s[64:67], s25 offen sc1
    s_add_u32 s25, s25, 1024
    buffer_load_dwordx4 v[88:91], v5, s[64:67], s25 offen sc1
    s_add_u32 s25, s25, 1024
    buffer_load_dwordx4 v[92:95], v5, s[64:67], s25 offen sc1
    s_add_u32 s25, s25, 1024
    buffer_load_dwordx4 v[96:99], v5, s[64:67], s25 offen sc1
    s_add_u32 s25, s25, 1024
    buffer_load_dwordx4 v[100:103], v5, s[64:67], s25 offen sc1
    s_add_u32 s25, s25, 1024
    buffer_load_dwordx4 v[104:107], v5, s[64:67], s25 offen sc1
    s_add_u32 s25, s25, 1024
    buffer_load_dwordx4 v[108:111], v5, s[64:67], s25 offen sc1
    s_add_u32 s25, s25, 1024
    buffer_load_dwordx4 v[112:115], v5, s[64:67], s25 offen sc1
    s_add_u32 s25, s25, 1024
    buffer_load_dwordx4 v[116:119], v5, s[64:67], s25 offen sc1
    s_add_u32 s25, s25, 1024
    buffer_load_dwordx4 v[120:123], v5, s[64:67], s25 offen sc1
    s_add_u32 s25, s25, 1024
    buffer_load_dwordx4 v[124:127], v5, s[64:67], s25 offen sc1
    s_add_u32 s25, s25, 1024
    buffer_load_dwordx4 v[128:131], v5, s[64:67], s25 offen sc1
    s_add_u32 s25, s25, 1024
    buffer_load_dwordx4 v[132:135], v5, s[64:67], s25 offen sc1
    s_add_u32 s25, s25, 1024
    buffer_load_dwordx4 v[136:139], v5, s[64:67], s25 offen sc1
    s_add_u32 s25, s25, 1024
    buffer_load_dwordx4 v[140:143], v5, s[64:67], s25 offen sc1
    s_add_u32 s25, s25, 1024
    buffer_load_dwordx4 v[144:147], v5, s[64:67], s25 offen sc1
    s_add_u32 s25, s25, 1024
    buffer_load_dwordx4 v[148:151], v5, s[64:67], s25 offen sc1
    s_add_u32 s25, s25, 1024
    buffer_load_dwordx4 v[152:155], v5, s[64:67], s25 offen sc1
    s_add_u32 s25, s25, 1024
    buffer_load_dwordx4 v[156:159], v5, s[64:67], s25 offen sc1
    s_add_u32 s25, s25, 1024
    buffer_load_dwordx4 v[160:163], v5, s[64:67], s25 offen sc1
    s_add_u32 s25, s25, 1024
    buffer_load_dwordx4 v[164:167], v5, s[64:67], s25 offen sc1
    s_add_u32 s25, s25, 1024
    buffer_load_dwordx4 v[168:171], v5, s[64:67], s25 offen sc1
    s_add_u32 s25, s25, 1024
    buffer_load_dwordx4 v[172:175], v5, s[64:67], s25 offen sc1
    s_add_u32 s25, s25, 1024
    buffer_load_dwordx4 v[176:179], v5, s[64:67], s25 offen sc1
    s_add_u32 s25, s25, 1024
    ds_read_b32 v3, v15
    s_waitcnt lgkmcnt(0)
L_sw_47:
    v_readfirstlane_b32 s13, v3
    s_cmp_ge_u32 s13, s10
    s_cbranch_scc1 L_swok_48
    ds_read_b32 v3, v15
    s_waitcnt lgkmcnt(0)
    s_branch L_sw_47
L_swok_48:
    ds_read_b64_tr_b16 v[20:21], v6 offset:0
    ds_read_b64_tr_b16 v[22:23], v6 offset:1024
    ds_read_b64_tr_b16 v[24:25], v7 offset:0
    ds_read_b64_tr_b16 v[26:27], v7 offset:1024
    ds_read_b64_tr_b16 v[28:29], v6 offset:2048
    ds_read_b64_tr_b16 v[30:31], v6 offset:3072
    ds_read_b64_tr_b16 v[32:33], v7 offset:2048
    ds_read_b64_tr_b16 v[34:35], v7 offset:3072
    s_waitcnt vmcnt(31) lgkmcnt(4)
    v_mfma_f32_32x32x16_bf16 v[184:199], v[20:23], v[52:55], v[184:199]
    ds_read_b64_tr_b16 v[36:37], v6 offset:4096
    ds_read_b64_tr_b16 v[38:39], v6 offset:5120
    v_mfma_f32_32x32x16_bf16 v[200:215], v[24:27], v[52:55], v[200:215]
    ds_read_b64_tr_b16 v[40:41], v7 offset:4096
    ds_read_b64_tr_b16 v[42:43], v7 offset:5120
    s_waitcnt vmcnt(30) lgkmcnt(4)
    v_mfma_f32_32x32x16_bf16 v[184:199], v[28:31], v[56:59], v[184:199]
    ds_read_b64_tr_b16 v[44:45], v6 offset:6144
    ds_read_b64_tr_b16 v[46:47], v6 offset:7168
    v_mfma_f32_32x32x16_bf16 v[200:215], v[32:35], v[56:59], v[200:215]
    ds_read_b64_tr_b16 v[48:49], v7 offset:6144
    ds_read_b64_tr_b16 v[50:51], v7 offset:7168
    s_waitcnt vmcnt(29) lgkmcnt(4)
    v_mfma_f32_32x32x16_bf16 v[184:199], v[36:39], v[60:63], v[184:199]
    ds_read_b64_tr_b16 v[20:21], v6 offset:8192
    ds_read_b64_tr_b16 v[22:23], v6 offset:9216
    v_mfma_f32_32x32x16_bf16 v[200:215], v[40:43], v[60:63], v[200:215]
    ds_read_b64_tr_b16 v[24:25], v7 offset:8192
    ds_read_b64_tr_b16 v[26:27], v7 offset:9216
    s_waitcnt vmcnt(28) lgkmcnt(4)
    v_mfma_f32_32x32x16_bf16 v[184:199], v[44:47], v[64:67], v[184:199]
    ds_read_b64_tr_b16 v[28:29], v6 offset:10240
    ds_read_b64_tr_b16 v[30:31], v6 offset:11264
    v_mfma_f32_32x32x16_bf16 v[200:215], v[48:51], v[64:67], v[200:215]
    ds_read_b64_tr_b16 v[32:33], v7 offset:10240
    ds_read_b64_tr_b16 v[34:35], v7 offset:11264
    s_waitcnt vmcnt(27) lgkmcnt(4)
    v_mfma_f32_32x32x16_bf16 v[184:199], v[20:23], v[68:71], v[184:199]
    ds_read_b64_tr_b16 v[36:37], v6 offset:12288
    ds_read_b64_tr_b16 v[38:39], v6 offset:13312
    v_mfma_f32_32x32x16_bf16 v[200:215], v[24:27], v[68:71], v[200:215]
    ds_read_b64_tr_b16 v[40:41], v7 offset:12288
    ds_read_b64_tr_b16 v[42:43], v7 offset:13312
    s_waitcnt vmcnt(26) lgkmcnt(4)
    v_mfma_f32_32x32x16_bf16 v[184:199], v[28:31], v[72:75], v[184:199]
    ds_read_b64_tr_b16 v[44:45], v6 offset:14336
    ds_read_b64_tr_b16 v[46:47], v6 offset:15360
    v_mfma_f32_32x32x16_bf16 v[200:215], v[32:35], v[72:75], v[200:215]
    ds_read_b64_tr_b16 v[48:49], v7 offset:14336
    ds_read_b64_tr_b16 v[50:51], v7 offset:15360
    s_waitcnt vmcnt(25) lgkmcnt(4)
    v_mfma_f32_32x32x16_bf16 v[184:199], v[36:39], v[76:79], v[184:199]
    ds_read_b64_tr_b16 v[20:21], v6 offset:16384
    ds_read_b64_tr_b16 v[22:23], v6 offset:17408
    v_mfma_f32_32x32x16_bf16 v[200:215], v[40:43], v[76:79], v[200:215]
    ds_read_b64_tr_b16 v[24:25], v7 offset:16384
    ds_read_b64_tr_b16 v[26:27], v7 offset:17408
    s_waitcnt vmcnt(24) lgkmcnt(4)
    v_mfma_f32_32x32x16_bf16 v[184:199], v[44:47], v[80:83], v[184:199]
    ds_read_b64_tr_b16 v[28:29], v6 offset:18432
    ds_read_b64_tr_b16 v[30:31], v6 offset:19456
    v_mfma_f32_32x32x16_bf16 v[200:215], v[48:51], v[80:83], v[200:215]
    ds_read_b64_tr_b16 v[32:33], v7 offset:18432
    ds_read_b64_tr_b16 v[34:35], v7 offset:19456
    s_waitcnt vmcnt(23) lgkmcnt(4)
    v_mfma_f32_32x32x16_bf16 v[184:199], v[20:23], v[84:87], v[184:199]
    ds_read_b64_tr_b16 v[36:37], v6 offset:20480
    ds_read_b64_tr_b16 v[38:39], v6 offset:21504
    v_mfma_f32_32x32x16_bf16 v[200:215], v[24:27], v[84:87], v[200:215]
    ds_read_b64_tr_b16 v[40:41], v7 offset:20480
    ds_read_b64_tr_b16 v[42:43], v7 offset:21504
    s_waitcnt vmcnt(22) lgkmcnt(4)
    v_mfma_f32_32x32x16_bf16 v[184:199], v[28:31], v[88:91], v[184:199]
    ds_read_b64_tr_b16 v[44:45], v6 offset:22528
    ds_read_b64_tr_b16 v[46:47], v6 offset:23552
    v_mfma_f32_32x32x16_bf16 v[200:215], v[32:35], v[88:91], v[200:215]
    ds_read_b64_tr_b16 v[48:49], v7 offset:22528
    ds_read_b64_tr_b16 v[50:51], v7 offset:23552
    s_waitcnt vmcnt(21) lgkmcnt(4)
    v_mfma_f32_32x32x16_bf16 v[184:199], v[36:39], v[92:95], v[184:199]
    ds_read_b64_tr_b16 v[20:21], v6 offset:24576
    ds_read_b64_tr_b16 v[22:23], v6 offset:25600
    v_mfma_f32_32x32x16_bf16 v[200:215], v[40:43], v[92:95], v[200:215]
    ds_read_b64_tr_b16 v[24:25], v7 offset:24576
    ds_read_b64_tr_b16 v[26:27], v7 offset:25600
    s_waitcnt vmcnt(20) lgkmcnt(4)
    v_mfma_f32_32x32x16_bf16 v[184:199], v[44:47], v[96:99], v[184:199]
    ds_read_b64_tr_b16 v[28:29], v6 offset:26624
    ds_read_b64_tr_b16 v[30:31], v6 offset:27648
    v_mfma_f32_32x32x16_bf16 v[200:215], v[48:51], v[96:99], v[200:215]
    ds_read_b64_tr_b16 v[32:33], v7 offset:26624
    ds_read_b64_tr_b16 v[34:35], v7 offset:27648
    s_waitcnt vmcnt(19) lgkmcnt(4)
    v_mfma_f32_32x32x16_bf16 v[184:199], v[20:23], v[100:103], v[184:199]
    ds_read_b64_tr_b16 v[36:37], v6 offset:28672
    ds_read_b64_tr_b16 v[38:39], v6 offset:29696
    v_mfma_f32_32x32x16_bf16 v[200:215], v[24:27], v[100:103], v[200:215]
    ds_read_b64_tr_b16 v[40:41], v7 offset:28672
    ds_read_b64_tr_b16 v[42:43], v7 offset:29696
    s_waitcnt vmcnt(18) lgkmcnt(4)
    v_mfma_f32_32x32x16_bf16 v[184:199], v[28:31], v[104:107], v[184:199]
    ds_read_b64_tr_b16 v[44:45], v6 offset:30720
    ds_read_b64_tr_b16 v[46:47], v6 offset:31744
    v_mfma_f32_32x32x16_bf16 v[200:215], v[32:35], v[104:107], v[200:215]
    ds_read_b64_tr_b16 v[48:49], v7 offset:30720
    ds_read_b64_tr_b16 v[50:51], v7 offset:31744
    s_waitcnt vmcnt(17) lgkmcnt(4)
    v_mfma_f32_32x32x16_bf16 v[184:199], v[36:39], v[108:111], v[184:199]
    ds_read_b64_tr_b16 v[20:21], v6 offset:32768
    ds_read_b64_tr_b16 v[22:23], v6 offset:33792
    v_mfma_f32_32x32x16_bf16 v[200:215], v[40:43], v[108:111], v[200:215]
    ds_read_b64_tr_b16 v[24:25], v7 offset:32768
    ds_read_b64_tr_b16 v[26:27], v7 offset:33792
    s_waitcnt vmcnt(16) lgkmcnt(4)
    v_mfma_f32_32x32x16_bf16 v[184:199], v[44:47], v[112:115], v[184:199]
    ds_read_b64_tr_b16 v[28:29], v6 offset:34816
    ds_read_b64_tr_b16 v[30:31], v6 offset:35840
    v_mfma_f32_32x32x16_bf16 v[200:215], v[48:51], v[112:115], v[200:215]
    ds_read_b64_tr_b16 v[32:33], v7 offset:34816
    ds_read_b64_tr_b16 v[34:35], v7 offset:35840
    s_waitcnt vmcnt(15) lgkmcnt(4)
    v_mfma_f32_32x32x16_bf16 v[184:199], v[20:23], v[116:119], v[184:199]
    ds_read_b64_tr_b16 v[36:37], v6 offset:36864
    ds_read_b64_tr_b16 v[38:39], v6 offset:37888
    v_mfma_f32_32x32x16_bf16 v[200:215], v[24:27], v[116:119], v[200:215]
    ds_read_b64_tr_b16 v[40:41], v7 offset:36864
    ds_read_b64_tr_b16 v[42:43], v7 offset:37888
    s_waitcnt vmcnt(14) lgkmcnt(4)
    v_mfma_f32_32x32x16_bf16 v[184:199], v[28:31], v[120:123], v[184:199]
    ds_read_b64_tr_b16 v[44:45], v6 offset:38912
    ds_read_b64_tr_b16 v[46:47], v6 offset:39936
    v_mfma_f32_32x32x16_bf16 v[200:215], v[32:35], v[120:123], v[200:215]
    ds_read_b64_tr_b16 v[48:49], v7 offset:38912
    ds_read_b64_tr_b16 v[50:51], v7 offset:39936
    s_waitcnt vmcnt(13) lgkmcnt(4)
    v_mfma_f32_32x32x16_bf16 v[184:199], v[36:39], v[124:127], v[184:199]
    ds_read_b64_tr_b16 v[20:21], v6 offset:40960
    ds_read_b64_tr_b16 v[22:23], v6 offset:41984
    v_mfma_f32_32x32x16_bf16 v[200:215], v[40:43], v[124:127], v[200:215]
    ds_read_b64_tr_b16 v[24:25], v7 offset:40960
    ds_read_b64_tr_b16 v[26:27], v7 offset:41984
    s_waitcnt vmcnt(12) lgkmcnt(4)
    v_mfma_f32_32x32x16_bf16 v[184:199], v[44:47], v[128:131], v[184:199]
    ds_read_b64_tr_b16 v[28:29], v6 offset:43008
    ds_read_b64_tr_b16 v[30:31], v6 offset:44032
    v_mfma_f32_32x32x16_bf16 v[200:215], v[48:51], v[128:131], v[200:215]
    ds_read_b64_tr_b16 v[32:33], v7 offset:43008
    ds_read_b64_tr_b16 v[34:35], v7 offset:44032
    s_waitcnt vmcnt(11) lgkmcnt(4)
    v_mfma_f32_32x32x16_bf16 v[184:199], v[20:23], v[132:135], v[184:199]
    ds_read_b64_tr_b16 v[36:37], v6 offset:45056
    ds_read_b64_tr_b16 v[38:39], v6 offset:46080
    v_mfma_f32_32x32x16_bf16 v[200:215], v[24:27], v[132:135], v[200:215]
    ds_read_b64_tr_b16 v[40:41], v7 offset:45056
    ds_read_b64_tr_b16 v[42:43], v7 offset:46080
    s_waitcnt vmcnt(10) lgkmcnt(4)
    v_mfma_f32_32x32x16_bf16 v[184:199], v[28:31], v[136:139], v[184:199]
    ds_read_b64_tr_b16 v[44:45], v6 offset:47104
    ds_read_b64_tr_b16 v[46:47], v6 offset:48128
    v_mfma_f32_32x32x16_bf16 v[200:215], v[32:35], v[136:139], v[200:215]
    ds_read_b64_tr_b16 v[48:49], v7 offset:47104
    ds_read_b64_tr_b16 v[50:51], v7 offset:48128
    s_waitcnt vmcnt(9) lgkmcnt(4)
    v_mfma_f32_32x32x16_bf16 v[184:199], v[36:39], v[140:143], v[184:199]
    ds_read_b64_tr_b16 v[20:21], v6 offset:49152
    ds_read_b64_tr_b16 v[22:23], v6 offset:50176
    v_mfma_f32_32x32x16_bf16 v[200:215], v[40:43], v[140:143], v[200:215]
    ds_read_b64_tr_b16 v[24:25], v7 offset:49152
    ds_read_b64_tr_b16 v[26:27], v7 offset:50176
    s_waitcnt vmcnt(8) lgkmcnt(4)
    v_mfma_f32_32x32x16_bf16 v[184:199], v[44:47], v[144:147], v[184:199]
    ds_read_b64_tr_b16 v[28:29], v6 offset:51200
    ds_read_b64_tr_b16 v[30:31], v6 offset:52224
    v_mfma_f32_32x32x16_bf16 v[200:215], v[48:51], v[144:147], v[200:215]
    ds_read_b64_tr_b16 v[32:33], v7 offset:51200
    ds_read_b64_tr_b16 v[34:35], v7 offset:52224
    s_waitcnt vmcnt(7) lgkmcnt(4)
    v_mfma_f32_32x32x16_bf16 v[184:199], v[20:23], v[148:151], v[184:199]
    ds_read_b64_tr_b16 v[36:37], v6 offset:53248
    ds_read_b64_tr_b16 v[38:39], v6 offset:54272
    v_mfma_f32_32x32x16_bf16 v[200:215], v[24:27], v[148:151], v[200:215]
    ds_read_b64_tr_b16 v[40:41], v7 offset:53248
    ds_read_b64_tr_b16 v[42:43], v7 offset:54272
    s_waitcnt vmcnt(6) lgkmcnt(4)
    v_mfma_f32_32x32x16_bf16 v[184:199], v[28:31], v[152:155], v[184:199]
    ds_read_b64_tr_b16 v[44:45], v6 offset:55296
    ds_read_b64_tr_b16 v[46:47], v6 offset:56320
    v_mfma_f32_32x32x16_bf16 v[200:215], v[32:35], v[152:155], v[200:215]
    ds_read_b64_tr_b16 v[48:49], v7 offset:55296
    ds_read_b64_tr_b16 v[50:51], v7 offset:56320
    s_waitcnt vmcnt(5) lgkmcnt(4)
    v_mfma_f32_32x32x16_bf16 v[184:199], v[36:39], v[156:159], v[184:199]
    ds_read_b64_tr_b16 v[20:21], v6 offset:57344
    ds_read_b64_tr_b16 v[22:23], v6 offset:58368
    v_mfma_f32_32x32x16_bf16 v[200:215], v[40:43], v[156:159], v[200:215]
    ds_read_b64_tr_b16 v[24:25], v7 offset:57344
    ds_read_b64_tr_b16 v[26:27], v7 offset:58368
    s_waitcnt vmcnt(4) lgkmcnt(4)
    v_mfma_f32_32x32x16_bf16 v[184:199], v[44:47], v[160:163], v[184:199]
    ds_read_b64_tr_b16 v[28:29], v6 offset:59392
    ds_read_b64_tr_b16 v[30:31], v6 offset:60416
    v_mfma_f32_32x32x16_bf16 v[200:215], v[48:51], v[160:163], v[200:215]
    ds_read_b64_tr_b16 v[32:33], v7 offset:59392
    ds_read_b64_tr_b16 v[34:35], v7 offset:60416
    s_waitcnt vmcnt(3) lgkmcnt(4)
    v_mfma_f32_32x32x16_bf16 v[184:199], v[20:23], v[164:167], v[184:199]
    ds_read_b64_tr_b16 v[36:37], v6 offset:61440
    ds_read_b64_tr_b16 v[38:39], v6 offset:62464
    v_mfma_f32_32x32x16_bf16 v[200:215], v[24:27], v[164:167], v[200:215]
    ds_read_b64_tr_b16 v[40:41], v7 offset:61440
    ds_read_b64_tr_b16 v[42:43], v7 offset:62464
    s_waitcnt vmcnt(2) lgkmcnt(4)
    v_mfma_f32_32x32x16_bf16 v[184:199], v[28:31], v[168:171], v[184:199]
    ds_read_b64_tr_b16 v[44:45], v6 offset:63488
    ds_read_b64_tr_b16 v[46:47], v6 offset:64512
    v_mfma_f32_32x32x16_bf16 v[200:215], v[32:35], v[168:171], v[200:215]
    ds_read_b64_tr_b16 v[48:49], v7 offset:63488
    ds_read_b64_tr_b16 v[50:51], v7 offset:64512
    s_waitcnt vmcnt(1) lgkmcnt(4)
    v_mfma_f32_32x32x16_bf16 v[184:199], v[36:39], v[172:175], v[184:199]
    v_mfma_f32_32x32x16_bf16 v[200:215], v[40:43], v[172:175], v[200:215]
    s_waitcnt vmcnt(0) lgkmcnt(0)
    v_mfma_f32_32x32x16_bf16 v[184:199], v[44:47], v[176:179], v[184:199]
    v_mfma_f32_32x32x16_bf16 v[200:215], v[48:51], v[176:179], v[200:215]
    s_mov_b64 exec, 1
    ds_add_u32 v15, v4
    s_mov_b64 exec, -1
    s_add_u32 s10, s10, 4
    ds_read_b32 v3, v15
    s_waitcnt lgkmcnt(0)
L_sw_49:
    v_readfirstlane_b32 s13, v3
    s_cmp_ge_u32 s13, s10
    s_cbranch_scc1 L_swok_50
    ds_read_b32 v3, v15
    s_waitcnt lgkmcnt(0)
    s_branch L_sw_49
L_swok_50:
    s_nop 7
    s_lshl_b32 s13, s6, 13
    s_add_u32 s13, s13, 65536
    v_add_u32 v16, s13, v5
    s_nop 3
    ds_write_b128 v16, v[184:187] offset:0
    ds_write_b128 v16, v[188:191] offset:1024
    ds_write_b128 v16, v[192:195] offset:2048
    ds_write_b128 v16, v[196:199] offset:3072
    ds_write_b128 v16, v[200:203] offset:4096
    ds_write_b128 v16, v[204:207] offset:5120
    ds_write_b128 v16, v[208:211] offset:6144
    ds_write_b128 v16, v[212:215] offset:7168
    s_waitcnt lgkmcnt(0)
    s_mov_b64 exec, 1
    ds_add_u32 v15, v4
    s_mov_b64 exec, -1
    s_add_u32 s10, s10, 4
    s_endpgm
L_role_g_1:
    v_mov_b32 v14, 0
    s_mul_i32 s13, s6, 3
    s_add_u32 s13, s13, 0
    s_mov_b32 s72, s48
    s_and_b32 s73, s49, 0xffff
    s_mov_b32 s74, 0x700000
    s_mov_b32 s75, 0x00020000
    s_cmp_ge_u32 s13, 7
    s_cselect_b32 s14, 1, 0
    s_mul_i32 s15, s14, 7
    s_sub_u32 s15, s13, s15
    s_lshl_b32 s15, s15, 10
    v_add_u32 v24, s15, v5
    s_mov_b32 s16, 9363
    v_mul_lo_u32 v25, v24, s16
    v_lshrrev_b32 v25, 22, v25
    s_mov_b32 s16, 6720
    v_mul_lo_u32 v25, v25, s16
    v_add_u32 v1, v24, v25
    s_mul_i32 s16, s14, 114688
    s_mul_i32 s88, s5, 448
    s_add_u32 s88, s88, s16
    s_mov_b32 s92, 229376
    s_mul_i32 s16, s14, 7168
    s_add_u32 s96, s15, s16
    s_mul_i32 s13, s6, 3
    s_add_u32 s13, s13, 1
    s_mov_b32 s76, s48
    s_and_b32 s77, s49, 0xffff
    s_mov_b32 s78, 0x700000
    s_mov_b32 s79, 0x00020000
    s_cmp_ge_u32 s13, 7
    s_cselect_b32 s14, 1, 0
    s_mul_i32 s15, s14, 7
    s_sub_u32 s15, s13, s15
    s_lshl_b32 s15, s15, 10
    v_add_u32 v24, s15, v5
    s_mov_b32 s16, 9363
    v_mul_lo_u32 v25, v24, s16
    v_lshrrev_b32 v25, 22, v25
    s_mov_b32 s16, 6720
    v_mul_lo_u32 v25, v25, s16
    v_add_u32 v2, v24, v25
    s_mul_i32 s16, s14, 114688
    s_mul_i32 s89, s5, 448
    s_add_u32 s89, s89, s16
    s_mov_b32 s93, 229376
    s_mul_i32 s16, s14, 7168
    s_add_u32 s97, s15, s16
    s_mul_i32 s13, s6, 3
    s_add_u32 s13, s13, 2
    s_mov_b32 s80, s48
    s_and_b32 s81, s49, 0xffff
    s_mov_b32 s82, 0x700000
    s_mov_b32 s83, 0x00020000
    s_cmp_ge_u32 s13, 7
    s_cselect_b32 s14, 1, 0
    s_mul_i32 s15, s14, 7
    s_sub_u32 s15, s13, s15
    s_lshl_b32 s15, s15, 10
    v_add_u32 v24, s15, v5
    s_mov_b32 s16, 9363
    v_mul_lo_u32 v25, v24, s16
    v_lshrrev_b32 v25, 22, v25
    s_mov_b32 s16, 6720
    v_mul_lo_u32 v25, v25, s16
    v_add_u32 v3, v24, v25
    s_mul_i32 s16, s14, 114688
    s_mul_i32 s90, s5, 448
    s_add_u32 s90, s90, s16
    s_mov_b32 s94, 229376
    s_mul_i32 s16, s14, 7168
    s_add_u32 s98, s15, s16
    s_add_u32 m0, s96, 0
    s_nop 0
    buffer_load_dwordx4 v1, s[72:75], s88 offen  lds
    s_add_u32 s88, s88, s92
    s_add_u32 m0, s97, 0
    s_nop 0
    buffer_load_dwordx4 v2, s[76:79], s89 offen  lds
    s_add_u32 s89, s89, s93
    s_add_u32 m0, s98, 0
    s_nop 0
    buffer_load_dwordx4 v3, s[80:83], s90 offen  lds
    s_add_u32 s90, s90, s94
    s_add_u32 m0, s96, 20480
    s_nop 0
    buffer_load_dwordx4 v1, s[72:75], s88 offen  lds
    s_add_u32 s88, s88, s92
    s_add_u32 m0, s97, 20480
    s_nop 0
    buffer_load_dwordx4 v2, s[76:79], s89 offen  lds
    s_add_u32 s89, s89, s93
    s_add_u32 m0, s98, 20480
    s_nop 0
    buffer_load_dwordx4 v3, s[80:83], s90 offen  lds
    s_add_u32 s90, s90, s94
    s_add_u32 m0, s96, 40960
    s_nop 0
    buffer_load_dwordx4 v1, s[72:75], s88 offen  lds
    s_add_u32 s88, s88, s92
    s_add_u32 m0, s97, 40960
    s_nop 0
    buffer_load_dwordx4 v2, s[76:79], s89 offen  lds
    s_add_u32 s89, s89, s93
    s_add_u32 m0, s98, 40960
    s_nop 0
    buffer_load_dwordx4 v3, s[80:83], s90 offen  lds
    s_add_u32 s90, s90, s94
    s_add_u32 m0, s96, 61440
    s_nop 0
    buffer_load_dwordx4 v1, s[72:75], s88 offen  lds
    s_add_u32 s88, s88, s92
    s_add_u32 m0, s97, 61440
    s_nop 0
    buffer_load_dwordx4 v2, s[76:79], s89 offen  lds
    s_add_u32 s89, s89, s93
    s_add_u32 m0, s98, 61440
    s_nop 0
    buffer_load_dwordx4 v3, s[80:83], s90 offen  lds
    s_add_u32 s90, s90, s94
    v_lshrrev_b32 v20, 5, v0
    v_bfe_u32 v21, v0, 2, 2
    v_lshl_add_u32 v22, v20, 3, v21
    v_bfe_u32 v23, v0, 4, 1
    v_and_b32 v24, 3, v0
    v_lshlrev_b32 v25, 3, v24
    v_lshl_add_u32 v25, v23, 5, v25
    s_mov_b32 s13, 448
    v_mul_lo_u32 v26, v22, s13
    v_add_u32 v26, v26, v25
    s_mul_i32 s13, s8, 192
    v_add_u32 v228, s13, v26
    v_add_u32 v230, 384, v26
    v_add_u32 v229, 0xf000, v228
    v_add_u32 v231, 0xf000, v230
    v_bfe_u32 v27, v0, 1, 3
    v_xor_b32 v27, v27, v20
    v_and_b32 v26, 31, v0
    v_lshlrev_b32 v26, 7, v26
    v_lshl_add_u32 v26, v27, 4, v26
    s_lshl_b32 s13, s18, 12
    s_add_u32 s13, s13, 102400
    s_lshl_b32 s14, s19, 12
    s_add_u32 s14, s14, 102400
    v_add_u32 v232, s13, v26
    v_add_u32 v236, s14, v26
    v_xor_b32 v233, 32, v232
    v_xor_b32 v234, 64, v232
    v_xor_b32 v235, 96, v232
    v_xor_b32 v237, 32, v236
    v_xor_b32 v238, 64, v236
    v_xor_b32 v239, 96, v236
    v_mov_b32 v116, 0
    v_mov_b32 v117, 0
    v_mov_b32 v118, 0
    v_mov_b32 v119, 0
    v_mov_b32 v120, 0
    v_mov_b32 v121, 0
    v_mov_b32 v122, 0
    v_mov_b32 v123, 0
    v_mov_b32 v124, 0
    v_mov_b32 v125, 0
    v_mov_b32 v126, 0
    v_mov_b32 v127, 0
    v_mov_b32 v128, 0
    v_mov_b32 v129, 0
    v_mov_b32 v130, 0
    v_mov_b32 v131, 0
    v_mov_b32 v132, 0
    v_mov_b32 v133, 0
    v_mov_b32 v134, 0
    v_mov_b32 v135, 0
    v_mov_b32 v136, 0
    v_mov_b32 v137, 0
    v_mov_b32 v138, 0
    v_mov_b32 v139, 0
    v_mov_b32 v140, 0
    v_mov_b32 v141, 0
    v_mov_b32 v142, 0
    v_mov_b32 v143, 0
    v_mov_b32 v144, 0
    v_mov_b32 v145, 0
    v_mov_b32 v146, 0
    v_mov_b32 v147, 0
    v_mov_b32 v148, 0
    v_mov_b32 v149, 0
    v_mov_b32 v150, 0
    v_mov_b32 v151, 0
    v_mov_b32 v152, 0
    v_mov_b32 v153, 0
    v_mov_b32 v154, 0
    v_mov_b32 v155, 0
    v_mov_b32 v156, 0
    v_mov_b32 v157, 0
    v_mov_b32 v158, 0
    v_mov_b32 v159, 0
    v_mov_b32 v160, 0
    v_mov_b32 v161, 0
    v_mov_b32 v162, 0
    v_mov_b32 v163, 0
    v_mov_b32 v164, 0
    v_mov_b32 v165, 0
    v_mov_b32 v166, 0
    v_mov_b32 v167, 0
    v_mov_b32 v168, 0
    v_mov_b32 v169, 0
    v_mov_b32 v170, 0
    v_mov_b32 v171, 0
    v_mov_b32 v172, 0
    v_mov_b32 v173, 0
    v_mov_b32 v174, 0
    v_mov_b32 v175, 0
    v_mov_b32 v176, 0
    v_mov_b32 v177, 0
    v_mov_b32 v178, 0
    v_mov_b32 v179, 0
    v_mov_b32 v180, 0
    v_mov_b32 v181, 0
    v_mov_b32 v182, 0
    v_mov_b32 v183, 0
    v_mov_b32 v184, 0
    v_mov_b32 v185, 0
    v_mov_b32 v186, 0
    v_mov_b32 v187, 0
    v_mov_b32 v188, 0
    v_mov_b32 v189, 0
    v_mov_b32 v190, 0
    v_mov_b32 v191, 0
    v_mov_b32 v192, 0
    v_mov_b32 v193, 0
    v_mov_b32 v194, 0
    v_mov_b32 v195, 0
    v_mov_b32 v196, 0
    v_mov_b32 v197, 0
    v_mov_b32 v198, 0
    v_mov_b32 v199, 0
    v_mov_b32 v200, 0
    v_mov_b32 v201, 0
    v_mov_b32 v202, 0
    v_mov_b32 v203, 0
    v_mov_b32 v204, 0
    v_mov_b32 v205, 0
    v_mov_b32 v206, 0
    v_mov_b32 v207, 0
    v_mov_b32 v208, 0
    v_mov_b32 v209, 0
    v_mov_b32 v210, 0
    v_mov_b32 v211, 0
    v_mov_b32 v212, 0
    v_mov_b32 v213, 0
    v_mov_b32 v214, 0
    v_mov_b32 v215, 0
    v_mov_b32 v216, 0
    v_mov_b32 v217, 0
    v_mov_b32 v218, 0
    v_mov_b32 v219, 0
    v_mov_b32 v220, 0
    v_mov_b32 v221, 0
    v_mov_b32 v222, 0
    v_mov_b32 v223, 0
    v_mov_b32 v224, 0
    v_mov_b32 v225, 0
    v_mov_b32 v226, 0
    v_mov_b32 v227, 0
    s_waitcnt vmcnt(9)
    s_barrier
    ds_read_b128 v[36:39], v232 offset:0
    ds_read_b64_tr_b16 v[20:21], v228 offset:0
    ds_read_b64_tr_b16 v[22:23], v228 offset:1792
    ds_read_b128 v[40:43], v236 offset:0
    ds_read_b64_tr_b16 v[24:25], v228 offset:64
    ds_read_b64_tr_b16 v[26:27], v228 offset:1856
    ds_read_b64_tr_b16 v[28:29], v228 offset:128
    ds_read_b64_tr_b16 v[30:31], v228 offset:1920
    ds_read_b64_tr_b16 v[32:33], v230 offset:0
    ds_read_b64_tr_b16 v[34:35], v230 offset:1792
    ds_read_b128 v[60:63], v233 offset:0
    ds_read_b64_tr_b16 v[44:45], v228 offset:7168
    ds_read_b64_tr_b16 v[46:47], v228 offset:8960
    ds_read_b128 v[64:67], v237 offset:0
    ds_read_b64_tr_b16 v[48:49], v228 offset:7232
    ds_read_b64_tr_b16 v[50:51], v228 offset:9024
    ds_read_b64_tr_b16 v[52:53], v228 offset:7296
    ds_read_b64_tr_b16 v[54:55], v228 offset:9088
    ds_read_b64_tr_b16 v[56:57], v230 offset:7168
    ds_read_b64_tr_b16 v[58:59], v230 offset:8960
    s_waitcnt vmcnt(6) lgkmcnt(10)
    v_mfma_f32_32x32x16_bf16 v[116:131], v[20:23], v[36:39], v[116:131]
    s_barrier
    ds_read_b128 v[84:87], v234 offset:0
    v_mfma_f32_32x32x16_bf16 v[132:147], v[20:23], v[40:43], v[132:147]
    ds_read_b64_tr_b16 v[68:69], v228 offset:20480
    v_mfma_f32_32x32x16_bf16 v[148:163], v[24:27], v[36:39], v[148:163]
    ds_read_b64_tr_b16 v[70:71], v228 offset:22272
    ds_read_b128 v[88:91], v238 offset:0
    v_mfma_f32_32x32x16_bf16 v[164:179], v[24:27], v[40:43], v[164:179]
    ds_read_b64_tr_b16 v[72:73], v228 offset:20544
    v_mfma_f32_32x32x16_bf16 v[180:195], v[28:31], v[36:39], v[180:195]
    ds_read_b64_tr_b16 v[74:75], v228 offset:22336
    ds_read_b64_tr_b16 v[76:77], v228 offset:20608
    s_add_u32 m0, s96, 81920
    s_nop 0
    buffer_load_dwordx4 v1, s[72:75], s88 offen  lds
    s_add_u32 s88, s88, s92
    v_mfma_f32_32x32x16_bf16 v[196:211], v[28:31], v[40:43], v[196:211]
    ds_read_b64_tr_b16 v[78:79], v228 offset:22400
    v_mfma_f32_32x32x16_bf16 v[212:227], v[32:35], v[36:39], v[212:227]
    ds_read_b64_tr_b16 v[80:81], v230 offset:20480
    ds_read_b64_tr_b16 v[82:83], v230 offset:22272
    s_waitcnt lgkmcnt(10)
    v_mfma_f32_32x32x16_bf16 v[116:131], v[44:47], v[60:63], v[116:131]
    ds_read_b128 v[108:111], v235 offset:0
    v_mfma_f32_32x32x16_bf16 v[132:147], v[44:47], v[64:67], v[132:147]
    ds_read_b64_tr_b16 v[92:93], v228 offset:27648
    s_add_u32 m0, s97, 81920
    s_nop 0
    buffer_load_dwordx4 v2, s[76:79], s89 offen  lds
    s_add_u32 s89, s89, s93
    v_mfma_f32_32x32x16_bf16 v[148:163], v[48:51], v[60:63], v[148:163]
    ds_read_b64_tr_b16 v[94:95], v228 offset:29440
    ds_read_b128 v[112:115], v239 offset:0
    v_mfma_f32_32x32x16_bf16 v[164:179], v[48:51], v[64:67], v[164:179]
    ds_read_b64_tr_b16 v[96:97], v228 offset:27712
    v_mfma_f32_32x32x16_bf16 v[180:195], v[52:55], v[60:63], v[180:195]
    ds_read_b64_tr_b16 v[98:99], v228 offset:29504
    ds_read_b64_tr_b16 v[100:101], v228 offset:27776
    v_mfma_f32_32x32x16_bf16 v[196:211], v[52:55], v[64:67], v[196:211]
    ds_read_b64_tr_b16 v[102:103], v228 offset:29568
    s_add_u32 m0, s98, 81920
    s_nop 0
    buffer_load_dwordx4 v3, s[80:83], s90 offen  lds
    s_add_u32 s90, s90, s94
    v_mfma_f32_32x32x16_bf16 v[212:227], v[56:59], v[60:63], v[212:227]
    ds_read_b64_tr_b16 v[104:105], v230 offset:27648
    ds_read_b64_tr_b16 v[106:107], v230 offset:29440
    s_waitcnt vmcnt(6) lgkmcnt(10)
    v_mfma_f32_32x32x16_bf16 v[116:131], v[68:71], v[84:87], v[116:131]
    s_barrier
    ds_read_b128 v[36:39], v232 offset:16384
    v_mfma_f32_32x32x16_bf16 v[132:147], v[68:71], v[88:91], v[132:147]
    ds_read_b64_tr_b16 v[20:21], v228 offset:40960
    v_mfma_f32_32x32x16_bf16 v[148:163], v[72:75], v[84:87], v[148:163]
    ds_read_b64_tr_b16 v[22:23], v228 offset:42752
    ds_read_b128 v[40:43], v236 offset:16384
    v_mfma_f32_32x32x16_bf16 v[164:179], v[72:75], v[88:91], v[164:179]
    ds_read_b64_tr_b16 v[24:25], v228 offset:41024
    v_mfma_f32_32x32x16_bf16 v[180:195], v[76:79], v[84:87], v[180:195]
    ds_read_b64_tr_b16 v[26:27], v228 offset:42816
    ds_read_b64_tr_b16 v[28:29], v228 offset:41088
    s_add_u32 m0, s96, 0
    s_nop 0
    buffer_load_dwordx4 v1, s[72:75], s88 offen  lds
    s_add_u32 s88, s88, s92
    v_mfma_f32_32x32x16_bf16 v[196:211], v[76:79], v[88:91], v[196:211]
    ds_read_b64_tr_b16 v[30:31], v228 offset:42880
    v_mfma_f32_32x32x16_bf16 v[212:227], v[80:83], v[84:87], v[212:227]
    ds_read_b64_tr_b16 v[32:33], v230 offset:40960
    ds_read_b64_tr_b16 v[34:35], v230 offset:42752
    s_waitcnt lgkmcnt(10)
    v_mfma_f32_32x32x16_bf16 v[116:131], v[92:95], v[108:111], v[116:131]
    ds_read_b128 v[60:63], v233 offset:16384
    v_mfma_f32_32x32x16_bf16 v[132:147], v[92:95], v[112:115], v[132:147]
    ds_read_b64_tr_b16 v[44:45], v228 offset:48128
    s_add_u32 m0, s97, 0
    s_nop 0
    buffer_load_dwordx4 v2, s[76:79], s89 offen  lds
    s_add_u32 s89, s89, s93
    v_mfma_f32_32x32x16_bf16 v[148:163], v[96:99], v[108:111], v[148:163]
    ds_read_b64_tr_b16 v[46:47], v228 offset:49920
    ds_read_b128 v[64:67], v237 offset:16384
    v_mfma_f32_32x32x16_bf16 v[164:179], v[96:99], v[112:115], v[164:179]
    ds_read_b64_tr_b16 v[48:49], v228 offset:48192
    v_mfma_f32_32x32x16_bf16 v[180:195], v[100:103], v[108:111], v[180:195]
    ds_read_b64_tr_b16 v[50:51], v228 offset:49984
    ds_read_b64_tr_b16 v[52:53], v228 offset:48256
    v_mfma_f32_32x32x16_bf16 v[196:211], v[100:103], v[112:115], v[196:211]
    ds_read_b64_tr_b16 v[54:55], v228 offset:50048
    s_add_u32 m0, s98, 0
    s_nop 0
    buffer_load_dwordx4 v3, s[80:83], s90 offen  lds
    s_add_u32 s90, s90, s94
    v_mfma_f32_32x32x16_bf16 v[212:227], v[104:107], v[108:111], v[212:227]
    ds_read_b64_tr_b16 v[56:57], v230 offset:48128
    ds_read_b64_tr_b16 v[58:59], v230 offset:49920
    s_waitcnt vmcnt(6) lgkmcnt(10)
    v_mfma_f32_32x32x16_bf16 v[116:131], v[20:23], v[36:39], v[116:131]
    s_barrier
    ds_read_b128 v[84:87], v234 offset:16384
    v_mfma_f32_32x32x16_bf16 v[132:147], v[20:23], v[40:43], v[132:147]
    ds_read_b64_tr_b16 v[68:69], v229 offset:0
    v_mfma_f32_32x32x16_bf16 v[148:163], v[24:27], v[36:39], v[148:163]
    ds_read_b64_tr_b16 v[70:71], v229 offset:1792
    ds_read_b128 v[88:91], v238 offset:16384
    v_mfma_f32_32x32x16_bf16 v[164:179], v[24:27], v[40:43], v[164:179]
    ds_read_b64_tr_b16 v[72:73], v229 offset:64
    v_mfma_f32_32x32x16_bf16 v[180:195], v[28:31], v[36:39], v[180:195]
    ds_read_b64_tr_b16 v[74:75], v229 offset:1856
    ds_read_b64_tr_b16 v[76:77], v229 offset:128
    s_add_u32 m0, s96, 20480
    s_nop 0
    buffer_load_dwordx4 v1, s[72:75], s88 offen  lds
    s_add_u32 s88, s88, s92
    v_mfma_f32_32x32x16_bf16 v[196:211], v[28:31], v[40:43], v[196:211]
    ds_read_b64_tr_b16 v[78:79], v229 offset:1920
    v_mfma_f32_32x32x16_bf16 v[212:227], v[32:35], v[36:39], v[212:227]
    ds_read_b64_tr_b16 v[80:81], v231 offset:0
    ds_read_b64_tr_b16 v[82:83], v231 offset:1792
    s_waitcnt lgkmcnt(10)
    v_mfma_f32_32x32x16_bf16 v[116:131], v[44:47], v[60:63], v[116:131]
    ds_read_b128 v[108:111], v235 offset:16384
    v_mfma_f32_32x32x16_bf16 v[132:147], v[44:47], v[64:67], v[132:147]
    ds_read_b64_tr_b16 v[92:93], v229 offset:7168
    s_add_u32 m0, s97, 20480
    s_nop 0
    buffer_load_dwordx4 v2, s[76:79], s89 offen  lds
    s_add_u32 s89, s89, s93
    v_mfma_f32_32x32x16_bf16 v[148:163], v[48:51], v[60:63], v[148:163]
    ds_read_b64_tr_b16 v[94:95], v229 offset:8960
    ds_read_b128 v[112:115], v239 offset:16384
    v_mfma_f32_32x32x16_bf16 v[164:179], v[48:51], v[64:67], v[164:179]
    ds_read_b64_tr_b16 v[96:97], v229 offset:7232
    v_mfma_f32_32x32x16_bf16 v[180:195], v[52:55], v[60:63], v[180:195]
    ds_read_b64_tr_b16 v[98:99], v229 offset:9024
    ds_read_b64_tr_b16 v[100:101], v229 offset:7296
    v_mfma_f32_32x32x16_bf16 v[196:211], v[52:55], v[64:67], v[196:211]
    ds_read_b64_tr_b16 v[102:103], v229 offset:9088
    s_add_u32 m0, s98, 20480
    s_nop 0
    buffer_load_dwordx4 v3, s[80:83], s90 offen  lds
    s_add_u32 s90, s90, s94
    v_mfma_f32_32x32x16_bf16 v[212:227], v[56:59], v[60:63], v[212:227]
    ds_read_b64_tr_b16 v[104:105], v231 offset:7168
    ds_read_b64_tr_b16 v[106:107], v231 offset:8960
    s_waitcnt vmcnt(6) lgkmcnt(10)
    v_mfma_f32_32x32x16_bf16 v[116:131], v[68:71], v[84:87], v[116:131]
    s_barrier
    ds_read_b128 v[36:39], v232 offset:32768
    v_mfma_f32_32x32x16_bf16 v[132:147], v[68:71], v[88:91], v[132:147]
    ds_read_b64_tr_b16 v[20:21], v229 offset:20480
    v_mfma_f32_32x32x16_bf16 v[148:163], v[72:75], v[84:87], v[148:163]
    ds_read_b64_tr_b16 v[22:23], v229 offset:22272
    ds_read_b128 v[40:43], v236 offset:32768
    v_mfma_f32_32x32x16_bf16 v[164:179], v[72:75], v[88:91], v[164:179]
    ds_read_b64_tr_b16 v[24:25], v229 offset:20544
    v_mfma_f32_32x32x16_bf16 v[180:195], v[76:79], v[84:87], v[180:195]
    ds_read_b64_tr_b16 v[26:27], v229 offset:22336
    ds_read_b64_tr_b16 v[28:29], v229 offset:20608
    s_add_u32 m0, s96, 40960
    s_nop 0
    buffer_load_dwordx4 v1, s[72:75], s88 offen  lds
    s_add_u32 s88, s88, s92
    v_mfma_f32_32x32x16_bf16 v[196:211], v[76:79], v[88:91], v[196:211]
    ds_read_b64_tr_b16 v[30:31], v229 offset:22400
    v_mfma_f32_32x32x16_bf16 v[212:227], v[80:83], v[84:87], v[212:227]
    ds_read_b64_tr_b16 v[32:33], v231 offset:20480
    ds_read_b64_tr_b16 v[34:35], v231 offset:22272
    s_waitcnt lgkmcnt(10)
    v_mfma_f32_32x32x16_bf16 v[116:131], v[92:95], v[108:111], v[116:131]
    ds_read_b128 v[60:63], v233 offset:32768
    v_mfma_f32_32x32x16_bf16 v[132:147], v[92:95], v[112:115], v[132:147]
    ds_read_b64_tr_b16 v[44:45], v229 offset:27648
    s_add_u32 m0, s97, 40960
    s_nop 0
    buffer_load_dwordx4 v2, s[76:79], s89 offen  lds
    s_add_u32 s89, s89, s93
    v_mfma_f32_32x32x16_bf16 v[148:163], v[96:99], v[108:111], v[148:163]
    ds_read_b64_tr_b16 v[46:47], v229 offset:29440
    ds_read_b128 v[64:67], v237 offset:32768
    v_mfma_f32_32x32x16_bf16 v[164:179], v[96:99], v[112:115], v[164:179]
    ds_read_b64_tr_b16 v[48:49], v229 offset:27712
    v_mfma_f32_32x32x16_bf16 v[180:195], v[100:103], v[108:111], v[180:195]
    ds_read_b64_tr_b16 v[50:51], v229 offset:29504
    ds_read_b64_tr_b16 v[52:53], v229 offset:27776
    v_mfma_f32_32x32x16_bf16 v[196:211], v[100:103], v[112:115], v[196:211]
    ds_read_b64_tr_b16 v[54:55], v229 offset:29568
    s_add_u32 m0, s98, 40960
    s_nop 0
    buffer_load_dwordx4 v3, s[80:83], s90 offen  lds
    s_add_u32 s90, s90, s94
    v_mfma_f32_32x32x16_bf16 v[212:227], v[104:107], v[108:111], v[212:227]
    ds_read_b64_tr_b16 v[56:57], v231 offset:27648
    ds_read_b64_tr_b16 v[58:59], v231 offset:29440
    s_waitcnt vmcnt(6) lgkmcnt(10)
    v_mfma_f32_32x32x16_bf16 v[116:131], v[20:23], v[36:39], v[116:131]
    s_barrier
    ds_read_b128 v[84:87], v234 offset:32768
    v_mfma_f32_32x32x16_bf16 v[132:147], v[20:23], v[40:43], v[132:147]
    ds_read_b64_tr_b16 v[68:69], v228 offset:0
    v_mfma_f32_32x32x16_bf16 v[148:163], v[24:27], v[36:39], v[148:163]
    ds_read_b64_tr_b16 v[70:71], v228 offset:1792
    ds_read_b128 v[88:91], v238 offset:32768
    v_mfma_f32_32x32x16_bf16 v[164:179], v[24:27], v[40:43], v[164:179]
    ds_read_b64_tr_b16 v[72:73], v228 offset:64
    v_mfma_f32_32x32x16_bf16 v[180:195], v[28:31], v[36:39], v[180:195]
    ds_read_b64_tr_b16 v[74:75], v228 offset:1856
    ds_read_b64_tr_b16 v[76:77], v228 offset:128
    s_add_u32 m0, s96, 61440
    s_nop 0
    buffer_load_dwordx4 v1, s[72:75], s88 offen  lds
    s_add_u32 s88, s88, s92
    v_mfma_f32_32x32x16_bf16 v[196:211], v[28:31], v[40:43], v[196:211]
    ds_read_b64_tr_b16 v[78:79], v228 offset:1920
    v_mfma_f32_32x32x16_bf16 v[212:227], v[32:35], v[36:39], v[212:227]
    ds_read_b64_tr_b16 v[80:81], v230 offset:0
    ds_read_b64_tr_b16 v[82:83], v230 offset:1792
    s_waitcnt lgkmcnt(10)
    v_mfma_f32_32x32x16_bf16 v[116:131], v[44:47], v[60:63], v[116:131]
    ds_read_b128 v[108:111], v235 offset:32768
    v_mfma_f32_32x32x16_bf16 v[132:147], v[44:47], v[64:67], v[132:147]
    ds_read_b64_tr_b16 v[92:93], v228 offset:7168
    s_add_u32 m0, s97, 61440
    s_nop 0
    buffer_load_dwordx4 v2, s[76:79], s89 offen  lds
    s_add_u32 s89, s89, s93
    v_mfma_f32_32x32x16_bf16 v[148:163], v[48:51], v[60:63], v[148:163]
    ds_read_b64_tr_b16 v[94:95], v228 offset:8960
    ds_read_b128 v[112:115], v239 offset:32768
    v_mfma_f32_32x32x16_bf16 v[164:179], v[48:51], v[64:67], v[164:179]
    ds_read_b64_tr_b16 v[96:97], v228 offset:7232
    v_mfma_f32_32x32x16_bf16 v[180:195], v[52:55], v[60:63], v[180:195]
    ds_read_b64_tr_b16 v[98:99], v228 offset:9024
    ds_read_b64_tr_b16 v[100:101], v228 offset:7296
    v_mfma_f32_32x32x16_bf16 v[196:211], v[52:55], v[64:67], v[196:211]
    ds_read_b64_tr_b16 v[102:103], v228 offset:9088
    s_add_u32 m0, s98, 61440
    s_nop 0
    buffer_load_dwordx4 v3, s[80:83], s90 offen  lds
    s_add_u32 s90, s90, s94
    v_mfma_f32_32x32x16_bf16 v[212:227], v[56:59], v[60:63], v[212:227]
    ds_read_b64_tr_b16 v[104:105], v230 offset:7168
    ds_read_b64_tr_b16 v[106:107], v230 offset:8960
    s_waitcnt vmcnt(6) lgkmcnt(10)
    v_mfma_f32_32x32x16_bf16 v[116:131], v[68:71], v[84:87], v[116:131]
    s_barrier
    ds_read_b128 v[36:39], v232 offset:0
    v_mfma_f32_32x32x16_bf16 v[132:147], v[68:71], v[88:91], v[132:147]
    ds_read_b64_tr_b16 v[20:21], v228 offset:20480
    v_mfma_f32_32x32x16_bf16 v[148:163], v[72:75], v[84:87], v[148:163]
    ds_read_b64_tr_b16 v[22:23], v228 offset:22272
    ds_read_b128 v[40:43], v236 offset:0
    v_mfma_f32_32x32x16_bf16 v[164:179], v[72:75], v[88:91], v[164:179]
    ds_read_b64_tr_b16 v[24:25], v228 offset:20544
    v_mfma_f32_32x32x16_bf16 v[180:195], v[76:79], v[84:87], v[180:195]
    ds_read_b64_tr_b16 v[26:27], v228 offset:22336
    ds_read_b64_tr_b16 v[28:29], v228 offset:20608
    s_add_u32 m0, s96, 81920
    s_nop 0
    buffer_load_dwordx4 v1, s[72:75], s88 offen  lds
    s_add_u32 s88, s88, s92
    v_mfma_f32_32x32x16_bf16 v[196:211], v[76:79], v[88:91], v[196:211]
    ds_read_b64_tr_b16 v[30:31], v228 offset:22400
    v_mfma_f32_32x32x16_bf16 v[212:227], v[80:83], v[84:87], v[212:227]
    ds_read_b64_tr_b16 v[32:33], v230 offset:20480
    ds_read_b64_tr_b16 v[34:35], v230 offset:22272
    s_waitcnt lgkmcnt(10)
    v_mfma_f32_32x32x16_bf16 v[116:131], v[92:95], v[108:111], v[116:131]
    ds_read_b128 v[60:63], v233 offset:0
    v_mfma_f32_32x32x16_bf16 v[132:147], v[92:95], v[112:115], v[132:147]
    ds_read_b64_tr_b16 v[44:45], v228 offset:27648
    s_add_u32 m0, s97, 81920
    s_nop 0
    buffer_load_dwordx4 v2, s[76:79], s89 offen  lds
    s_add_u32 s89, s89, s93
    v_mfma_f32_32x32x16_bf16 v[148:163], v[96:99], v[108:111], v[148:163]
    ds_read_b64_tr_b16 v[46:47], v228 offset:29440
    ds_read_b128 v[64:67], v237 offset:0
    v_mfma_f32_32x32x16_bf16 v[164:179], v[96:99], v[112:115], v[164:179]
    ds_read_b64_tr_b16 v[48:49], v228 offset:27712
    v_mfma_f32_32x32x16_bf16 v[180:195], v[100:103], v[108:111], v[180:195]
    ds_read_b64_tr_b16 v[50:51], v228 offset:29504
    ds_read_b64_tr_b16 v[52:53], v228 offset:27776
    v_mfma_f32_32x32x16_bf16 v[196:211], v[100:103], v[112:115], v[196:211]
    ds_read_b64_tr_b16 v[54:55], v228 offset:29568
    s_add_u32 m0, s98, 81920
    s_nop 0
    buffer_load_dwordx4 v3, s[80:83], s90 offen  lds
    s_add_u32 s90, s90, s94
    v_mfma_f32_32x32x16_bf16 v[212:227], v[104:107], v[108:111], v[212:227]
    ds_read_b64_tr_b16 v[56:57], v230 offset:27648
    ds_read_b64_tr_b16 v[58:59], v230 offset:29440
    s_waitcnt vmcnt(6) lgkmcnt(10)
    v_mfma_f32_32x32x16_bf16 v[116:131], v[20:23], v[36:39], v[116:131]
    s_barrier
    ds_read_b128 v[84:87], v234 offset:0
    v_mfma_f32_32x32x16_bf16 v[132:147], v[20:23], v[40:43], v[132:147]
    ds_read_b64_tr_b16 v[68:69], v228 offset:40960
    v_mfma_f32_32x32x16_bf16 v[148:163], v[24:27], v[36:39], v[148:163]
    ds_read_b64_tr_b16 v[70:71], v228 offset:42752
    ds_read_b128 v[88:91], v238 offset:0
    v_mfma_f32_32x32x16_bf16 v[164:179], v[24:27], v[40:43], v[164:179]
    ds_read_b64_tr_b16 v[72:73], v228 offset:41024
    v_mfma_f32_32x32x16_bf16 v[180:195], v[28:31], v[36:39], v[180:195]
    ds_read_b64_tr_b16 v[74:75], v228 offset:42816
    ds_read_b64_tr_b16 v[76:77], v228 offset:41088
    s_add_u32 m0, s96, 0
    s_nop 0
    buffer_load_dwordx4 v1, s[72:75], s88 offen  lds
    s_add_u32 s88, s88, s92
    v_mfma_f32_32x32x16_bf16 v[196:211], v[28:31], v[40:43], v[196:211]
    ds_read_b64_tr_b16 v[78:79], v228 offset:42880
    v_mfma_f32_32x32x16_bf16 v[212:227], v[32:35], v[36:39], v[212:227]
    ds_read_b64_tr_b16 v[80:81], v230 offset:40960
    ds_read_b64_tr_b16 v[82:83], v230 offset:42752
    s_waitcnt lgkmcnt(10)
    v_mfma_f32_32x32x16_bf16 v[116:131], v[44:47], v[60:63], v[116:131]
    ds_read_b128 v[108:111], v235 offset:0
    v_mfma_f32_32x32x16_bf16 v[132:147], v[44:47], v[64:67], v[132:147]
    ds_read_b64_tr_b16 v[92:93], v228 offset:48128
    s_add_u32 m0, s97, 0
    s_nop 0
    buffer_load_dwordx4 v2, s[76:79], s89 offen  lds
    s_add_u32 s89, s89, s93
    v_mfma_f32_32x32x16_bf16 v[148:163], v[48:51], v[60:63], v[148:163]
    ds_read_b64_tr_b16 v[94:95], v228 offset:49920
    ds_read_b128 v[112:115], v239 offset:0
    v_mfma_f32_32x32x16_bf16 v[164:179], v[48:51], v[64:67], v[164:179]
    ds_read_b64_tr_b16 v[96:97], v228 offset:48192
    v_mfma_f32_32x32x16_bf16 v[180:195], v[52:55], v[60:63], v[180:195]
    ds_read_b64_tr_b16 v[98:99], v228 offset:49984
    ds_read_b64_tr_b16 v[100:101], v228 offset:48256
    v_mfma_f32_32x32x16_bf16 v[196:211], v[52:55], v[64:67], v[196:211]
    ds_read_b64_tr_b16 v[102:103], v228 offset:50048
    s_add_u32 m0, s98, 0
    s_nop 0
    buffer_load_dwordx4 v3, s[80:83], s90 offen  lds
    s_add_u32 s90, s90, s94
    v_mfma_f32_32x32x16_bf16 v[212:227], v[56:59], v[60:63], v[212:227]
    ds_read_b64_tr_b16 v[104:105], v230 offset:48128
    ds_read_b64_tr_b16 v[106:107], v230 offset:49920
    s_waitcnt vmcnt(6) lgkmcnt(10)
    v_mfma_f32_32x32x16_bf16 v[116:131], v[68:71], v[84:87], v[116:131]
    s_barrier
    ds_read_b128 v[36:39], v232 offset:16384
    v_mfma_f32_32x32x16_bf16 v[132:147], v[68:71], v[88:91], v[132:147]
    ds_read_b64_tr_b16 v[20:21], v229 offset:0
    v_mfma_f32_32x32x16_bf16 v[148:163], v[72:75], v[84:87], v[148:163]
    ds_read_b64_tr_b16 v[22:23], v229 offset:1792
    ds_read_b128 v[40:43], v236 offset:16384
    v_mfma_f32_32x32x16_bf16 v[164:179], v[72:75], v[88:91], v[164:179]
    ds_read_b64_tr_b16 v[24:25], v229 offset:64
    v_mfma_f32_32x32x16_bf16 v[180:195], v[76:79], v[84:87], v[180:195]
    ds_read_b64_tr_b16 v[26:27], v229 offset:1856
    ds_read_b64_tr_b16 v[28:29], v229 offset:128
    s_add_u32 m0, s96, 20480
    s_nop 0
    buffer_load_dwordx4 v1, s[72:75], s88 offen  lds
    s_add_u32 s88, s88, s92
    v_mfma_f32_32x32x16_bf16 v[196:211], v[76:79], v[88:91], v[196:211]
    ds_read_b64_tr_b16 v[30:31], v229 offset:1920
    v_mfma_f32_32x32x16_bf16 v[212:227], v[80:83], v[84:87], v[212:227]
    ds_read_b64_tr_b16 v[32:33], v231 offset:0
    ds_read_b64_tr_b16 v[34:35], v231 offset:1792
    s_waitcnt lgkmcnt(10)
    v_mfma_f32_32x32x16_bf16 v[116:131], v[92:95], v[108:111], v[116:131]
    ds_read_b128 v[60:63], v233 offset:16384
    v_mfma_f32_32x32x16_bf16 v[132:147], v[92:95], v[112:115], v[132:147]
    ds_read_b64_tr_b16 v[44:45], v229 offset:7168
    s_add_u32 m0, s97, 20480
    s_nop 0
    buffer_load_dwordx4 v2, s[76:79], s89 offen  lds
    s_add_u32 s89, s89, s93
    v_mfma_f32_32x32x16_bf16 v[148:163], v[96:99], v[108:111], v[148:163]
    ds_read_b64_tr_b16 v[46:47], v229 offset:8960
    ds_read_b128 v[64:67], v237 offset:16384
    v_mfma_f32_32x32x16_bf16 v[164:179], v[96:99], v[112:115], v[164:179]
    ds_read_b64_tr_b16 v[48:49], v229 offset:7232
    v_mfma_f32_32x32x16_bf16 v[180:195], v[100:103], v[108:111], v[180:195]
    ds_read_b64_tr_b16 v[50:51], v229 offset:9024
    ds_read_b64_tr_b16 v[52:53], v229 offset:7296
    v_mfma_f32_32x32x16_bf16 v[196:211], v[100:103], v[112:115], v[196:211]
    ds_read_b64_tr_b16 v[54:55], v229 offset:9088
    s_add_u32 m0, s98, 20480
    s_nop 0
    buffer_load_dwordx4 v3, s[80:83], s90 offen  lds
    s_add_u32 s90, s90, s94
    v_mfma_f32_32x32x16_bf16 v[212:227], v[104:107], v[108:111], v[212:227]
    ds_read_b64_tr_b16 v[56:57], v231 offset:7168
    ds_read_b64_tr_b16 v[58:59], v231 offset:8960
    s_waitcnt vmcnt(6) lgkmcnt(10)
    v_mfma_f32_32x32x16_bf16 v[116:131], v[20:23], v[36:39], v[116:131]
    s_barrier
    ds_read_b128 v[84:87], v234 offset:16384
    v_mfma_f32_32x32x16_bf16 v[132:147], v[20:23], v[40:43], v[132:147]
    ds_read_b64_tr_b16 v[68:69], v229 offset:20480
    v_mfma_f32_32x32x16_bf16 v[148:163], v[24:27], v[36:39], v[148:163]
    ds_read_b64_tr_b16 v[70:71], v229 offset:22272
    ds_read_b128 v[88:91], v238 offset:16384
    v_mfma_f32_32x32x16_bf16 v[164:179], v[24:27], v[40:43], v[164:179]
    ds_read_b64_tr_b16 v[72:73], v229 offset:20544
    s_mov_b32 s28, s52
    s_and_b32 s29, s53, 0xffff
    s_mov_b32 s30, 0x700000
    s_mov_b32 s31, 0x00020000
    s_lshl_b32 s13, s2, 2
    s_add_u32 s13, s13, s6
    s_mul_i32 s13, s13, 7168
    v_mfma_f32_32x32x16_bf16 v[180:195], v[28:31], v[36:39], v[180:195]
    ds_read_b64_tr_b16 v[74:75], v229 offset:22336
    ds_read_b64_tr_b16 v[76:77], v229 offset:20608
    s_add_u32 m0, s96, 40960
    s_nop 0
    buffer_load_dwordx4 v1, s[72:75], s88 offen  lds
    s_add_u32 s88, s88, s92
    v_mfma_f32_32x32x16_bf16 v[196:211], v[28:31], v[40:43], v[196:211]
    ds_read_b64_tr_b16 v[78:79], v229 offset:22400
    v_mfma_f32_32x32x16_bf16 v[212:227], v[32:35], v[36:39], v[212:227]
    ds_read_b64_tr_b16 v[80:81], v231 offset:20480
    ds_read_b64_tr_b16 v[82:83], v231 offset:22272
    buffer_load_dwordx4 v[244:247], v5, s[28:31], s13 offen
    s_add_u32 s13, s13, 1024
    s_waitcnt lgkmcnt(10)
    v_mfma_f32_32x32x16_bf16 v[116:131], v[44:47], v[60:63], v[116:131]
    ds_read_b128 v[108:111], v235 offset:16384
    v_mfma_f32_32x32x16_bf16 v[132:147], v[44:47], v[64:67], v[132:147]
    ds_read_b64_tr_b16 v[92:93], v229 offset:27648
    s_add_u32 m0, s97, 40960
    s_nop 0
    buffer_load_dwordx4 v2, s[76:79], s89 offen  lds
    s_add_u32 s89, s89, s93
    v_mfma_f32_32x32x16_bf16 v[148:163], v[48:51], v[60:63], v[148:163]
    ds_read_b64_tr_b16 v[94:95], v229 offset:29440
    ds_read_b128 v[112:115], v239 offset:16384
    v_mfma_f32_32x32x16_bf16 v[164:179], v[48:51], v[64:67], v[164:179]
    ds_read_b64_tr_b16 v[96:97], v229 offset:27712
    v_mfma_f32_32x32x16_bf16 v[180:195], v[52:55], v[60:63], v[180:195]
    ds_read_b64_tr_b16 v[98:99], v229 offset:29504
    ds_read_b64_tr_b16 v[100:101], v229 offset:27776
    v_mfma_f32_32x32x16_bf16 v[196:211], v[52:55], v[64:67], v[196:211]
    ds_read_b64_tr_b16 v[102:103], v229 offset:29568
    s_add_u32 m0, s98, 40960
    s_nop 0
    buffer_load_dwordx4 v3, s[80:83], s90 offen  lds
    s_add_u32 s90, s90, s94
    v_mfma_f32_32x32x16_bf16 v[212:227], v[56:59], v[60:63], v[212:227]
    ds_read_b64_tr_b16 v[104:105], v231 offset:27648
    ds_read_b64_tr_b16 v[106:107], v231 offset:29440
    s_waitcnt vmcnt(7) lgkmcnt(10)
    v_mfma_f32_32x32x16_bf16 v[116:131], v[68:71], v[84:87], v[116:131]
    s_barrier
    ds_read_b128 v[36:39], v232 offset:32768
    v_mfma_f32_32x32x16_bf16 v[132:147], v[68:71], v[88:91], v[132:147]
    ds_read_b64_tr_b16 v[20:21], v228 offset:0
    v_mfma_f32_32x32x16_bf16 v[148:163], v[72:75], v[84:87], v[148:163]
    ds_read_b64_tr_b16 v[22:23], v228 offset:1792
    ds_read_b128 v[40:43], v236 offset:32768
    v_mfma_f32_32x32x16_bf16 v[164:179], v[72:75], v[88:91], v[164:179]
    ds_read_b64_tr_b16 v[24:25], v228 offset:64
    v_mfma_f32_32x32x16_bf16 v[180:195], v[76:79], v[84:87], v[180:195]
    ds_read_b64_tr_b16 v[26:27], v228 offset:1856
    ds_read_b64_tr_b16 v[28:29], v228 offset:128
    s_add_u32 m0, s96, 61440
    s_nop 0
    buffer_load_dwordx4 v1, s[72:75], s88 offen  lds
    s_add_u32 s88, s88, s92
    v_mfma_f32_32x32x16_bf16 v[196:211], v[76:79], v[88:91], v[196:211]
    ds_read_b64_tr_b16 v[30:31], v228 offset:1920
    v_mfma_f32_32x32x16_bf16 v[212:227], v[80:83], v[84:87], v[212:227]
    ds_read_b64_tr_b16 v[32:33], v230 offset:0
    ds_read_b64_tr_b16 v[34:35], v230 offset:1792
    s_waitcnt lgkmcnt(10)
    v_mfma_f32_32x32x16_bf16 v[116:131], v[92:95], v[108:111], v[116:131]
    ds_read_b128 v[60:63], v233 offset:32768
    v_mfma_f32_32x32x16_bf16 v[132:147], v[92:95], v[112:115], v[132:147]
    ds_read_b64_tr_b16 v[44:45], v228 offset:7168
    s_add_u32 m0, s97, 61440
    s_nop 0
    buffer_load_dwordx4 v2, s[76:79], s89 offen  lds
    s_add_u32 s89, s89, s93
    v_mfma_f32_32x32x16_bf16 v[148:163], v[96:99], v[108:111], v[148:163]
    ds_read_b64_tr_b16 v[46:47], v228 offset:8960
    ds_read_b128 v[64:67], v237 offset:32768
    v_mfma_f32_32x32x16_bf16 v[164:179], v[96:99], v[112:115], v[164:179]
    ds_read_b64_tr_b16 v[48:49], v228 offset:7232
    v_mfma_f32_32x32x16_bf16 v[180:195], v[100:103], v[108:111], v[180:195]
    ds_read_b64_tr_b16 v[50:51], v228 offset:9024
    ds_read_b64_tr_b16 v[52:53], v228 offset:7296
    v_mfma_f32_32x32x16_bf16 v[196:211], v[100:103], v[112:115], v[196:211]
    ds_read_b64_tr_b16 v[54:55], v228 offset:9088
    s_add_u32 m0, s98, 61440
    s_nop 0
    buffer_load_dwordx4 v3, s[80:83], s90 offen  lds
    s_add_u32 s90, s90, s94
    v_mfma_f32_32x32x16_bf16 v[212:227], v[104:107], v[108:111], v[212:227]
    ds_read_b64_tr_b16 v[56:57], v230 offset:7168
    ds_read_b64_tr_b16 v[58:59], v230 offset:8960
    s_waitcnt vmcnt(7) lgkmcnt(10)
    v_mfma_f32_32x32x16_bf16 v[116:131], v[20:23], v[36:39], v[116:131]
    s_barrier
    ds_read_b128 v[84:87], v234 offset:32768
    v_mfma_f32_32x32x16_bf16 v[132:147], v[20:23], v[40:43], v[132:147]
    ds_read_b64_tr_b16 v[68:69], v228 offset:20480
    v_mfma_f32_32x32x16_bf16 v[148:163], v[24:27], v[36:39], v[148:163]
    ds_read_b64_tr_b16 v[70:71], v228 offset:22272
    ds_read_b128 v[88:91], v238 offset:32768
    v_mfma_f32_32x32x16_bf16 v[164:179], v[24:27], v[40:43], v[164:179]
    ds_read_b64_tr_b16 v[72:73], v228 offset:20544
    v_mfma_f32_32x32x16_bf16 v[180:195], v[28:31], v[36:39], v[180:195]
    ds_read_b64_tr_b16 v[74:75], v228 offset:22336
    ds_read_b64_tr_b16 v[76:77], v228 offset:20608
    s_add_u32 m0, s96, 81920
    s_nop 0
    buffer_load_dwordx4 v1, s[72:75], s88 offen  lds
    s_add_u32 s88, s88, s92
    v_mfma_f32_32x32x16_bf16 v[196:211], v[28:31], v[40:43], v[196:211]
    ds_read_b64_tr_b16 v[78:79], v228 offset:22400
    v_mfma_f32_32x32x16_bf16 v[212:227], v[32:35], v[36:39], v[212:227]
    ds_read_b64_tr_b16 v[80:81], v230 offset:20480
    ds_read_b64_tr_b16 v[82:83], v230 offset:22272
    buffer_load_dwordx4 v[244:247], v5, s[28:31], s13 offen
    s_add_u32 s13, s13, 1024
    s_waitcnt lgkmcnt(10)
    v_mfma_f32_32x32x16_bf16 v[116:131], v[44:47], v[60:63], v[116:131]
    ds_read_b128 v[108:111], v235 offset:32768
    v_mfma_f32_32x32x16_bf16 v[132:147], v[44:47], v[64:67], v[132:147]
    ds_read_b64_tr_b16 v[92:93], v228 offset:27648
    s_add_u32 m0, s97, 81920
    s_nop 0
    buffer_load_dwordx4 v2, s[76:79], s89 offen  lds
    s_add_u32 s89, s89, s93
    v_mfma_f32_32x32x16_bf16 v[148:163], v[48:51], v[60:63], v[148:163]
    ds_read_b64_tr_b16 v[94:95], v228 offset:29440
    ds_read_b128 v[112:115], v239 offset:32768
    v_mfma_f32_32x32x16_bf16 v[164:179], v[48:51], v[64:67], v[164:179]
    ds_read_b64_tr_b16 v[96:97], v228 offset:27712
    v_mfma_f32_32x32x16_bf16 v[180:195], v[52:55], v[60:63], v[180:195]
    ds_read_b64_tr_b16 v[98:99], v228 offset:29504
    ds_read_b64_tr_b16 v[100:101], v228 offset:27776
    v_mfma_f32_32x32x16_bf16 v[196:211], v[52:55], v[64:67], v[196:211]
    ds_read_b64_tr_b16 v[102:103], v228 offset:29568
    s_add_u32 m0, s98, 81920
    s_nop 0
    buffer_load_dwordx4 v3, s[80:83], s90 offen  lds
    s_add_u32 s90, s90, s94
    v_mfma_f32_32x32x16_bf16 v[212:227], v[56:59], v[60:63], v[212:227]
    ds_read_b64_tr_b16 v[104:105], v230 offset:27648
    ds_read_b64_tr_b16 v[106:107], v230 offset:29440
    s_waitcnt vmcnt(7) lgkmcnt(10)
    v_mfma_f32_32x32x16_bf16 v[116:131], v[68:71], v[84:87], v[116:131]
    s_barrier
    ds_read_b128 v[36:39], v232 offset:0
    v_mfma_f32_32x32x16_bf16 v[132:147], v[68:71], v[88:91], v[132:147]
    ds_read_b64_tr_b16 v[20:21], v228 offset:40960
    v_mfma_f32_32x32x16_bf16 v[148:163], v[72:75], v[84:87], v[148:163]
    ds_read_b64_tr_b16 v[22:23], v228 offset:42752
    ds_read_b128 v[40:43], v236 offset:0
    v_mfma_f32_32x32x16_bf16 v[164:179], v[72:75], v[88:91], v[164:179]
    ds_read_b64_tr_b16 v[24:25], v228 offset:41024
    v_mfma_f32_32x32x16_bf16 v[180:195], v[76:79], v[84:87], v[180:195]
    ds_read_b64_tr_b16 v[26:27], v228 offset:42816
    ds_read_b64_tr_b16 v[28:29], v228 offset:41088
    s_add_u32 m0, s96, 0
    s_nop 0
    buffer_load_dwordx4 v1, s[72:75], s88 offen  lds
    s_add_u32 s88, s88, s92
    v_mfma_f32_32x32x16_bf16 v[196:211], v[76:79], v[88:91], v[196:211]
    ds_read_b64_tr_b16 v[30:31], v228 offset:42880
    v_mfma_f32_32x32x16_bf16 v[212:227], v[80:83], v[84:87], v[212:227]
    ds_read_b64_tr_b16 v[32:33], v230 offset:40960
    ds_read_b64_tr_b16 v[34:35], v230 offset:42752
    s_waitcnt lgkmcnt(10)
    v_mfma_f32_32x32x16_bf16 v[116:131], v[92:95], v[108:111], v[116:131]
    ds_read_b128 v[60:63], v233 offset:0
    v_mfma_f32_32x32x16_bf16 v[132:147], v[92:95], v[112:115], v[132:147]
    ds_read_b64_tr_b16 v[44:45], v228 offset:48128
    s_add_u32 m0, s97, 0
    s_nop 0
    buffer_load_dwordx4 v2, s[76:79], s89 offen  lds
    s_add_u32 s89, s89, s93
    v_mfma_f32_32x32x16_bf16 v[148:163], v[96:99], v[108:111], v[148:163]
    ds_read_b64_tr_b16 v[46:47], v228 offset:49920
    ds_read_b128 v[64:67], v237 offset:0
    v_mfma_f32_32x32x16_bf16 v[164:179], v[96:99], v[112:115], v[164:179]
    ds_read_b64_tr_b16 v[48:49], v228 offset:48192
    v_mfma_f32_32x32x16_bf16 v[180:195], v[100:103], v[108:111], v[180:195]
    ds_read_b64_tr_b16 v[50:51], v228 offset:49984
    ds_read_b64_tr_b16 v[52:53], v228 offset:48256
    v_mfma_f32_32x32x16_bf16 v[196:211], v[100:103], v[112:115], v[196:211]
    ds_read_b64_tr_b16 v[54:55], v228 offset:50048
    s_add_u32 m0, s98, 0
    s_nop 0
    buffer_load_dwordx4 v3, s[80:83], s90 offen  lds
    s_add_u32 s90, s90, s94
    v_mfma_f32_32x32x16_bf16 v[212:227], v[104:107], v[108:111], v[212:227]
    ds_read_b64_tr_b16 v[56:57], v230 offset:48128
    ds_read_b64_tr_b16 v[58:59], v230 offset:49920
    s_waitcnt vmcnt(7) lgkmcnt(10)
    v_mfma_f32_32x32x16_bf16 v[116:131], v[20:23], v[36:39], v[116:131]
    s_barrier
    ds_read_b128 v[84:87], v234 offset:0
    v_mfma_f32_32x32x16_bf16 v[132:147], v[20:23], v[40:43], v[132:147]
    ds_read_b64_tr_b16 v[68:69], v229 offset:0
    v_mfma_f32_32x32x16_bf16 v[148:163], v[24:27], v[36:39], v[148:163]
    ds_read_b64_tr_b16 v[70:71], v229 offset:1792
    ds_read_b128 v[88:91], v238 offset:0
    v_mfma_f32_32x32x16_bf16 v[164:179], v[24:27], v[40:43], v[164:179]
    ds_read_b64_tr_b16 v[72:73], v229 offset:64
    v_mfma_f32_32x32x16_bf16 v[180:195], v[28:31], v[36:39], v[180:195]
    ds_read_b64_tr_b16 v[74:75], v229 offset:1856
    ds_read_b64_tr_b16 v[76:77], v229 offset:128
    s_add_u32 m0, s96, 20480
    s_nop 0
    buffer_load_dwordx4 v1, s[72:75], s88 offen  lds
    s_add_u32 s88, s88, s92
    v_mfma_f32_32x32x16_bf16 v[196:211], v[28:31], v[40:43], v[196:211]
    ds_read_b64_tr_b16 v[78:79], v229 offset:1920
    v_mfma_f32_32x32x16_bf16 v[212:227], v[32:35], v[36:39], v[212:227]
    ds_read_b64_tr_b16 v[80:81], v231 offset:0
    ds_read_b64_tr_b16 v[82:83], v231 offset:1792
    buffer_load_dwordx4 v[244:247], v5, s[28:31], s13 offen
    s_add_u32 s13, s13, 1024
    s_waitcnt lgkmcnt(10)
    v_mfma_f32_32x32x16_bf16 v[116:131], v[44:47], v[60:63], v[116:131]
    ds_read_b128 v[108:111], v235 offset:0
    v_mfma_f32_32x32x16_bf16 v[132:147], v[44:47], v[64:67], v[132:147]
    ds_read_b64_tr_b16 v[92:93], v229 offset:7168
    s_add_u32 m0, s97, 20480
    s_nop 0
    buffer_load_dwordx4 v2, s[76:79], s89 offen  lds
    s_add_u32 s89, s89, s93
    v_mfma_f32_32x32x16_bf16 v[148:163], v[48:51], v[60:63], v[148:163]
    ds_read_b64_tr_b16 v[94:95], v229 offset:8960
    ds_read_b128 v[112:115], v239 offset:0
    v_mfma_f32_32x32x16_bf16 v[164:179], v[48:51], v[64:67], v[164:179]
    ds_read_b64_tr_b16 v[96:97], v229 offset:7232
    v_mfma_f32_32x32x16_bf16 v[180:195], v[52:55], v[60:63], v[180:195]
    ds_read_b64_tr_b16 v[98:99], v229 offset:9024
    ds_read_b64_tr_b16 v[100:101], v229 offset:7296
    v_mfma_f32_32x32x16_bf16 v[196:211], v[52:55], v[64:67], v[196:211]
    ds_read_b64_tr_b16 v[102:103], v229 offset:9088
    s_add_u32 m0, s98, 20480
    s_nop 0
    buffer_load_dwordx4 v3, s[80:83], s90 offen  lds
    s_add_u32 s90, s90, s94
    v_mfma_f32_32x32x16_bf16 v[212:227], v[56:59], v[60:63], v[212:227]
    ds_read_b64_tr_b16 v[104:105], v231 offset:7168
    ds_read_b64_tr_b16 v[106:107], v231 offset:8960
    s_waitcnt vmcnt(7) lgkmcnt(10)
    v_mfma_f32_32x32x16_bf16 v[116:131], v[68:71], v[84:87], v[116:131]
    s_barrier
    ds_read_b128 v[36:39], v232 offset:16384
    v_mfma_f32_32x32x16_bf16 v[132:147], v[68:71], v[88:91], v[132:147]
    ds_read_b64_tr_b16 v[20:21], v229 offset:20480
    v_mfma_f32_32x32x16_bf16 v[148:163], v[72:75], v[84:87], v[148:163]
    ds_read_b64_tr_b16 v[22:23], v229 offset:22272
    ds_read_b128 v[40:43], v236 offset:16384
    v_mfma_f32_32x32x16_bf16 v[164:179], v[72:75], v[88:91], v[164:179]
    ds_read_b64_tr_b16 v[24:25], v229 offset:20544
    v_mfma_f32_32x32x16_bf16 v[180:195], v[76:79], v[84:87], v[180:195]
    ds_read_b64_tr_b16 v[26:27], v229 offset:22336
    ds_read_b64_tr_b16 v[28:29], v229 offset:20608
    s_add_u32 m0, s96, 40960
    s_nop 0
    buffer_load_dwordx4 v1, s[72:75], s88 offen  lds
    s_add_u32 s88, s88, s92
    v_mfma_f32_32x32x16_bf16 v[196:211], v[76:79], v[88:91], v[196:211]
    ds_read_b64_tr_b16 v[30:31], v229 offset:22400
    v_mfma_f32_32x32x16_bf16 v[212:227], v[80:83], v[84:87], v[212:227]
    ds_read_b64_tr_b16 v[32:33], v231 offset:20480
    ds_read_b64_tr_b16 v[34:35], v231 offset:22272
    s_waitcnt lgkmcnt(10)
    v_mfma_f32_32x32x16_bf16 v[116:131], v[92:95], v[108:111], v[116:131]
    ds_read_b128 v[60:63], v233 offset:16384
    v_mfma_f32_32x32x16_bf16 v[132:147], v[92:95], v[112:115], v[132:147]
    ds_read_b64_tr_b16 v[44:45], v229 offset:27648
    s_add_u32 m0, s97, 40960
    s_nop 0
    buffer_load_dwordx4 v2, s[76:79], s89 offen  lds
    s_add_u32 s89, s89, s93
    v_mfma_f32_32x32x16_bf16 v[148:163], v[96:99], v[108:111], v[148:163]
    ds_read_b64_tr_b16 v[46:47], v229 offset:29440
    ds_read_b128 v[64:67], v237 offset:16384
    v_mfma_f32_32x32x16_bf16 v[164:179], v[96:99], v[112:115], v[164:179]
    ds_read_b64_tr_b16 v[48:49], v229 offset:27712
    v_mfma_f32_32x32x16_bf16 v[180:195], v[100:103], v[108:111], v[180:195]
    ds_read_b64_tr_b16 v[50:51], v229 offset:29504
    ds_read_b64_tr_b16 v[52:53], v229 offset:27776
    v_mfma_f32_32x32x16_bf16 v[196:211], v[100:103], v[112:115], v[196:211]
    ds_read_b64_tr_b16 v[54:55], v229 offset:29568
    s_add_u32 m0, s98, 40960
    s_nop 0
    buffer_load_dwordx4 v3, s[80:83], s90 offen  lds
    s_add_u32 s90, s90, s94
    v_mfma_f32_32x32x16_bf16 v[212:227], v[104:107], v[108:111], v[212:227]
    ds_read_b64_tr_b16 v[56:57], v231 offset:27648
    ds_read_b64_tr_b16 v[58:59], v231 offset:29440
    s_waitcnt vmcnt(7) lgkmcnt(10)
    v_mfma_f32_32x32x16_bf16 v[116:131], v[20:23], v[36:39], v[116:131]
    s_barrier
    ds_read_b128 v[84:87], v234 offset:16384
    v_mfma_f32_32x32x16_bf16 v[132:147], v[20:23], v[40:43], v[132:147]
    ds_read_b64_tr_b16 v[68:69], v228 offset:0
    v_mfma_f32_32x32x16_bf16 v[148:163], v[24:27], v[36:39], v[148:163]
    ds_read_b64_tr_b16 v[70:71], v228 offset:1792
    ds_read_b128 v[88:91], v238 offset:16384
    v_mfma_f32_32x32x16_bf16 v[164:179], v[24:27], v[40:43], v[164:179]
    ds_read_b64_tr_b16 v[72:73], v228 offset:64
    v_mfma_f32_32x32x16_bf16 v[180:195], v[28:31], v[36:39], v[180:195]
    ds_read_b64_tr_b16 v[74:75], v228 offset:1856
    ds_read_b64_tr_b16 v[76:77], v228 offset:128
    s_add_u32 m0, s96, 61440
    s_nop 0
    buffer_load_dwordx4 v1, s[72:75], s88 offen  lds
    s_add_u32 s88, s88, s92
    v_mfma_f32_32x32x16_bf16 v[196:211], v[28:31], v[40:43], v[196:211]
    ds_read_b64_tr_b16 v[78:79], v228 offset:1920
    v_mfma_f32_32x32x16_bf16 v[212:227], v[32:35], v[36:39], v[212:227]
    ds_read_b64_tr_b16 v[80:81], v230 offset:0
    ds_read_b64_tr_b16 v[82:83], v230 offset:1792
    buffer_load_dwordx4 v[244:247], v5, s[28:31], s13 offen
    s_add_u32 s13, s13, 1024
    s_waitcnt lgkmcnt(10)
    v_mfma_f32_32x32x16_bf16 v[116:131], v[44:47], v[60:63], v[116:131]
    ds_read_b128 v[108:111], v235 offset:16384
    v_mfma_f32_32x32x16_bf16 v[132:147], v[44:47], v[64:67], v[132:147]
    ds_read_b64_tr_b16 v[92:93], v228 offset:7168
    s_add_u32 m0, s97, 61440
    s_nop 0
    buffer_load_dwordx4 v2, s[76:79], s89 offen  lds
    s_add_u32 s89, s89, s93
    v_mfma_f32_32x32x16_bf16 v[148:163], v[48:51], v[60:63], v[148:163]
    ds_read_b64_tr_b16 v[94:95], v228 offset:8960
    ds_read_b128 v[112:115], v239 offset:16384
    v_mfma_f32_32x32x16_bf16 v[164:179], v[48:51], v[64:67], v[164:179]
    ds_read_b64_tr_b16 v[96:97], v228 offset:7232
    v_mfma_f32_32x32x16_bf16 v[180:195], v[52:55], v[60:63], v[180:195]
    ds_read_b64_tr_b16 v[98:99], v228 offset:9024
    ds_read_b64_tr_b16 v[100:101], v228 offset:7296
    v_mfma_f32_32x32x16_bf16 v[196:211], v[52:55], v[64:67], v[196:211]
    ds_read_b64_tr_b16 v[102:103], v228 offset:9088
    s_add_u32 m0, s98, 61440
    s_nop 0
    buffer_load_dwordx4 v3, s[80:83], s90 offen  lds
    s_add_u32 s90, s90, s94
    v_mfma_f32_32x32x16_bf16 v[212:227], v[56:59], v[60:63], v[212:227]
    ds_read_b64_tr_b16 v[104:105], v230 offset:7168
    ds_read_b64_tr_b16 v[106:107], v230 offset:8960
    s_waitcnt vmcnt(7) lgkmcnt(10)
    v_mfma_f32_32x32x16_bf16 v[116:131], v[68:71], v[84:87], v[116:131]
    s_barrier
    ds_read_b128 v[36:39], v232 offset:32768
    v_mfma_f32_32x32x16_bf16 v[132:147], v[68:71], v[88:91], v[132:147]
    ds_read_b64_tr_b16 v[20:21], v228 offset:20480
    v_mfma_f32_32x32x16_bf16 v[148:163], v[72:75], v[84:87], v[148:163]
    ds_read_b64_tr_b16 v[22:23], v228 offset:22272
    ds_read_b128 v[40:43], v236 offset:32768
    v_mfma_f32_32x32x16_bf16 v[164:179], v[72:75], v[88:91], v[164:179]
    ds_read_b64_tr_b16 v[24:25], v228 offset:20544
    v_mfma_f32_32x32x16_bf16 v[180:195], v[76:79], v[84:87], v[180:195]
    ds_read_b64_tr_b16 v[26:27], v228 offset:22336
    ds_read_b64_tr_b16 v[28:29], v228 offset:20608
    s_add_u32 m0, s96, 81920
    s_nop 0
    buffer_load_dwordx4 v1, s[72:75], s88 offen  lds
    s_add_u32 s88, s88, s92
    v_mfma_f32_32x32x16_bf16 v[196:211], v[76:79], v[88:91], v[196:211]
    ds_read_b64_tr_b16 v[30:31], v228 offset:22400
    v_mfma_f32_32x32x16_bf16 v[212:227], v[80:83], v[84:87], v[212:227]
    ds_read_b64_tr_b16 v[32:33], v230 offset:20480
    ds_read_b64_tr_b16 v[34:35], v230 offset:22272
    s_waitcnt lgkmcnt(10)
    v_mfma_f32_32x32x16_bf16 v[116:131], v[92:95], v[108:111], v[116:131]
    ds_read_b128 v[60:63], v233 offset:32768
    v_mfma_f32_32x32x16_bf16 v[132:147], v[92:95], v[112:115], v[132:147]
    ds_read_b64_tr_b16 v[44:45], v228 offset:27648
    s_add_u32 m0, s97, 81920
    s_nop 0
    buffer_load_dwordx4 v2, s[76:79], s89 offen  lds
    s_add_u32 s89, s89, s93
    v_mfma_f32_32x32x16_bf16 v[148:163], v[96:99], v[108:111], v[148:163]
    ds_read_b64_tr_b16 v[46:47], v228 offset:29440
    ds_read_b128 v[64:67], v237 offset:32768
    v_mfma_f32_32x32x16_bf16 v[164:179], v[96:99], v[112:115], v[164:179]
    ds_read_b64_tr_b16 v[48:49], v228 offset:27712
    v_mfma_f32_32x32x16_bf16 v[180:195], v[100:103], v[108:111], v[180:195]
    ds_read_b64_tr_b16 v[50:51], v228 offset:29504
    ds_read_b64_tr_b16 v[52:53], v228 offset:27776
    v_mfma_f32_32x32x16_bf16 v[196:211], v[100:103], v[112:115], v[196:211]
    ds_read_b64_tr_b16 v[54:55], v228 offset:29568
    s_add_u32 m0, s98, 81920
    s_nop 0
    buffer_load_dwordx4 v3, s[80:83], s90 offen  lds
    s_add_u32 s90, s90, s94
    v_mfma_f32_32x32x16_bf16 v[212:227], v[104:107], v[108:111], v[212:227]
    ds_read_b64_tr_b16 v[56:57], v230 offset:27648
    ds_read_b64_tr_b16 v[58:59], v230 offset:29440
    s_waitcnt vmcnt(7) lgkmcnt(10)
    v_mfma_f32_32x32x16_bf16 v[116:131], v[20:23], v[36:39], v[116:131]
    s_barrier
    ds_read_b128 v[84:87], v234 offset:32768
    v_mfma_f32_32x32x16_bf16 v[132:147], v[20:23], v[40:43], v[132:147]
    ds_read_b64_tr_b16 v[68:69], v228 offset:40960
    v_mfma_f32_32x32x16_bf16 v[148:163], v[24:27], v[36:39], v[148:163]
    ds_read_b64_tr_b16 v[70:71], v228 offset:42752
    ds_read_b128 v[88:91], v238 offset:32768
    v_mfma_f32_32x32x16_bf16 v[164:179], v[24:27], v[40:43], v[164:179]
    ds_read_b64_tr_b16 v[72:73], v228 offset:41024
    v_mfma_f32_32x32x16_bf16 v[180:195], v[28:31], v[36:39], v[180:195]
    ds_read_b64_tr_b16 v[74:75], v228 offset:42816
    ds_read_b64_tr_b16 v[76:77], v228 offset:41088
    s_add_u32 m0, s96, 0
    s_nop 0
    buffer_load_dwordx4 v1, s[72:75], s88 offen  lds
    s_add_u32 s88, s88, s92
    v_mfma_f32_32x32x16_bf16 v[196:211], v[28:31], v[40:43], v[196:211]
    ds_read_b64_tr_b16 v[78:79], v228 offset:42880
    v_mfma_f32_32x32x16_bf16 v[212:227], v[32:35], v[36:39], v[212:227]
    ds_read_b64_tr_b16 v[80:81], v230 offset:40960
    ds_read_b64_tr_b16 v[82:83], v230 offset:42752
    buffer_load_dwordx4 v[244:247], v5, s[28:31], s13 offen
    s_add_u32 s13, s13, 1024
    s_waitcnt lgkmcnt(10)
    v_mfma_f32_32x32x16_bf16 v[116:131], v[44:47], v[60:63], v[116:131]
    ds_read_b128 v[108:111], v235 offset:32768
    v_mfma_f32_32x32x16_bf16 v[132:147], v[44:47], v[64:67], v[132:147]
    ds_read_b64_tr_b16 v[92:93], v228 offset:48128
    s_add_u32 m0, s97, 0
    s_nop 0
    buffer_load_dwordx4 v2, s[76:79], s89 offen  lds
    s_add_u32 s89, s89, s93
    v_mfma_f32_32x32x16_bf16 v[148:163], v[48:51], v[60:63], v[148:163]
    ds_read_b64_tr_b16 v[94:95], v228 offset:49920
    ds_read_b128 v[112:115], v239 offset:32768
    v_mfma_f32_32x32x16_bf16 v[164:179], v[48:51], v[64:67], v[164:179]
    ds_read_b64_tr_b16 v[96:97], v228 offset:48192
    v_mfma_f32_32x32x16_bf16 v[180:195], v[52:55], v[60:63], v[180:195]
    ds_read_b64_tr_b16 v[98:99], v228 offset:49984
    ds_read_b64_tr_b16 v[100:101], v228 offset:48256
    v_mfma_f32_32x32x16_bf16 v[196:211], v[52:55], v[64:67], v[196:211]
    ds_read_b64_tr_b16 v[102:103], v228 offset:50048
    s_add_u32 m0, s98, 0
    s_nop 0
    buffer_load_dwordx4 v3, s[80:83], s90 offen  lds
    s_add_u32 s90, s90, s94
    v_mfma_f32_32x32x16_bf16 v[212:227], v[56:59], v[60:63], v[212:227]
    ds_read_b64_tr_b16 v[104:105], v230 offset:48128
    ds_read_b64_tr_b16 v[106:107], v230 offset:49920
    s_waitcnt vmcnt(7) lgkmcnt(10)
    v_mfma_f32_32x32x16_bf16 v[116:131], v[68:71], v[84:87], v[116:131]
    s_barrier
    ds_read_b128 v[36:39], v232 offset:0
    v_mfma_f32_32x32x16_bf16 v[132:147], v[68:71], v[88:91], v[132:147]
    ds_read_b64_tr_b16 v[20:21], v229 offset:0
    v_mfma_f32_32x32x16_bf16 v[148:163], v[72:75], v[84:87], v[148:163]
    ds_read_b64_tr_b16 v[22:23], v229 offset:1792
    ds_read_b128 v[40:43], v236 offset:0
    v_mfma_f32_32x32x16_bf16 v[164:179], v[72:75], v[88:91], v[164:179]
    ds_read_b64_tr_b16 v[24:25], v229 offset:64
    v_mfma_f32_32x32x16_bf16 v[180:195], v[76:79], v[84:87], v[180:195]
    ds_read_b64_tr_b16 v[26:27], v229 offset:1856
    ds_read_b64_tr_b16 v[28:29], v229 offset:128
    s_add_u32 m0, s96, 20480
    s_nop 0
    buffer_load_dwordx4 v1, s[72:75], s88 offen  lds
    s_add_u32 s88, s88, s92
    v_mfma_f32_32x32x16_bf16 v[196:211], v[76:79], v[88:91], v[196:211]
    ds_read_b64_tr_b16 v[30:31], v229 offset:1920
    v_mfma_f32_32x32x16_bf16 v[212:227], v[80:83], v[84:87], v[212:227]
    ds_read_b64_tr_b16 v[32:33], v231 offset:0
    ds_read_b64_tr_b16 v[34:35], v231 offset:1792
    s_waitcnt lgkmcnt(10)
    v_mfma_f32_32x32x16_bf16 v[116:131], v[92:95], v[108:111], v[116:131]
    ds_read_b128 v[60:63], v233 offset:0
    v_mfma_f32_32x32x16_bf16 v[132:147], v[92:95], v[112:115], v[132:147]
    ds_read_b64_tr_b16 v[44:45], v229 offset:7168
    s_add_u32 m0, s97, 20480
    s_nop 0
    buffer_load_dwordx4 v2, s[76:79], s89 offen  lds
    s_add_u32 s89, s89, s93
    v_mfma_f32_32x32x16_bf16 v[148:163], v[96:99], v[108:111], v[148:163]
    ds_read_b64_tr_b16 v[46:47], v229 offset:8960
    ds_read_b128 v[64:67], v237 offset:0
    v_mfma_f32_32x32x16_bf16 v[164:179], v[96:99], v[112:115], v[164:179]
    ds_read_b64_tr_b16 v[48:49], v229 offset:7232
    v_mfma_f32_32x32x16_bf16 v[180:195], v[100:103], v[108:111], v[180:195]
    ds_read_b64_tr_b16 v[50:51], v229 offset:9024
    ds_read_b64_tr_b16 v[52:53], v229 offset:7296
    v_mfma_f32_32x32x16_bf16 v[196:211], v[100:103], v[112:115], v[196:211]
    ds_read_b64_tr_b16 v[54:55], v229 offset:9088
    s_add_u32 m0, s98, 20480
    s_nop 0
    buffer_load_dwordx4 v3, s[80:83], s90 offen  lds
    s_add_u32 s90, s90, s94
    v_mfma_f32_32x32x16_bf16 v[212:227], v[104:107], v[108:111], v[212:227]
    ds_read_b64_tr_b16 v[56:57], v231 offset:7168
    ds_read_b64_tr_b16 v[58:59], v231 offset:8960
    s_waitcnt vmcnt(7) lgkmcnt(10)
    v_mfma_f32_32x32x16_bf16 v[116:131], v[20:23], v[36:39], v[116:131]
    s_barrier
    ds_read_b128 v[84:87], v234 offset:0
    v_mfma_f32_32x32x16_bf16 v[132:147], v[20:23], v[40:43], v[132:147]
    ds_read_b64_tr_b16 v[68:69], v229 offset:20480
    v_mfma_f32_32x32x16_bf16 v[148:163], v[24:27], v[36:39], v[148:163]
    ds_read_b64_tr_b16 v[70:71], v229 offset:22272
    ds_read_b128 v[88:91], v238 offset:0
    v_mfma_f32_32x32x16_bf16 v[164:179], v[24:27], v[40:43], v[164:179]
    ds_read_b64_tr_b16 v[72:73], v229 offset:20544
    v_mfma_f32_32x32x16_bf16 v[180:195], v[28:31], v[36:39], v[180:195]
    ds_read_b64_tr_b16 v[74:75], v229 offset:22336
    ds_read_b64_tr_b16 v[76:77], v229 offset:20608
    s_add_u32 m0, s96, 40960
    s_nop 0
    buffer_load_dwordx4 v1, s[72:75], s88 offen  lds
    s_add_u32 s88, s88, s92
    v_mfma_f32_32x32x16_bf16 v[196:211], v[28:31], v[40:43], v[196:211]
    ds_read_b64_tr_b16 v[78:79], v229 offset:22400
    v_mfma_f32_32x32x16_bf16 v[212:227], v[32:35], v[36:39], v[212:227]
    ds_read_b64_tr_b16 v[80:81], v231 offset:20480
    ds_read_b64_tr_b16 v[82:83], v231 offset:22272
    buffer_load_dwordx4 v[244:247], v5, s[28:31], s13 offen
    s_add_u32 s13, s13, 1024
    s_waitcnt lgkmcnt(10)
    v_mfma_f32_32x32x16_bf16 v[116:131], v[44:47], v[60:63], v[116:131]
    ds_read_b128 v[108:111], v235 offset:0
    v_mfma_f32_32x32x16_bf16 v[132:147], v[44:47], v[64:67], v[132:147]
    ds_read_b64_tr_b16 v[92:93], v229 offset:27648
    s_add_u32 m0, s97, 40960
    s_nop 0
    buffer_load_dwordx4 v2, s[76:79], s89 offen  lds
    s_add_u32 s89, s89, s93
    v_mfma_f32_32x32x16_bf16 v[148:163], v[48:51], v[60:63], v[148:163]
    ds_read_b64_tr_b16 v[94:95], v229 offset:29440
    ds_read_b128 v[112:115], v239 offset:0
    v_mfma_f32_32x32x16_bf16 v[164:179], v[48:51], v[64:67], v[164:179]
    ds_read_b64_tr_b16 v[96:97], v229 offset:27712
    v_mfma_f32_32x32x16_bf16 v[180:195], v[52:55], v[60:63], v[180:195]
    ds_read_b64_tr_b16 v[98:99], v229 offset:29504
    ds_read_b64_tr_b16 v[100:101], v229 offset:27776
    v_mfma_f32_32x32x16_bf16 v[196:211], v[52:55], v[64:67], v[196:211]
    ds_read_b64_tr_b16 v[102:103], v229 offset:29568
    s_add_u32 m0, s98, 40960
    s_nop 0
    buffer_load_dwordx4 v3, s[80:83], s90 offen  lds
    s_add_u32 s90, s90, s94
    v_mfma_f32_32x32x16_bf16 v[212:227], v[56:59], v[60:63], v[212:227]
    ds_read_b64_tr_b16 v[104:105], v231 offset:27648
    ds_read_b64_tr_b16 v[106:107], v231 offset:29440
    s_waitcnt vmcnt(7) lgkmcnt(10)
    v_mfma_f32_32x32x16_bf16 v[116:131], v[68:71], v[84:87], v[116:131]
    s_barrier
    ds_read_b128 v[36:39], v232 offset:16384
    v_mfma_f32_32x32x16_bf16 v[132:147], v[68:71], v[88:91], v[132:147]
    ds_read_b64_tr_b16 v[20:21], v228 offset:0
    v_mfma_f32_32x32x16_bf16 v[148:163], v[72:75], v[84:87], v[148:163]
    ds_read_b64_tr_b16 v[22:23], v228 offset:1792
    ds_read_b128 v[40:43], v236 offset:16384
    v_mfma_f32_32x32x16_bf16 v[164:179], v[72:75], v[88:91], v[164:179]
    ds_read_b64_tr_b16 v[24:25], v228 offset:64
    v_mfma_f32_32x32x16_bf16 v[180:195], v[76:79], v[84:87], v[180:195]
    ds_read_b64_tr_b16 v[26:27], v228 offset:1856
    ds_read_b64_tr_b16 v[28:29], v228 offset:128
    s_add_u32 m0, s96, 61440
    s_nop 0
    buffer_load_dwordx4 v1, s[72:75], s88 offen  lds
    s_add_u32 s88, s88, s92
    v_mfma_f32_32x32x16_bf16 v[196:211], v[76:79], v[88:91], v[196:211]
    ds_read_b64_tr_b16 v[30:31], v228 offset:1920
    v_mfma_f32_32x32x16_bf16 v[212:227], v[80:83], v[84:87], v[212:227]
    ds_read_b64_tr_b16 v[32:33], v230 offset:0
    ds_read_b64_tr_b16 v[34:35], v230 offset:1792
    s_waitcnt lgkmcnt(10)
    v_mfma_f32_32x32x16_bf16 v[116:131], v[92:95], v[108:111], v[116:131]
    ds_read_b128 v[60:63], v233 offset:16384
    v_mfma_f32_32x32x16_bf16 v[132:147], v[92:95], v[112:115], v[132:147]
    ds_read_b64_tr_b16 v[44:45], v228 offset:7168
    s_add_u32 m0, s97, 61440
    s_nop 0
    buffer_load_dwordx4 v2, s[76:79], s89 offen  lds
    s_add_u32 s89, s89, s93
    v_mfma_f32_32x32x16_bf16 v[148:163], v[96:99], v[108:111], v[148:163]
    ds_read_b64_tr_b16 v[46:47], v228 offset:8960
    ds_read_b128 v[64:67], v237 offset:16384
    v_mfma_f32_32x32x16_bf16 v[164:179], v[96:99], v[112:115], v[164:179]
    ds_read_b64_tr_b16 v[48:49], v228 offset:7232
    v_mfma_f32_32x32x16_bf16 v[180:195], v[100:103], v[108:111], v[180:195]
    ds_read_b64_tr_b16 v[50:51], v228 offset:9024
    ds_read_b64_tr_b16 v[52:53], v228 offset:7296
    v_mfma_f32_32x32x16_bf16 v[196:211], v[100:103], v[112:115], v[196:211]
    ds_read_b64_tr_b16 v[54:55], v228 offset:9088
    s_add_u32 m0, s98, 61440
    s_nop 0
    buffer_load_dwordx4 v3, s[80:83], s90 offen  lds
    s_add_u32 s90, s90, s94
    v_mfma_f32_32x32x16_bf16 v[212:227], v[104:107], v[108:111], v[212:227]
    ds_read_b64_tr_b16 v[56:57], v230 offset:7168
    ds_read_b64_tr_b16 v[58:59], v230 offset:8960
    s_waitcnt vmcnt(7) lgkmcnt(10)
    v_mfma_f32_32x32x16_bf16 v[116:131], v[20:23], v[36:39], v[116:131]
    s_barrier
    ds_read_b128 v[84:87], v234 offset:16384
    v_mfma_f32_32x32x16_bf16 v[132:147], v[20:23], v[40:43], v[132:147]
    ds_read_b64_tr_b16 v[68:69], v228 offset:20480
    v_mfma_f32_32x32x16_bf16 v[148:163], v[24:27], v[36:39], v[148:163]
    ds_read_b64_tr_b16 v[70:71], v228 offset:22272
    ds_read_b128 v[88:91], v238 offset:16384
    v_mfma_f32_32x32x16_bf16 v[164:179], v[24:27], v[40:43], v[164:179]
    ds_read_b64_tr_b16 v[72:73], v228 offset:20544
    v_mfma_f32_32x32x16_bf16 v[180:195], v[28:31], v[36:39], v[180:195]
    ds_read_b64_tr_b16 v[74:75], v228 offset:22336
    ds_read_b64_tr_b16 v[76:77], v228 offset:20608
    s_add_u32 m0, s96, 81920
    s_nop 0
    buffer_load_dwordx4 v1, s[72:75], s88 offen  lds
    s_add_u32 s88, s88, s92
    v_mfma_f32_32x32x16_bf16 v[196:211], v[28:31], v[40:43], v[196:211]
    ds_read_b64_tr_b16 v[78:79], v228 offset:22400
    v_mfma_f32_32x32x16_bf16 v[212:227], v[32:35], v[36:39], v[212:227]
    ds_read_b64_tr_b16 v[80:81], v230 offset:20480
    ds_read_b64_tr_b16 v[82:83], v230 offset:22272
    buffer_load_dwordx4 v[244:247], v5, s[28:31], s13 offen
    s_add_u32 s13, s13, 1024
    s_waitcnt lgkmcnt(10)
    v_mfma_f32_32x32x16_bf16 v[116:131], v[44:47], v[60:63], v[116:131]
    ds_read_b128 v[108:111], v235 offset:16384
    v_mfma_f32_32x32x16_bf16 v[132:147], v[44:47], v[64:67], v[132:147]
    ds_read_b64_tr_b16 v[92:93], v228 offset:27648
    s_add_u32 m0, s97, 81920
    s_nop 0
    buffer_load_dwordx4 v2, s[76:79], s89 offen  lds
    s_add_u32 s89, s89, s93
    v_mfma_f32_32x32x16_bf16 v[148:163], v[48:51], v[60:63], v[148:163]
    ds_read_b64_tr_b16 v[94:95], v228 offset:29440
    ds_read_b128 v[112:115], v239 offset:16384
    v_mfma_f32_32x32x16_bf16 v[164:179], v[48:51], v[64:67], v[164:179]
    ds_read_b64_tr_b16 v[96:97], v228 offset:27712
    v_mfma_f32_32x32x16_bf16 v[180:195], v[52:55], v[60:63], v[180:195]
    ds_read_b64_tr_b16 v[98:99], v228 offset:29504
    ds_read_b64_tr_b16 v[100:101], v228 offset:27776
    v_mfma_f32_32x32x16_bf16 v[196:211], v[52:55], v[64:67], v[196:211]
    ds_read_b64_tr_b16 v[102:103], v228 offset:29568
    s_add_u32 m0, s98, 81920
    s_nop 0
    buffer_load_dwordx4 v3, s[80:83], s90 offen  lds
    s_add_u32 s90, s90, s94
    v_mfma_f32_32x32x16_bf16 v[212:227], v[56:59], v[60:63], v[212:227]
    ds_read_b64_tr_b16 v[104:105], v230 offset:27648
    ds_read_b64_tr_b16 v[106:107], v230 offset:29440
    s_waitcnt vmcnt(7) lgkmcnt(10)
    v_mfma_f32_32x32x16_bf16 v[116:131], v[68:71], v[84:87], v[116:131]
    s_barrier
    ds_read_b128 v[36:39], v232 offset:32768
    v_mfma_f32_32x32x16_bf16 v[132:147], v[68:71], v[88:91], v[132:147]
    ds_read_b64_tr_b16 v[20:21], v228 offset:40960
    v_mfma_f32_32x32x16_bf16 v[148:163], v[72:75], v[84:87], v[148:163]
    ds_read_b64_tr_b16 v[22:23], v228 offset:42752
    ds_read_b128 v[40:43], v236 offset:32768
    v_mfma_f32_32x32x16_bf16 v[164:179], v[72:75], v[88:91], v[164:179]
    ds_read_b64_tr_b16 v[24:25], v228 offset:41024
    v_mfma_f32_32x32x16_bf16 v[180:195], v[76:79], v[84:87], v[180:195]
    ds_read_b64_tr_b16 v[26:27], v228 offset:42816
    ds_read_b64_tr_b16 v[28:29], v228 offset:41088
    s_add_u32 m0, s96, 0
    s_nop 0
    buffer_load_dwordx4 v1, s[72:75], s88 offen  lds
    s_add_u32 s88, s88, s92
    v_mfma_f32_32x32x16_bf16 v[196:211], v[76:79], v[88:91], v[196:211]
    ds_read_b64_tr_b16 v[30:31], v228 offset:42880
    v_mfma_f32_32x32x16_bf16 v[212:227], v[80:83], v[84:87], v[212:227]
    ds_read_b64_tr_b16 v[32:33], v230 offset:40960
    ds_read_b64_tr_b16 v[34:35], v230 offset:42752
    s_waitcnt lgkmcnt(10)
    v_mfma_f32_32x32x16_bf16 v[116:131], v[92:95], v[108:111], v[116:131]
    ds_read_b128 v[60:63], v233 offset:32768
    v_mfma_f32_32x32x16_bf16 v[132:147], v[92:95], v[112:115], v[132:147]
    ds_read_b64_tr_b16 v[44:45], v228 offset:48128
    s_add_u32 m0, s97, 0
    s_nop 0
    buffer_load_dwordx4 v2, s[76:79], s89 offen  lds
    s_add_u32 s89, s89, s93
    v_mfma_f32_32x32x16_bf16 v[148:163], v[96:99], v[108:111], v[148:163]
    ds_read_b64_tr_b16 v[46:47], v228 offset:49920
    ds_read_b128 v[64:67], v237 offset:32768
    v_mfma_f32_32x32x16_bf16 v[164:179], v[96:99], v[112:115], v[164:179]
    ds_read_b64_tr_b16 v[48:49], v228 offset:48192
    v_mfma_f32_32x32x16_bf16 v[180:195], v[100:103], v[108:111], v[180:195]
    ds_read_b64_tr_b16 v[50:51], v228 offset:49984
    ds_read_b64_tr_b16 v[52:53], v228 offset:48256
    v_mfma_f32_32x32x16_bf16 v[196:211], v[100:103], v[112:115], v[196:211]
    ds_read_b64_tr_b16 v[54:55], v228 offset:50048
    s_add_u32 m0, s98, 0
    s_nop 0
    buffer_load_dwordx4 v3, s[80:83], s90 offen  lds
    s_add_u32 s90, s90, s94
    v_mfma_f32_32x32x16_bf16 v[212:227], v[104:107], v[108:111], v[212:227]
    ds_read_b64_tr_b16 v[56:57], v230 offset:48128
    ds_read_b64_tr_b16 v[58:59], v230 offset:49920
    s_waitcnt vmcnt(7) lgkmcnt(10)
    v_mfma_f32_32x32x16_bf16 v[116:131], v[20:23], v[36:39], v[116:131]
    s_barrier
    ds_read_b128 v[84:87], v234 offset:32768
    v_mfma_f32_32x32x16_bf16 v[132:147], v[20:23], v[40:43], v[132:147]
    ds_read_b64_tr_b16 v[68:69], v229 offset:0
    v_mfma_f32_32x32x16_bf16 v[148:163], v[24:27], v[36:39], v[148:163]
    ds_read_b64_tr_b16 v[70:71], v229 offset:1792
    ds_read_b128 v[88:91], v238 offset:32768
    v_mfma_f32_32x32x16_bf16 v[164:179], v[24:27], v[40:43], v[164:179]
    ds_read_b64_tr_b16 v[72:73], v229 offset:64
    s_mov_b32 s28, s44
    s_and_b32 s29, s45, 0xffff
    s_mov_b32 s30, 0x200000
    s_mov_b32 s31, 0x00020000
    s_lshl_b32 s13, s2, 2
    s_add_u32 s13, s13, s6
    s_mul_i32 s13, s13, 2048
    v_mfma_f32_32x32x16_bf16 v[180:195], v[28:31], v[36:39], v[180:195]
    ds_read_b64_tr_b16 v[74:75], v229 offset:1856
    ds_read_b64_tr_b16 v[76:77], v229 offset:128
    s_add_u32 m0, s96, 20480
    s_nop 0
    buffer_load_dwordx4 v1, s[72:75], s88 offen  lds
    s_add_u32 s88, s88, s92
    v_mfma_f32_32x32x16_bf16 v[196:211], v[28:31], v[40:43], v[196:211]
    ds_read_b64_tr_b16 v[78:79], v229 offset:1920
    v_mfma_f32_32x32x16_bf16 v[212:227], v[32:35], v[36:39], v[212:227]
    ds_read_b64_tr_b16 v[80:81], v231 offset:0
    ds_read_b64_tr_b16 v[82:83], v231 offset:1792
    buffer_load_dwordx4 v[244:247], v5, s[28:31], s13 offen
    s_add_u32 s13, s13, 1024
    s_waitcnt lgkmcnt(10)
    v_mfma_f32_32x32x16_bf16 v[116:131], v[44:47], v[60:63], v[116:131]
    ds_read_b128 v[108:111], v235 offset:32768
    v_mfma_f32_32x32x16_bf16 v[132:147], v[44:47], v[64:67], v[132:147]
    ds_read_b64_tr_b16 v[92:93], v229 offset:7168
    s_add_u32 m0, s97, 20480
    s_nop 0
    buffer_load_dwordx4 v2, s[76:79], s89 offen  lds
    s_add_u32 s89, s89, s93
    v_mfma_f32_32x32x16_bf16 v[148:163], v[48:51], v[60:63], v[148:163]
    ds_read_b64_tr_b16 v[94:95], v229 offset:8960
    ds_read_b128 v[112:115], v239 offset:32768
    v_mfma_f32_32x32x16_bf16 v[164:179], v[48:51], v[64:67], v[164:179]
    ds_read_b64_tr_b16 v[96:97], v229 offset:7232
    v_mfma_f32_32x32x16_bf16 v[180:195], v[52:55], v[60:63], v[180:195]
    ds_read_b64_tr_b16 v[98:99], v229 offset:9024
    ds_read_b64_tr_b16 v[100:101], v229 offset:7296
    v_mfma_f32_32x32x16_bf16 v[196:211], v[52:55], v[64:67], v[196:211]
    ds_read_b64_tr_b16 v[102:103], v229 offset:9088
    s_add_u32 m0, s98, 20480
    s_nop 0
    buffer_load_dwordx4 v3, s[80:83], s90 offen  lds
    s_add_u32 s90, s90, s94
    v_mfma_f32_32x32x16_bf16 v[212:227], v[56:59], v[60:63], v[212:227]
    ds_read_b64_tr_b16 v[104:105], v231 offset:7168
    ds_read_b64_tr_b16 v[106:107], v231 offset:8960
    s_waitcnt vmcnt(7) lgkmcnt(10)
    v_mfma_f32_32x32x16_bf16 v[116:131], v[68:71], v[84:87], v[116:131]
    s_barrier
    ds_read_b128 v[36:39], v232 offset:0
    v_mfma_f32_32x32x16_bf16 v[132:147], v[68:71], v[88:91], v[132:147]
    ds_read_b64_tr_b16 v[20:21], v229 offset:20480
    v_mfma_f32_32x32x16_bf16 v[148:163], v[72:75], v[84:87], v[148:163]
    ds_read_b64_tr_b16 v[22:23], v229 offset:22272
    ds_read_b128 v[40:43], v236 offset:0
    v_mfma_f32_32x32x16_bf16 v[164:179], v[72:75], v[88:91], v[164:179]
    ds_read_b64_tr_b16 v[24:25], v229 offset:20544
    v_mfma_f32_32x32x16_bf16 v[180:195], v[76:79], v[84:87], v[180:195]
    ds_read_b64_tr_b16 v[26:27], v229 offset:22336
    ds_read_b64_tr_b16 v[28:29], v229 offset:20608
    s_add_u32 m0, s96, 40960
    s_nop 0
    buffer_load_dwordx4 v1, s[72:75], s88 offen  lds
    s_add_u32 s88, s88, s92
    v_mfma_f32_32x32x16_bf16 v[196:211], v[76:79], v[88:91], v[196:211]
    ds_read_b64_tr_b16 v[30:31], v229 offset:22400
    v_mfma_f32_32x32x16_bf16 v[212:227], v[80:83], v[84:87], v[212:227]
    ds_read_b64_tr_b16 v[32:33], v231 offset:20480
    ds_read_b64_tr_b16 v[34:35], v231 offset:22272
    s_waitcnt lgkmcnt(10)
    v_mfma_f32_32x32x16_bf16 v[116:131], v[92:95], v[108:111], v[116:131]
    ds_read_b128 v[60:63], v233 offset:0
    v_mfma_f32_32x32x16_bf16 v[132:147], v[92:95], v[112:115], v[132:147]
    ds_read_b64_tr_b16 v[44:45], v229 offset:27648
    s_add_u32 m0, s97, 40960
    s_nop 0
    buffer_load_dwordx4 v2, s[76:79], s89 offen  lds
    s_add_u32 s89, s89, s93
    v_mfma_f32_32x32x16_bf16 v[148:163], v[96:99], v[108:111], v[148:163]
    ds_read_b64_tr_b16 v[46:47], v229 offset:29440
    ds_read_b128 v[64:67], v237 offset:0
    v_mfma_f32_32x32x16_bf16 v[164:179], v[96:99], v[112:115], v[164:179]
    ds_read_b64_tr_b16 v[48:49], v229 offset:27712
    v_mfma_f32_32x32x16_bf16 v[180:195], v[100:103], v[108:111], v[180:195]
    ds_read_b64_tr_b16 v[50:51], v229 offset:29504
    ds_read_b64_tr_b16 v[52:53], v229 offset:27776
    v_mfma_f32_32x32x16_bf16 v[196:211], v[100:103], v[112:115], v[196:211]
    ds_read_b64_tr_b16 v[54:55], v229 offset:29568
    s_add_u32 m0, s98, 40960
    s_nop 0
    buffer_load_dwordx4 v3, s[80:83], s90 offen  lds
    s_add_u32 s90, s90, s94
    v_mfma_f32_32x32x16_bf16 v[212:227], v[104:107], v[108:111], v[212:227]
    ds_read_b64_tr_b16 v[56:57], v231 offset:27648
    ds_read_b64_tr_b16 v[58:59], v231 offset:29440
    s_waitcnt vmcnt(7) lgkmcnt(10)
    v_mfma_f32_32x32x16_bf16 v[116:131], v[20:23], v[36:39], v[116:131]
    s_barrier
    ds_read_b128 v[84:87], v234 offset:0
    v_mfma_f32_32x32x16_bf16 v[132:147], v[20:23], v[40:43], v[132:147]
    ds_read_b64_tr_b16 v[68:69], v228 offset:0
    v_mfma_f32_32x32x16_bf16 v[148:163], v[24:27], v[36:39], v[148:163]
    ds_read_b64_tr_b16 v[70:71], v228 offset:1792
    ds_read_b128 v[88:91], v238 offset:0
    v_mfma_f32_32x32x16_bf16 v[164:179], v[24:27], v[40:43], v[164:179]
    ds_read_b64_tr_b16 v[72:73], v228 offset:64
    v_mfma_f32_32x32x16_bf16 v[180:195], v[28:31], v[36:39], v[180:195]
    ds_read_b64_tr_b16 v[74:75], v228 offset:1856
    ds_read_b64_tr_b16 v[76:77], v228 offset:128
    s_add_u32 m0, s96, 61440
    s_nop 0
    buffer_load_dwordx4 v1, s[72:75], s88 offen  lds
    s_add_u32 s88, s88, s92
    v_mfma_f32_32x32x16_bf16 v[196:211], v[28:31], v[40:43], v[196:211]
    ds_read_b64_tr_b16 v[78:79], v228 offset:1920
    v_mfma_f32_32x32x16_bf16 v[212:227], v[32:35], v[36:39], v[212:227]
    ds_read_b64_tr_b16 v[80:81], v230 offset:0
    ds_read_b64_tr_b16 v[82:83], v230 offset:1792
    buffer_load_dwordx4 v[244:247], v5, s[28:31], s13 offen
    s_add_u32 s13, s13, 1024
    s_waitcnt lgkmcnt(10)
    v_mfma_f32_32x32x16_bf16 v[116:131], v[44:47], v[60:63], v[116:131]
    ds_read_b128 v[108:111], v235 offset:0
    v_mfma_f32_32x32x16_bf16 v[132:147], v[44:47], v[64:67], v[132:147]
    ds_read_b64_tr_b16 v[92:93], v228 offset:7168
    s_add_u32 m0, s97, 61440
    s_nop 0
    buffer_load_dwordx4 v2, s[76:79], s89 offen  lds
    s_add_u32 s89, s89, s93
    v_mfma_f32_32x32x16_bf16 v[148:163], v[48:51], v[60:63], v[148:163]
    ds_read_b64_tr_b16 v[94:95], v228 offset:8960
    ds_read_b128 v[112:115], v239 offset:0
    v_mfma_f32_32x32x16_bf16 v[164:179], v[48:51], v[64:67], v[164:179]
    ds_read_b64_tr_b16 v[96:97], v228 offset:7232
    v_mfma_f32_32x32x16_bf16 v[180:195], v[52:55], v[60:63], v[180:195]
    ds_read_b64_tr_b16 v[98:99], v228 offset:9024
    ds_read_b64_tr_b16 v[100:101], v228 offset:7296
    v_mfma_f32_32x32x16_bf16 v[196:211], v[52:55], v[64:67], v[196:211]
    ds_read_b64_tr_b16 v[102:103], v228 offset:9088
    s_add_u32 m0, s98, 61440
    s_nop 0
    buffer_load_dwordx4 v3, s[80:83], s90 offen  lds
    s_add_u32 s90, s90, s94
    v_mfma_f32_32x32x16_bf16 v[212:227], v[56:59], v[60:63], v[212:227]
    ds_read_b64_tr_b16 v[104:105], v230 offset:7168
    ds_read_b64_tr_b16 v[106:107], v230 offset:8960
    s_waitcnt vmcnt(7) lgkmcnt(10)
    v_mfma_f32_32x32x16_bf16 v[116:131], v[68:71], v[84:87], v[116:131]
    s_barrier
    ds_read_b128 v[36:39], v232 offset:16384
    v_mfma_f32_32x32x16_bf16 v[132:147], v[68:71], v[88:91], v[132:147]
    ds_read_b64_tr_b16 v[20:21], v228 offset:20480
    v_mfma_f32_32x32x16_bf16 v[148:163], v[72:75], v[84:87], v[148:163]
    ds_read_b64_tr_b16 v[22:23], v228 offset:22272
    ds_read_b128 v[40:43], v236 offset:16384
    v_mfma_f32_32x32x16_bf16 v[164:179], v[72:75], v[88:91], v[164:179]
    ds_read_b64_tr_b16 v[24:25], v228 offset:20544
    v_mfma_f32_32x32x16_bf16 v[180:195], v[76:79], v[84:87], v[180:195]
    ds_read_b64_tr_b16 v[26:27], v228 offset:22336
    ds_read_b64_tr_b16 v[28:29], v228 offset:20608
    s_add_u32 m0, s96, 81920
    s_nop 0
    buffer_load_dwordx4 v1, s[72:75], s88 offen  lds
    s_add_u32 s88, s88, s92
    v_mfma_f32_32x32x16_bf16 v[196:211], v[76:79], v[88:91], v[196:211]
    ds_read_b64_tr_b16 v[30:31], v228 offset:22400
    v_mfma_f32_32x32x16_bf16 v[212:227], v[80:83], v[84:87], v[212:227]
    ds_read_b64_tr_b16 v[32:33], v230 offset:20480
    ds_read_b64_tr_b16 v[34:35], v230 offset:22272
    s_waitcnt lgkmcnt(10)
    v_mfma_f32_32x32x16_bf16 v[116:131], v[92:95], v[108:111], v[116:131]
    ds_read_b128 v[60:63], v233 offset:16384
    v_mfma_f32_32x32x16_bf16 v[132:147], v[92:95], v[112:115], v[132:147]
    ds_read_b64_tr_b16 v[44:45], v228 offset:27648
    s_add_u32 m0, s97, 81920
    s_nop 0
    buffer_load_dwordx4 v2, s[76:79], s89 offen  lds
    s_add_u32 s89, s89, s93
    v_mfma_f32_32x32x16_bf16 v[148:163], v[96:99], v[108:111], v[148:163]
    ds_read_b64_tr_b16 v[46:47], v228 offset:29440
    ds_read_b128 v[64:67], v237 offset:16384
    v_mfma_f32_32x32x16_bf16 v[164:179], v[96:99], v[112:115], v[164:179]
    ds_read_b64_tr_b16 v[48:49], v228 offset:27712
    v_mfma_f32_32x32x16_bf16 v[180:195], v[100:103], v[108:111], v[180:195]
    ds_read_b64_tr_b16 v[50:51], v228 offset:29504
    ds_read_b64_tr_b16 v[52:53], v228 offset:27776
    v_mfma_f32_32x32x16_bf16 v[196:211], v[100:103], v[112:115], v[196:211]
    ds_read_b64_tr_b16 v[54:55], v228 offset:29568
    s_add_u32 m0, s98, 81920
    s_nop 0
    buffer_load_dwordx4 v3, s[80:83], s90 offen  lds
    s_add_u32 s90, s90, s94
    v_mfma_f32_32x32x16_bf16 v[212:227], v[104:107], v[108:111], v[212:227]
    ds_read_b64_tr_b16 v[56:57], v230 offset:27648
    ds_read_b64_tr_b16 v[58:59], v230 offset:29440
    s_waitcnt vmcnt(7) lgkmcnt(10)
    v_mfma_f32_32x32x16_bf16 v[116:131], v[20:23], v[36:39], v[116:131]
    s_barrier
    ds_read_b128 v[84:87], v234 offset:16384
    v_mfma_f32_32x32x16_bf16 v[132:147], v[20:23], v[40:43], v[132:147]
    ds_read_b64_tr_b16 v[68:69], v228 offset:40960
    v_mfma_f32_32x32x16_bf16 v[148:163], v[24:27], v[36:39], v[148:163]
    ds_read_b64_tr_b16 v[70:71], v228 offset:42752
    ds_read_b128 v[88:91], v238 offset:16384
    v_mfma_f32_32x32x16_bf16 v[164:179], v[24:27], v[40:43], v[164:179]
    ds_read_b64_tr_b16 v[72:73], v228 offset:41024
    v_mfma_f32_32x32x16_bf16 v[180:195], v[28:31], v[36:39], v[180:195]
    ds_read_b64_tr_b16 v[74:75], v228 offset:42816
    ds_read_b64_tr_b16 v[76:77], v228 offset:41088
    s_add_u32 m0, s96, 0
    s_nop 0
    buffer_load_dwordx4 v1, s[72:75], s88 offen  lds
    s_add_u32 s88, s88, s92
    v_mfma_f32_32x32x16_bf16 v[196:211], v[28:31], v[40:43], v[196:211]
    ds_read_b64_tr_b16 v[78:79], v228 offset:42880
    v_mfma_f32_32x32x16_bf16 v[212:227], v[32:35], v[36:39], v[212:227]
    ds_read_b64_tr_b16 v[80:81], v230 offset:40960
    ds_read_b64_tr_b16 v[82:83], v230 offset:42752
    s_waitcnt lgkmcnt(10)
    v_mfma_f32_32x32x16_bf16 v[116:131], v[44:47], v[60:63], v[116:131]
    ds_read_b128 v[108:111], v235 offset:16384
    v_mfma_f32_32x32x16_bf16 v[132:147], v[44:47], v[64:67], v[132:147]
    ds_read_b64_tr_b16 v[92:93], v228 offset:48128
    s_add_u32 m0, s97, 0
    s_nop 0
    buffer_load_dwordx4 v2, s[76:79], s89 offen  lds
    s_add_u32 s89, s89, s93
    v_mfma_f32_32x32x16_bf16 v[148:163], v[48:51], v[60:63], v[148:163]
    ds_read_b64_tr_b16 v[94:95], v228 offset:49920
    ds_read_b128 v[112:115], v239 offset:16384
    v_mfma_f32_32x32x16_bf16 v[164:179], v[48:51], v[64:67], v[164:179]
    ds_read_b64_tr_b16 v[96:97], v228 offset:48192
    v_mfma_f32_32x32x16_bf16 v[180:195], v[52:55], v[60:63], v[180:195]
    ds_read_b64_tr_b16 v[98:99], v228 offset:49984
    ds_read_b64_tr_b16 v[100:101], v228 offset:48256
    v_mfma_f32_32x32x16_bf16 v[196:211], v[52:55], v[64:67], v[196:211]
    ds_read_b64_tr_b16 v[102:103], v228 offset:50048
    s_add_u32 m0, s98, 0
    s_nop 0
    buffer_load_dwordx4 v3, s[80:83], s90 offen  lds
    s_add_u32 s90, s90, s94
    v_mfma_f32_32x32x16_bf16 v[212:227], v[56:59], v[60:63], v[212:227]
    ds_read_b64_tr_b16 v[104:105], v230 offset:48128
    ds_read_b64_tr_b16 v[106:107], v230 offset:49920
    s_waitcnt vmcnt(6) lgkmcnt(10)
    v_mfma_f32_32x32x16_bf16 v[116:131], v[68:71], v[84:87], v[116:131]
    s_barrier
    ds_read_b128 v[36:39], v232 offset:32768
    v_mfma_f32_32x32x16_bf16 v[132:147], v[68:71], v[88:91], v[132:147]
    ds_read_b64_tr_b16 v[20:21], v229 offset:0
    v_mfma_f32_32x32x16_bf16 v[148:163], v[72:75], v[84:87], v[148:163]
    ds_read_b64_tr_b16 v[22:23], v229 offset:1792
    ds_read_b128 v[40:43], v236 offset:32768
    v_mfma_f32_32x32x16_bf16 v[164:179], v[72:75], v[88:91], v[164:179]
    ds_read_b64_tr_b16 v[24:25], v229 offset:64
    v_mfma_f32_32x32x16_bf16 v[180:195], v[76:79], v[84:87], v[180:195]
    ds_read_b64_tr_b16 v[26:27], v229 offset:1856
    ds_read_b64_tr_b16 v[28:29], v229 offset:128
    s_add_u32 m0, s96, 20480
    s_nop 0
    buffer_load_dwordx4 v1, s[72:75], s88 offen  lds
    s_add_u32 s88, s88, s92
    v_mfma_f32_32x32x16_bf16 v[196:211], v[76:79], v[88:91], v[196:211]
    ds_read_b64_tr_b16 v[30:31], v229 offset:1920
    v_mfma_f32_32x32x16_bf16 v[212:227], v[80:83], v[84:87], v[212:227]
    ds_read_b64_tr_b16 v[32:33], v231 offset:0
    ds_read_b64_tr_b16 v[34:35], v231 offset:1792
    s_waitcnt lgkmcnt(10)
    v_mfma_f32_32x32x16_bf16 v[116:131], v[92:95], v[108:111], v[116:131]
    ds_read_b128 v[60:63], v233 offset:32768
    v_mfma_f32_32x32x16_bf16 v[132:147], v[92:95], v[112:115], v[132:147]
    ds_read_b64_tr_b16 v[44:45], v229 offset:7168
    s_add_u32 m0, s97, 20480
    s_nop 0
    buffer_load_dwordx4 v2, s[76:79], s89 offen  lds
    s_add_u32 s89, s89, s93
    v_mfma_f32_32x32x16_bf16 v[148:163], v[96:99], v[108:111], v[148:163]
    ds_read_b64_tr_b16 v[46:47], v229 offset:8960
    ds_read_b128 v[64:67], v237 offset:32768
    v_mfma_f32_32x32x16_bf16 v[164:179], v[96:99], v[112:115], v[164:179]
    ds_read_b64_tr_b16 v[48:49], v229 offset:7232
    v_mfma_f32_32x32x16_bf16 v[180:195], v[100:103], v[108:111], v[180:195]
    ds_read_b64_tr_b16 v[50:51], v229 offset:9024
    ds_read_b64_tr_b16 v[52:53], v229 offset:7296
    v_mfma_f32_32x32x16_bf16 v[196:211], v[100:103], v[112:115], v[196:211]
    ds_read_b64_tr_b16 v[54:55], v229 offset:9088
    s_add_u32 m0, s98, 20480
    s_nop 0
    buffer_load_dwordx4 v3, s[80:83], s90 offen  lds
    s_add_u32 s90, s90, s94
    v_mfma_f32_32x32x16_bf16 v[212:227], v[104:107], v[108:111], v[212:227]
    ds_read_b64_tr_b16 v[56:57], v231 offset:7168
    ds_read_b64_tr_b16 v[58:59], v231 offset:8960
    s_waitcnt vmcnt(6) lgkmcnt(10)
    v_mfma_f32_32x32x16_bf16 v[116:131], v[20:23], v[36:39], v[116:131]
    s_barrier
    ds_read_b128 v[84:87], v234 offset:32768
    v_mfma_f32_32x32x16_bf16 v[132:147], v[20:23], v[40:43], v[132:147]
    ds_read_b64_tr_b16 v[68:69], v229 offset:20480
    v_mfma_f32_32x32x16_bf16 v[148:163], v[24:27], v[36:39], v[148:163]
    ds_read_b64_tr_b16 v[70:71], v229 offset:22272
    ds_read_b128 v[88:91], v238 offset:32768
    v_mfma_f32_32x32x16_bf16 v[164:179], v[24:27], v[40:43], v[164:179]
    ds_read_b64_tr_b16 v[72:73], v229 offset:20544
    v_mfma_f32_32x32x16_bf16 v[180:195], v[28:31], v[36:39], v[180:195]
    ds_read_b64_tr_b16 v[74:75], v229 offset:22336
    ds_read_b64_tr_b16 v[76:77], v229 offset:20608
    v_mfma_f32_32x32x16_bf16 v[196:211], v[28:31], v[40:43], v[196:211]
    ds_read_b64_tr_b16 v[78:79], v229 offset:22400
    v_mfma_f32_32x32x16_bf16 v[212:227], v[32:35], v[36:39], v[212:227]
    ds_read_b64_tr_b16 v[80:81], v231 offset:20480
    ds_read_b64_tr_b16 v[82:83], v231 offset:22272
    s_waitcnt lgkmcnt(10)
    v_mfma_f32_32x32x16_bf16 v[116:131], v[44:47], v[60:63], v[116:131]
    ds_read_b128 v[108:111], v235 offset:32768
    v_mfma_f32_32x32x16_bf16 v[132:147], v[44:47], v[64:67], v[132:147]
    ds_read_b64_tr_b16 v[92:93], v229 offset:27648
    v_mfma_f32_32x32x16_bf16 v[148:163], v[48:51], v[60:63], v[148:163]
    ds_read_b64_tr_b16 v[94:95], v229 offset:29440
    ds_read_b128 v[112:115], v239 offset:32768
    v_mfma_f32_32x32x16_bf16 v[164:179], v[48:51], v[64:67], v[164:179]
    ds_read_b64_tr_b16 v[96:97], v229 offset:27712
    v_mfma_f32_32x32x16_bf16 v[180:195], v[52:55], v[60:63], v[180:195]
    ds_read_b64_tr_b16 v[98:99], v229 offset:29504
    ds_read_b64_tr_b16 v[100:101], v229 offset:27776
    v_mfma_f32_32x32x16_bf16 v[196:211], v[52:55], v[64:67], v[196:211]
    ds_read_b64_tr_b16 v[102:103], v229 offset:29568
    v_mfma_f32_32x32x16_bf16 v[212:227], v[56:59], v[60:63], v[212:227]
    ds_read_b64_tr_b16 v[104:105], v231 offset:27648
    ds_read_b64_tr_b16 v[106:107], v231 offset:29440
    s_waitcnt vmcnt(3) lgkmcnt(10)
    v_mfma_f32_32x32x16_bf16 v[116:131], v[68:71], v[84:87], v[116:131]
    s_barrier
    ds_read_b128 v[36:39], v232 offset:0
    v_mfma_f32_32x32x16_bf16 v[132:147], v[68:71], v[88:91], v[132:147]
    ds_read_b64_tr_b16 v[20:21], v228 offset:0
    v_mfma_f32_32x32x16_bf16 v[148:163], v[72:75], v[84:87], v[148:163]
    ds_read_b64_tr_b16 v[22:23], v228 offset:1792
    ds_read_b128 v[40:43], v236 offset:0
    v_mfma_f32_32x32x16_bf16 v[164:179], v[72:75], v[88:91], v[164:179]
    ds_read_b64_tr_b16 v[24:25], v228 offset:64
    v_mfma_f32_32x32x16_bf16 v[180:195], v[76:79], v[84:87], v[180:195]
    ds_read_b64_tr_b16 v[26:27], v228 offset:1856
    ds_read_b64_tr_b16 v[28:29], v228 offset:128
    v_mfma_f32_32x32x16_bf16 v[196:211], v[76:79], v[88:91], v[196:211]
    ds_read_b64_tr_b16 v[30:31], v228 offset:1920
    v_mfma_f32_32x32x16_bf16 v[212:227], v[80:83], v[84:87], v[212:227]
    ds_read_b64_tr_b16 v[32:33], v230 offset:0
    ds_read_b64_tr_b16 v[34:35], v230 offset:1792
    s_waitcnt lgkmcnt(10)
    v_mfma_f32_32x32x16_bf16 v[116:131], v[92:95], v[108:111], v[116:131]
    ds_read_b128 v[60:63], v233 offset:0
    v_mfma_f32_32x32x16_bf16 v[132:147], v[92:95], v[112:115], v[132:147]
    ds_read_b64_tr_b16 v[44:45], v228 offset:7168
    v_mfma_f32_32x32x16_bf16 v[148:163], v[96:99], v[108:111], v[148:163]
    ds_read_b64_tr_b16 v[46:47], v228 offset:8960
    ds_read_b128 v[64:67], v237 offset:0
    v_mfma_f32_32x32x16_bf16 v[164:179], v[96:99], v[112:115], v[164:179]
    ds_read_b64_tr_b16 v[48:49], v228 offset:7232
    v_mfma_f32_32x32x16_bf16 v[180:195], v[100:103], v[108:111], v[180:195]
    ds_read_b64_tr_b16 v[50:51], v228 offset:9024
    ds_read_b64_tr_b16 v[52:53], v228 offset:7296
    v_mfma_f32_32x32x16_bf16 v[196:211], v[100:103], v[112:115], v[196:211]
    ds_read_b64_tr_b16 v[54:55], v228 offset:9088
    v_mfma_f32_32x32x16_bf16 v[212:227], v[104:107], v[108:111], v[212:227]
    ds_read_b64_tr_b16 v[56:57], v230 offset:7168
    ds_read_b64_tr_b16 v[58:59], v230 offset:8960
    s_waitcnt vmcnt(0) lgkmcnt(10)
    v_mfma_f32_32x32x16_bf16 v[116:131], v[20:23], v[36:39], v[116:131]
    s_barrier
    ds_read_b128 v[84:87], v234 offset:0
    v_mfma_f32_32x32x16_bf16 v[132:147], v[20:23], v[40:43], v[132:147]
    ds_read_b64_tr_b16 v[68:69], v228 offset:20480
    v_mfma_f32_32x32x16_bf16 v[148:163], v[24:27], v[36:39], v[148:163]
    ds_read_b64_tr_b16 v[70:71], v228 offset:22272
    ds_read_b128 v[88:91], v238 offset:0
    v_mfma_f32_32x32x16_bf16 v[164:179], v[24:27], v[40:43], v[164:179]
    ds_read_b64_tr_b16 v[72:73], v228 offset:20544
    v_mfma_f32_32x32x16_bf16 v[180:195], v[28:31], v[36:39], v[180:195]
    ds_read_b64_tr_b16 v[74:75], v228 offset:22336
    ds_read_b64_tr_b16 v[76:77], v228 offset:20608
    v_mfma_f32_32x32x16_bf16 v[196:211], v[28:31], v[40:43], v[196:211]
    ds_read_b64_tr_b16 v[78:79], v228 offset:22400
    v_mfma_f32_32x32x16_bf16 v[212:227], v[32:35], v[36:39], v[212:227]
    ds_read_b64_tr_b16 v[80:81], v230 offset:20480
    ds_read_b64_tr_b16 v[82:83], v230 offset:22272
    s_waitcnt lgkmcnt(10)
    v_mfma_f32_32x32x16_bf16 v[116:131], v[44:47], v[60:63], v[116:131]
    ds_read_b128 v[108:111], v235 offset:0
    v_mfma_f32_32x32x16_bf16 v[132:147], v[44:47], v[64:67], v[132:147]
    ds_read_b64_tr_b16 v[92:93], v228 offset:27648
    v_mfma_f32_32x32x16_bf16 v[148:163], v[48:51], v[60:63], v[148:163]
    ds_read_b64_tr_b16 v[94:95], v228 offset:29440
    ds_read_b128 v[112:115], v239 offset:0
    v_mfma_f32_32x32x16_bf16 v[164:179], v[48:51], v[64:67], v[164:179]
    ds_read_b64_tr_b16 v[96:97], v228 offset:27712
    v_mfma_f32_32x32x16_bf16 v[180:195], v[52:55], v[60:63], v[180:195]
    ds_read_b64_tr_b16 v[98:99], v228 offset:29504
    ds_read_b64_tr_b16 v[100:101], v228 offset:27776
    v_mfma_f32_32x32x16_bf16 v[196:211], v[52:55], v[64:67], v[196:211]
    ds_read_b64_tr_b16 v[102:103], v228 offset:29568
    v_mfma_f32_32x32x16_bf16 v[212:227], v[56:59], v[60:63], v[212:227]
    ds_read_b64_tr_b16 v[104:105], v230 offset:27648
    ds_read_b64_tr_b16 v[106:107], v230 offset:29440
    s_waitcnt lgkmcnt(10)
    v_mfma_f32_32x32x16_bf16 v[116:131], v[68:71], v[84:87], v[116:131]
    v_mfma_f32_32x32x16_bf16 v[132:147], v[68:71], v[88:91], v[132:147]
    v_mfma_f32_32x32x16_bf16 v[148:163], v[72:75], v[84:87], v[148:163]
    v_mfma_f32_32x32x16_bf16 v[164:179], v[72:75], v[88:91], v[164:179]
    v_mfma_f32_32x32x16_bf16 v[180:195], v[76:79], v[84:87], v[180:195]
    v_mfma_f32_32x32x16_bf16 v[196:211], v[76:79], v[88:91], v[196:211]
    v_mfma_f32_32x32x16_bf16 v[212:227], v[80:83], v[84:87], v[212:227]
    s_waitcnt lgkmcnt(0)
    v_mfma_f32_32x32x16_bf16 v[116:131], v[92:95], v[108:111], v[116:131]
    v_mfma_f32_32x32x16_bf16 v[132:147], v[92:95], v[112:115], v[132:147]
    v_mfma_f32_32x32x16_bf16 v[148:163], v[96:99], v[108:111], v[148:163]
    v_mfma_f32_32x32x16_bf16 v[164:179], v[96:99], v[112:115], v[164:179]
    v_mfma_f32_32x32x16_bf16 v[180:195], v[100:103], v[108:111], v[180:195]
    v_mfma_f32_32x32x16_bf16 v[196:211], v[100:103], v[112:115], v[196:211]
    v_mfma_f32_32x32x16_bf16 v[212:227], v[104:107], v[108:111], v[212:227]
    v_and_b32 v20, 31, v0
    v_lshlrev_b32 v20, 3, v20
    s_lshl_b32 s13, s18, 8
    s_lshl_b32 s14, s19, 8
    v_add_u32 v21, s13, v20
    v_add_u32 v22, s14, v20
    v_mov_b32 v23, 155136
    v_add_u32 v21, 154112, v21
    v_add_u32 v22, 154112, v22
    ds_read_b64 v[32:33], v21
    ds_read_b64 v[34:35], v22
    ds_read_b64 v[36:37], v23
    v_lshrrev_b32 v21, 5, v0
    v_lshlrev_b32 v21, 4, v21
    v_add_u32 v21, 151552, v21
    s_lshl_b32 s15, s4, 2
    s_add_u32 s16, s15, s19
    s_add_u32 s15, s15, s18
    s_waitcnt lgkmcnt(0)
    v_readfirstlane_b32 s62, v36
    v_readfirstlane_b32 s63, v37
    v_mov_b32 v24, v33
    v_mul_f32 v26, v32, v33
    v_sub_f32 v26, 0, v26
    v_mov_b32 v28, v35
    v_mul_f32 v30, v34, v35
    v_sub_f32 v30, 0, v30
    s_barrier
    s_mul_i32 s21, s8, 768
    v_add_u32 v22, s21, v21
    ds_read_b128 v[48:51], v22 offset:512
    ds_read_b128 v[52:55], v22 offset:544
    ds_read_b128 v[56:59], v22 offset:576
    ds_read_b128 v[60:63], v22 offset:608
    ds_read_b128 v[64:67], v22 offset:640
    ds_read_b128 v[68:71], v22 offset:672
    ds_read_b128 v[72:75], v22 offset:704
    ds_read_b128 v[76:79], v22 offset:736
    s_waitcnt lgkmcnt(0)
    v_pk_fma_f32 v[32:33], v[48:49], v[26:27], v[64:65] op_sel_hi:[1,0,1]
    v_pk_fma_f32 v[116:117], v[116:117], v[24:25], v[32:33] op_sel_hi:[1,0,1]
    v_mul_f32 v116, v116, abs(v116)
    v_mul_f32 v117, v117, abs(v117)
    v_cvt_pk_bf16_f32 v116, v116, v117
    v_pk_max_i16 v116, v116, 0
    v_pk_fma_f32 v[32:33], v[50:51], v[26:27], v[66:67] op_sel_hi:[1,0,1]
    v_pk_fma_f32 v[118:119], v[118:119], v[24:25], v[32:33] op_sel_hi:[1,0,1]
    v_mul_f32 v118, v118, abs(v118)
    v_mul_f32 v119, v119, abs(v119)
    v_cvt_pk_bf16_f32 v117, v118, v119
    v_pk_max_i16 v117, v117, 0
    v_pk_fma_f32 v[32:33], v[52:53], v[26:27], v[68:69] op_sel_hi:[1,0,1]
    v_pk_fma_f32 v[120:121], v[120:121], v[24:25], v[32:33] op_sel_hi:[1,0,1]
    v_mul_f32 v120, v120, abs(v120)
    v_mul_f32 v121, v121, abs(v121)
    v_cvt_pk_bf16_f32 v118, v120, v121
    v_pk_max_i16 v118, v118, 0
    v_pk_fma_f32 v[32:33], v[54:55], v[26:27], v[70:71] op_sel_hi:[1,0,1]
    v_pk_fma_f32 v[122:123], v[122:123], v[24:25], v[32:33] op_sel_hi:[1,0,1]
    v_mul_f32 v122, v122, abs(v122)
    v_mul_f32 v123, v123, abs(v123)
    v_cvt_pk_bf16_f32 v119, v122, v123
    v_pk_max_i16 v119, v119, 0
    v_pk_fma_f32 v[32:33], v[56:57], v[26:27], v[72:73] op_sel_hi:[1,0,1]
    v_pk_fma_f32 v[124:125], v[124:125], v[24:25], v[32:33] op_sel_hi:[1,0,1]
    v_mul_f32 v124, v124, abs(v124)
    v_mul_f32 v125, v125, abs(v125)
    v_cvt_pk_bf16_f32 v120, v124, v125
    v_pk_max_i16 v120, v120, 0
    v_pk_fma_f32 v[32:33], v[58:59], v[26:27], v[74:75] op_sel_hi:[1,0,1]
    v_pk_fma_f32 v[126:127], v[126:127], v[24:25], v[32:33] op_sel_hi:[1,0,1]
    v_mul_f32 v126, v126, abs(v126)
    v_mul_f32 v127, v127, abs(v127)
    v_cvt_pk_bf16_f32 v121, v126, v127
    v_pk_max_i16 v121, v121, 0
    v_pk_fma_f32 v[32:33], v[60:61], v[26:27], v[76:77] op_sel_hi:[1,0,1]
    v_pk_fma_f32 v[128:129], v[128:129], v[24:25], v[32:33] op_sel_hi:[1,0,1]
    v_mul_f32 v128, v128, abs(v128)
    v_mul_f32 v129, v129, abs(v129)
    v_cvt_pk_bf16_f32 v122, v128, v129
    v_pk_max_i16 v122, v122, 0
    v_pk_fma_f32 v[32:33], v[62:63], v[26:27], v[78:79] op_sel_hi:[1,0,1]
    v_pk_fma_f32 v[130:131], v[130:131], v[24:25], v[32:33] op_sel_hi:[1,0,1]
    v_mul_f32 v130, v130, abs(v130)
    v_mul_f32 v131, v131, abs(v131)
    v_cvt_pk_bf16_f32 v123, v130, v131
    v_pk_max_i16 v123, v123, 0
    v_pk_fma_f32 v[32:33], v[48:49], v[30:31], v[64:65] op_sel_hi:[1,0,1]
    v_pk_fma_f32 v[132:133], v[132:133], v[28:29], v[32:33] op_sel_hi:[1,0,1]
    v_mul_f32 v132, v132, abs(v132)
    v_mul_f32 v133, v133, abs(v133)
    v_cvt_pk_bf16_f32 v132, v132, v133
    v_pk_max_i16 v132, v132, 0
    v_pk_fma_f32 v[32:33], v[50:51], v[30:31], v[66:67] op_sel_hi:[1,0,1]
    v_pk_fma_f32 v[134:135], v[134:135], v[28:29], v[32:33] op_sel_hi:[1,0,1]
    v_mul_f32 v134, v134, abs(v134)
    v_mul_f32 v135, v135, abs(v135)
    v_cvt_pk_bf16_f32 v133, v134, v135
    v_pk_max_i16 v133, v133, 0
    v_pk_fma_f32 v[32:33], v[52:53], v[30:31], v[68:69] op_sel_hi:[1,0,1]
    v_pk_fma_f32 v[136:137], v[136:137], v[28:29], v[32:33] op_sel_hi:[1,0,1]
    v_mul_f32 v136, v136, abs(v136)
    v_mul_f32 v137, v137, abs(v137)
    v_cvt_pk_bf16_f32 v134, v136, v137
    v_pk_max_i16 v134, v134, 0
    v_pk_fma_f32 v[32:33], v[54:55], v[30:31], v[70:71] op_sel_hi:[1,0,1]
    v_pk_fma_f32 v[138:139], v[138:139], v[28:29], v[32:33] op_sel_hi:[1,0,1]
    v_mul_f32 v138, v138, abs(v138)
    v_mul_f32 v139, v139, abs(v139)
    v_cvt_pk_bf16_f32 v135, v138, v139
    v_pk_max_i16 v135, v135, 0
    v_pk_fma_f32 v[32:33], v[56:57], v[30:31], v[72:73] op_sel_hi:[1,0,1]
    v_pk_fma_f32 v[140:141], v[140:141], v[28:29], v[32:33] op_sel_hi:[1,0,1]
    v_mul_f32 v140, v140, abs(v140)
    v_mul_f32 v141, v141, abs(v141)
    v_cvt_pk_bf16_f32 v136, v140, v141
    v_pk_max_i16 v136, v136, 0
    v_pk_fma_f32 v[32:33], v[58:59], v[30:31], v[74:75] op_sel_hi:[1,0,1]
    v_pk_fma_f32 v[142:143], v[142:143], v[28:29], v[32:33] op_sel_hi:[1,0,1]
    v_mul_f32 v142, v142, abs(v142)
    v_mul_f32 v143, v143, abs(v143)
    v_cvt_pk_bf16_f32 v137, v142, v143
    v_pk_max_i16 v137, v137, 0
    v_pk_fma_f32 v[32:33], v[60:61], v[30:31], v[76:77] op_sel_hi:[1,0,1]
    v_pk_fma_f32 v[144:145], v[144:145], v[28:29], v[32:33] op_sel_hi:[1,0,1]
    v_mul_f32 v144, v144, abs(v144)
    v_mul_f32 v145, v145, abs(v145)
    v_cvt_pk_bf16_f32 v138, v144, v145
    v_pk_max_i16 v138, v138, 0
    v_pk_fma_f32 v[32:33], v[62:63], v[30:31], v[78:79] op_sel_hi:[1,0,1]
    v_pk_fma_f32 v[146:147], v[146:147], v[28:29], v[32:33] op_sel_hi:[1,0,1]
    v_mul_f32 v146, v146, abs(v146)
    v_mul_f32 v147, v147, abs(v147)
    v_cvt_pk_bf16_f32 v139, v146, v147
    v_pk_max_i16 v139, v139, 0
    ds_read_b128 v[48:51], v22 offset:768
    ds_read_b128 v[52:55], v22 offset:800
    ds_read_b128 v[56:59], v22 offset:832
    ds_read_b128 v[60:63], v22 offset:864
    ds_read_b128 v[64:67], v22 offset:896
    ds_read_b128 v[68:71], v22 offset:928
    ds_read_b128 v[72:75], v22 offset:960
    ds_read_b128 v[76:79], v22 offset:992
    s_waitcnt lgkmcnt(0)
    v_pk_fma_f32 v[32:33], v[48:49], v[26:27], v[64:65] op_sel_hi:[1,0,1]
    v_pk_fma_f32 v[148:149], v[148:149], v[24:25], v[32:33] op_sel_hi:[1,0,1]
    v_mul_f32 v148, v148, abs(v148)
    v_mul_f32 v149, v149, abs(v149)
    v_cvt_pk_bf16_f32 v148, v148, v149
    v_pk_max_i16 v148, v148, 0
    v_pk_fma_f32 v[32:33], v[50:51], v[26:27], v[66:67] op_sel_hi:[1,0,1]
    v_pk_fma_f32 v[150:151], v[150:151], v[24:25], v[32:33] op_sel_hi:[1,0,1]
    v_mul_f32 v150, v150, abs(v150)
    v_mul_f32 v151, v151, abs(v151)
    v_cvt_pk_bf16_f32 v149, v150, v151
    v_pk_max_i16 v149, v149, 0
    v_pk_fma_f32 v[32:33], v[52:53], v[26:27], v[68:69] op_sel_hi:[1,0,1]
    v_pk_fma_f32 v[152:153], v[152:153], v[24:25], v[32:33] op_sel_hi:[1,0,1]
    v_mul_f32 v152, v152, abs(v152)
    v_mul_f32 v153, v153, abs(v153)
    v_cvt_pk_bf16_f32 v150, v152, v153
    v_pk_max_i16 v150, v150, 0
    v_pk_fma_f32 v[32:33], v[54:55], v[26:27], v[70:71] op_sel_hi:[1,0,1]
    v_pk_fma_f32 v[154:155], v[154:155], v[24:25], v[32:33] op_sel_hi:[1,0,1]
    v_mul_f32 v154, v154, abs(v154)
    v_mul_f32 v155, v155, abs(v155)
    v_cvt_pk_bf16_f32 v151, v154, v155
    v_pk_max_i16 v151, v151, 0
    v_pk_fma_f32 v[32:33], v[56:57], v[26:27], v[72:73] op_sel_hi:[1,0,1]
    v_pk_fma_f32 v[156:157], v[156:157], v[24:25], v[32:33] op_sel_hi:[1,0,1]
    v_mul_f32 v156, v156, abs(v156)
    v_mul_f32 v157, v157, abs(v157)
    v_cvt_pk_bf16_f32 v152, v156, v157
    v_pk_max_i16 v152, v152, 0
    v_pk_fma_f32 v[32:33], v[58:59], v[26:27], v[74:75] op_sel_hi:[1,0,1]
    v_pk_fma_f32 v[158:159], v[158:159], v[24:25], v[32:33] op_sel_hi:[1,0,1]
    v_mul_f32 v158, v158, abs(v158)
    v_mul_f32 v159, v159, abs(v159)
    v_cvt_pk_bf16_f32 v153, v158, v159
    v_pk_max_i16 v153, v153, 0
    v_pk_fma_f32 v[32:33], v[60:61], v[26:27], v[76:77] op_sel_hi:[1,0,1]
    v_pk_fma_f32 v[160:161], v[160:161], v[24:25], v[32:33] op_sel_hi:[1,0,1]
    v_mul_f32 v160, v160, abs(v160)
    v_mul_f32 v161, v161, abs(v161)
    v_cvt_pk_bf16_f32 v154, v160, v161
    v_pk_max_i16 v154, v154, 0
    v_pk_fma_f32 v[32:33], v[62:63], v[26:27], v[78:79] op_sel_hi:[1,0,1]
    v_pk_fma_f32 v[162:163], v[162:163], v[24:25], v[32:33] op_sel_hi:[1,0,1]
    v_mul_f32 v162, v162, abs(v162)
    v_mul_f32 v163, v163, abs(v163)
    v_cvt_pk_bf16_f32 v155, v162, v163
    v_pk_max_i16 v155, v155, 0
    v_pk_fma_f32 v[32:33], v[48:49], v[30:31], v[64:65] op_sel_hi:[1,0,1]
    v_pk_fma_f32 v[164:165], v[164:165], v[28:29], v[32:33] op_sel_hi:[1,0,1]
    v_mul_f32 v164, v164, abs(v164)
    v_mul_f32 v165, v165, abs(v165)
    v_cvt_pk_bf16_f32 v164, v164, v165
    v_pk_max_i16 v164, v164, 0
    v_pk_fma_f32 v[32:33], v[50:51], v[30:31], v[66:67] op_sel_hi:[1,0,1]
    v_pk_fma_f32 v[166:167], v[166:167], v[28:29], v[32:33] op_sel_hi:[1,0,1]
    v_mul_f32 v166, v166, abs(v166)
    v_mul_f32 v167, v167, abs(v167)
    v_cvt_pk_bf16_f32 v165, v166, v167
    v_pk_max_i16 v165, v165, 0
    v_pk_fma_f32 v[32:33], v[52:53], v[30:31], v[68:69] op_sel_hi:[1,0,1]
    v_pk_fma_f32 v[168:169], v[168:169], v[28:29], v[32:33] op_sel_hi:[1,0,1]
    v_mul_f32 v168, v168, abs(v168)
    v_mul_f32 v169, v169, abs(v169)
    v_cvt_pk_bf16_f32 v166, v168, v169
    v_pk_max_i16 v166, v166, 0
    v_pk_fma_f32 v[32:33], v[54:55], v[30:31], v[70:71] op_sel_hi:[1,0,1]
    v_pk_fma_f32 v[170:171], v[170:171], v[28:29], v[32:33] op_sel_hi:[1,0,1]
    v_mul_f32 v170, v170, abs(v170)
    v_mul_f32 v171, v171, abs(v171)
    v_cvt_pk_bf16_f32 v167, v170, v171
    v_pk_max_i16 v167, v167, 0
    v_pk_fma_f32 v[32:33], v[56:57], v[30:31], v[72:73] op_sel_hi:[1,0,1]
    v_pk_fma_f32 v[172:173], v[172:173], v[28:29], v[32:33] op_sel_hi:[1,0,1]
    v_mul_f32 v172, v172, abs(v172)
    v_mul_f32 v173, v173, abs(v173)
    v_cvt_pk_bf16_f32 v168, v172, v173
    v_pk_max_i16 v168, v168, 0
    v_pk_fma_f32 v[32:33], v[58:59], v[30:31], v[74:75] op_sel_hi:[1,0,1]
    v_pk_fma_f32 v[174:175], v[174:175], v[28:29], v[32:33] op_sel_hi:[1,0,1]
    v_mul_f32 v174, v174, abs(v174)
    v_mul_f32 v175, v175, abs(v175)
    v_cvt_pk_bf16_f32 v169, v174, v175
    v_pk_max_i16 v169, v169, 0
    v_pk_fma_f32 v[32:33], v[60:61], v[30:31], v[76:77] op_sel_hi:[1,0,1]
    v_pk_fma_f32 v[176:177], v[176:177], v[28:29], v[32:33] op_sel_hi:[1,0,1]
    v_mul_f32 v176, v176, abs(v176)
    v_mul_f32 v177, v177, abs(v177)
    v_cvt_pk_bf16_f32 v170, v176, v177
    v_pk_max_i16 v170, v170, 0
    v_pk_fma_f32 v[32:33], v[62:63], v[30:31], v[78:79] op_sel_hi:[1,0,1]
    v_pk_fma_f32 v[178:179], v[178:179], v[28:29], v[32:33] op_sel_hi:[1,0,1]
    v_mul_f32 v178, v178, abs(v178)
    v_mul_f32 v179, v179, abs(v179)
    v_cvt_pk_bf16_f32 v171, v178, v179
    v_pk_max_i16 v171, v171, 0
    ds_read_b128 v[48:51], v22 offset:1024
    ds_read_b128 v[52:55], v22 offset:1056
    ds_read_b128 v[56:59], v22 offset:1088
    ds_read_b128 v[60:63], v22 offset:1120
    ds_read_b128 v[64:67], v22 offset:1152
    ds_read_b128 v[68:71], v22 offset:1184
    ds_read_b128 v[72:75], v22 offset:1216
    ds_read_b128 v[76:79], v22 offset:1248
    s_waitcnt lgkmcnt(0)
    v_pk_fma_f32 v[32:33], v[48:49], v[26:27], v[64:65] op_sel_hi:[1,0,1]
    v_pk_fma_f32 v[180:181], v[180:181], v[24:25], v[32:33] op_sel_hi:[1,0,1]
    v_mul_f32 v180, v180, abs(v180)
    v_mul_f32 v181, v181, abs(v181)
    v_cvt_pk_bf16_f32 v180, v180, v181
    v_pk_max_i16 v180, v180, 0
    v_pk_fma_f32 v[32:33], v[50:51], v[26:27], v[66:67] op_sel_hi:[1,0,1]
    v_pk_fma_f32 v[182:183], v[182:183], v[24:25], v[32:33] op_sel_hi:[1,0,1]
    v_mul_f32 v182, v182, abs(v182)
    v_mul_f32 v183, v183, abs(v183)
    v_cvt_pk_bf16_f32 v181, v182, v183
    v_pk_max_i16 v181, v181, 0
    v_pk_fma_f32 v[32:33], v[52:53], v[26:27], v[68:69] op_sel_hi:[1,0,1]
    v_pk_fma_f32 v[184:185], v[184:185], v[24:25], v[32:33] op_sel_hi:[1,0,1]
    v_mul_f32 v184, v184, abs(v184)
    v_mul_f32 v185, v185, abs(v185)
    v_cvt_pk_bf16_f32 v182, v184, v185
    v_pk_max_i16 v182, v182, 0
    v_pk_fma_f32 v[32:33], v[54:55], v[26:27], v[70:71] op_sel_hi:[1,0,1]
    v_pk_fma_f32 v[186:187], v[186:187], v[24:25], v[32:33] op_sel_hi:[1,0,1]
    v_mul_f32 v186, v186, abs(v186)
    v_mul_f32 v187, v187, abs(v187)
    v_cvt_pk_bf16_f32 v183, v186, v187
    v_pk_max_i16 v183, v183, 0
    v_pk_fma_f32 v[32:33], v[56:57], v[26:27], v[72:73] op_sel_hi:[1,0,1]
    v_pk_fma_f32 v[188:189], v[188:189], v[24:25], v[32:33] op_sel_hi:[1,0,1]
    v_mul_f32 v188, v188, abs(v188)
    v_mul_f32 v189, v189, abs(v189)
    v_cvt_pk_bf16_f32 v184, v188, v189
    v_pk_max_i16 v184, v184, 0
    v_pk_fma_f32 v[32:33], v[58:59], v[26:27], v[74:75] op_sel_hi:[1,0,1]
    v_pk_fma_f32 v[190:191], v[190:191], v[24:25], v[32:33] op_sel_hi:[1,0,1]
    v_mul_f32 v190, v190, abs(v190)
    v_mul_f32 v191, v191, abs(v191)
    v_cvt_pk_bf16_f32 v185, v190, v191
    v_pk_max_i16 v185, v185, 0
    v_pk_fma_f32 v[32:33], v[60:61], v[26:27], v[76:77] op_sel_hi:[1,0,1]
    v_pk_fma_f32 v[192:193], v[192:193], v[24:25], v[32:33] op_sel_hi:[1,0,1]
    v_mul_f32 v192, v192, abs(v192)
    v_mul_f32 v193, v193, abs(v193)
    v_cvt_pk_bf16_f32 v186, v192, v193
    v_pk_max_i16 v186, v186, 0
    v_pk_fma_f32 v[32:33], v[62:63], v[26:27], v[78:79] op_sel_hi:[1,0,1]
    v_pk_fma_f32 v[194:195], v[194:195], v[24:25], v[32:33] op_sel_hi:[1,0,1]
    v_mul_f32 v194, v194, abs(v194)
    v_mul_f32 v195, v195, abs(v195)
    v_cvt_pk_bf16_f32 v187, v194, v195
    v_pk_max_i16 v187, v187, 0
    v_pk_fma_f32 v[32:33], v[48:49], v[30:31], v[64:65] op_sel_hi:[1,0,1]
    v_pk_fma_f32 v[196:197], v[196:197], v[28:29], v[32:33] op_sel_hi:[1,0,1]
    v_mul_f32 v196, v196, abs(v196)
    v_mul_f32 v197, v197, abs(v197)
    v_cvt_pk_bf16_f32 v196, v196, v197
    v_pk_max_i16 v196, v196, 0
    v_pk_fma_f32 v[32:33], v[50:51], v[30:31], v[66:67] op_sel_hi:[1,0,1]
    v_pk_fma_f32 v[198:199], v[198:199], v[28:29], v[32:33] op_sel_hi:[1,0,1]
    v_mul_f32 v198, v198, abs(v198)
    v_mul_f32 v199, v199, abs(v199)
    v_cvt_pk_bf16_f32 v197, v198, v199
    v_pk_max_i16 v197, v197, 0
    v_pk_fma_f32 v[32:33], v[52:53], v[30:31], v[68:69] op_sel_hi:[1,0,1]
    v_pk_fma_f32 v[200:201], v[200:201], v[28:29], v[32:33] op_sel_hi:[1,0,1]
    v_mul_f32 v200, v200, abs(v200)
    v_mul_f32 v201, v201, abs(v201)
    v_cvt_pk_bf16_f32 v198, v200, v201
    v_pk_max_i16 v198, v198, 0
    v_pk_fma_f32 v[32:33], v[54:55], v[30:31], v[70:71] op_sel_hi:[1,0,1]
    v_pk_fma_f32 v[202:203], v[202:203], v[28:29], v[32:33] op_sel_hi:[1,0,1]
    v_mul_f32 v202, v202, abs(v202)
    v_mul_f32 v203, v203, abs(v203)
    v_cvt_pk_bf16_f32 v199, v202, v203
    v_pk_max_i16 v199, v199, 0
    v_pk_fma_f32 v[32:33], v[56:57], v[30:31], v[72:73] op_sel_hi:[1,0,1]
    v_pk_fma_f32 v[204:205], v[204:205], v[28:29], v[32:33] op_sel_hi:[1,0,1]
    v_mul_f32 v204, v204, abs(v204)
    v_mul_f32 v205, v205, abs(v205)
    v_cvt_pk_bf16_f32 v200, v204, v205
    v_pk_max_i16 v200, v200, 0
    v_pk_fma_f32 v[32:33], v[58:59], v[30:31], v[74:75] op_sel_hi:[1,0,1]
    v_pk_fma_f32 v[206:207], v[206:207], v[28:29], v[32:33] op_sel_hi:[1,0,1]
    v_mul_f32 v206, v206, abs(v206)
    v_mul_f32 v207, v207, abs(v207)
    v_cvt_pk_bf16_f32 v201, v206, v207
    v_pk_max_i16 v201, v201, 0
    v_pk_fma_f32 v[32:33], v[60:61], v[30:31], v[76:77] op_sel_hi:[1,0,1]
    v_pk_fma_f32 v[208:209], v[208:209], v[28:29], v[32:33] op_sel_hi:[1,0,1]
    v_mul_f32 v208, v208, abs(v208)
    v_mul_f32 v209, v209, abs(v209)
    v_cvt_pk_bf16_f32 v202, v208, v209
    v_pk_max_i16 v202, v202, 0
    v_pk_fma_f32 v[32:33], v[62:63], v[30:31], v[78:79] op_sel_hi:[1,0,1]
    v_pk_fma_f32 v[210:211], v[210:211], v[28:29], v[32:33] op_sel_hi:[1,0,1]
    v_mul_f32 v210, v210, abs(v210)
    v_mul_f32 v211, v211, abs(v211)
    v_cvt_pk_bf16_f32 v203, v210, v211
    v_pk_max_i16 v203, v203, 0
    ds_read_b128 v[48:51], v21 offset:2048
    ds_read_b128 v[52:55], v21 offset:2080
    ds_read_b128 v[56:59], v21 offset:2112
    ds_read_b128 v[60:63], v21 offset:2144
    ds_read_b128 v[64:67], v21 offset:2176
    ds_read_b128 v[68:71], v21 offset:2208
    ds_read_b128 v[72:75], v21 offset:2240
    ds_read_b128 v[76:79], v21 offset:2272
    s_waitcnt lgkmcnt(0)
    v_pk_fma_f32 v[32:33], v[48:49], v[26:27], v[64:65] op_sel_hi:[1,0,1]
    v_pk_fma_f32 v[212:213], v[212:213], v[24:25], v[32:33] op_sel_hi:[1,0,1]
    v_mul_f32 v212, v212, abs(v212)
    v_mul_f32 v213, v213, abs(v213)
    v_cvt_pk_bf16_f32 v212, v212, v213
    v_pk_max_i16 v212, v212, 0
    v_pk_fma_f32 v[32:33], v[50:51], v[26:27], v[66:67] op_sel_hi:[1,0,1]
    v_pk_fma_f32 v[214:215], v[214:215], v[24:25], v[32:33] op_sel_hi:[1,0,1]
    v_mul_f32 v214, v214, abs(v214)
    v_mul_f32 v215, v215, abs(v215)
    v_cvt_pk_bf16_f32 v213, v214, v215
    v_pk_max_i16 v213, v213, 0
    v_pk_fma_f32 v[32:33], v[52:53], v[26:27], v[68:69] op_sel_hi:[1,0,1]
    v_pk_fma_f32 v[216:217], v[216:217], v[24:25], v[32:33] op_sel_hi:[1,0,1]
    v_mul_f32 v216, v216, abs(v216)
    v_mul_f32 v217, v217, abs(v217)
    v_cvt_pk_bf16_f32 v214, v216, v217
    v_pk_max_i16 v214, v214, 0
    v_pk_fma_f32 v[32:33], v[54:55], v[26:27], v[70:71] op_sel_hi:[1,0,1]
    v_pk_fma_f32 v[218:219], v[218:219], v[24:25], v[32:33] op_sel_hi:[1,0,1]
    v_mul_f32 v218, v218, abs(v218)
    v_mul_f32 v219, v219, abs(v219)
    v_cvt_pk_bf16_f32 v215, v218, v219
    v_pk_max_i16 v215, v215, 0
    v_pk_fma_f32 v[32:33], v[56:57], v[26:27], v[72:73] op_sel_hi:[1,0,1]
    v_pk_fma_f32 v[220:221], v[220:221], v[24:25], v[32:33] op_sel_hi:[1,0,1]
    v_mul_f32 v220, v220, abs(v220)
    v_mul_f32 v221, v221, abs(v221)
    v_cvt_pk_bf16_f32 v216, v220, v221
    v_pk_max_i16 v216, v216, 0
    v_pk_fma_f32 v[32:33], v[58:59], v[26:27], v[74:75] op_sel_hi:[1,0,1]
    v_pk_fma_f32 v[222:223], v[222:223], v[24:25], v[32:33] op_sel_hi:[1,0,1]
    v_mul_f32 v222, v222, abs(v222)
    v_mul_f32 v223, v223, abs(v223)
    v_cvt_pk_bf16_f32 v217, v222, v223
    v_pk_max_i16 v217, v217, 0
    v_pk_fma_f32 v[32:33], v[60:61], v[26:27], v[76:77] op_sel_hi:[1,0,1]
    v_pk_fma_f32 v[224:225], v[224:225], v[24:25], v[32:33] op_sel_hi:[1,0,1]
    v_mul_f32 v224, v224, abs(v224)
    v_mul_f32 v225, v225, abs(v225)
    v_cvt_pk_bf16_f32 v218, v224, v225
    v_pk_max_i16 v218, v218, 0
    v_pk_fma_f32 v[32:33], v[62:63], v[26:27], v[78:79] op_sel_hi:[1,0,1]
    v_pk_fma_f32 v[226:227], v[226:227], v[24:25], v[32:33] op_sel_hi:[1,0,1]
    v_mul_f32 v226, v226, abs(v226)
    v_mul_f32 v227, v227, abs(v227)
    v_cvt_pk_bf16_f32 v219, v226, v227
    v_pk_max_i16 v219, v219, 0
    v_mov_b32 v32, 163820
L_ow_53:
    ds_read_b32 v33, v32
    s_waitcnt lgkmcnt(0)
    v_readfirstlane_b32 s13, v33
    s_cmp_ge_u32 s13, 5
    s_cbranch_scc1 L_owok_54
    s_sleep 1
    s_branch L_ow_53
L_owok_54:
    s_mul_i32 s20, s8, 3
    s_add_u32 s20, s20, 0
    s_mul_i32 s13, s5, 7
    s_add_u32 s20, s20, s13
    s_lshl_b32 s20, s20, 1
    s_mul_i32 s13, s15, 224
    s_add_u32 s13, s13, s20
    s_lshl_b32 s13, s13, 10
    buffer_store_dwordx4 v[116:119], v5, s[64:67], s13 offen sc1
    buffer_store_dwordx4 v[120:123], v5, s[64:67], s13 offen offset:1024 sc1
    s_mul_i32 s20, s8, 3
    s_add_u32 s20, s20, 0
    s_mul_i32 s13, s5, 7
    s_add_u32 s20, s20, s13
    s_lshl_b32 s20, s20, 1
    s_mul_i32 s13, s16, 224
    s_add_u32 s13, s13, s20
    s_lshl_b32 s13, s13, 10
    buffer_store_dwordx4 v[132:135], v5, s[64:67], s13 offen sc1
    buffer_store_dwordx4 v[136:139], v5, s[64:67], s13 offen offset:1024 sc1
    s_mul_i32 s20, s8, 3
    s_add_u32 s20, s20, 1
    s_mul_i32 s13, s5, 7
    s_add_u32 s20, s20, s13
    s_lshl_b32 s20, s20, 1
    s_mul_i32 s13, s15, 224
    s_add_u32 s13, s13, s20
    s_lshl_b32 s13, s13, 10
    buffer_store_dwordx4 v[148:151], v5, s[64:67], s13 offen sc1
    buffer_store_dwordx4 v[152:155], v5, s[64:67], s13 offen offset:1024 sc1
    s_mul_i32 s20, s8, 3
    s_add_u32 s20, s20, 1
    s_mul_i32 s13, s5, 7
    s_add_u32 s20, s20, s13
    s_lshl_b32 s20, s20, 1
    s_mul_i32 s13, s16, 224
    s_add_u32 s13, s13, s20
    s_lshl_b32 s13, s13, 10
    buffer_store_dwordx4 v[164:167], v5, s[64:67], s13 offen sc1
    buffer_store_dwordx4 v[168:171], v5, s[64:67], s13 offen offset:1024 sc1
    s_mul_i32 s20, s8, 3
    s_add_u32 s20, s20, 2
    s_mul_i32 s13, s5, 7
    s_add_u32 s20, s20, s13
    s_lshl_b32 s20, s20, 1
    s_mul_i32 s13, s15, 224
    s_add_u32 s13, s13, s20
    s_lshl_b32 s13, s13, 10
    buffer_store_dwordx4 v[180:183], v5, s[64:67], s13 offen sc1
    buffer_store_dwordx4 v[184:187], v5, s[64:67], s13 offen offset:1024 sc1
    s_mul_i32 s20, s8, 3
    s_add_u32 s20, s20, 2
    s_mul_i32 s13, s5, 7
    s_add_u32 s20, s20, s13
    s_lshl_b32 s20, s20, 1
    s_mul_i32 s13, s16, 224
    s_add_u32 s13, s13, s20
    s_lshl_b32 s13, s13, 10
    buffer_store_dwordx4 v[196:199], v5, s[64:67], s13 offen sc1
    buffer_store_dwordx4 v[200:203], v5, s[64:67], s13 offen offset:1024 sc1
    s_mov_b32 s20, 6
    s_mul_i32 s13, s5, 7
    s_add_u32 s20, s20, s13
    s_lshl_b32 s20, s20, 1
    s_mul_i32 s13, s15, 224
    s_add_u32 s13, s13, s20
    s_lshl_b32 s13, s13, 10
    buffer_store_dwordx4 v[212:215], v5, s[64:67], s13 offen sc1
    buffer_store_dwordx4 v[216:219], v5, s[64:67], s13 offen offset:1024 sc1
    v_lshrrev_b32 v16, 3, v0
    v_and_b32 v17, 7, v0
    v_and_b32 v1, 2, v16
    v_xor_b32 v17, v17, v1
    v_lshlrev_b32 v17, 4, v17
    v_lshl_add_u32 v1, v16, 11, v17
    s_mov_b32 s72, s52
    s_and_b32 s73, s53, 0xffff
    s_mov_b32 s74, 0x700000
    s_mov_b32 s75, 0x00020000
    s_mul_i32 s88, s8, 3670016
    s_lshl_b32 s13, s7, 16
    s_add_u32 s88, s88, s13
    s_lshl_b32 s13, s5, 7
    s_add_u32 s88, s88, s13
    s_lshl_b32 s96, s8, 13
    s_lshl_b32 s13, s7, 12
    s_add_u32 s96, s96, s13
    s_add_u32 m0, s96, 0
    s_nop 0
    buffer_load_dwordx4 v1, s[72:75], s88 offen lds
    s_add_u32 s88, s88, 16384
    s_add_u32 m0, s96, 1024
    s_nop 0
    buffer_load_dwordx4 v1, s[72:75], s88 offen lds
    s_add_u32 s88, s88, 16384
    s_add_u32 m0, s96, 2048
    s_nop 0
    buffer_load_dwordx4 v1, s[72:75], s88 offen lds
    s_add_u32 s88, s88, 16384
    s_add_u32 m0, s96, 3072
    s_nop 0
    buffer_load_dwordx4 v1, s[72:75], s88 offen lds
    s_add_u32 s88, s88, 81920
    s_add_u32 m0, s96, 16384
    s_nop 0
    buffer_load_dwordx4 v1, s[72:75], s88 offen lds
    s_add_u32 s88, s88, 16384
    s_add_u32 m0, s96, 17408
    s_nop 0
    buffer_load_dwordx4 v1, s[72:75], s88 offen lds
    s_add_u32 s88, s88, 16384
    s_add_u32 m0, s96, 18432
    s_nop 0
    buffer_load_dwordx4 v1, s[72:75], s88 offen lds
    s_add_u32 s88, s88, 16384
    s_add_u32 m0, s96, 19456
    s_nop 0
    buffer_load_dwordx4 v1, s[72:75], s88 offen lds
    s_add_u32 s88, s88, 81920
    s_add_u32 m0, s96, 32768
    s_nop 0
    buffer_load_dwordx4 v1, s[72:75], s88 offen lds
    s_add_u32 s88, s88, 16384
    s_add_u32 m0, s96, 33792
    s_nop 0
    buffer_load_dwordx4 v1, s[72:75], s88 offen lds
    s_add_u32 s88, s88, 16384
    s_add_u32 m0, s96, 34816
    s_nop 0
    buffer_load_dwordx4 v1, s[72:75], s88 offen lds
    s_add_u32 s88, s88, 16384
    s_add_u32 m0, s96, 35840
    s_nop 0
    buffer_load_dwordx4 v1, s[72:75], s88 offen lds
    s_add_u32 s88, s88, 81920
    s_waitcnt vmcnt(0)
    v_mov_b32 v16, 163824
    v_mov_b32 v17, 1
    s_mov_b64 exec, 1
    ds_add_rtn_u32 v18, v16, v17
    s_mov_b64 exec, -1
    s_waitcnt lgkmcnt(0)
    v_readfirstlane_b32 s13, v18
    s_cmp_lg_u32 s13, 3
    s_cbranch_scc1 L_nopost_55
    s_lshl_b32 s13, s4, 4
    s_add_u32 s13, s13, s5
    s_lshl_b32 s13, s13, 3
    s_add_u32 s13, s13, 17825792
    v_mov_b32 v16, s62
    v_mov_b32 v17, s63
    s_mov_b64 exec, 1
    buffer_store_dwordx2 v[16:17], v14, s[64:67], s13 offen sc1
    s_mov_b64 exec, -1
L_nopost_55:
    v_lshrrev_b32 v16, 5, v0
    v_lshlrev_b32 v148, 9, v16
    v_bfe_u32 v16, v0, 2, 2
    v_lshl_add_u32 v148, v16, 7, v148
    v_lshrrev_b32 v16, 1, v16
    v_lshl_add_u32 v148, v16, 5, v148
    v_and_b32 v16, 1, v0
    v_lshl_add_u32 v148, v16, 6, v148
    v_bfe_u32 v16, v0, 4, 1
    v_lshl_add_u32 v148, v16, 4, v148
    v_bfe_u32 v16, v0, 1, 1
    v_lshl_add_u32 v148, v16, 3, v148
    v_xor_b32 v149, 32, v148
    s_lshl_b32 s13, s8, 13
    v_add_u32 v148, s13, v148
    v_add_u32 v149, s13, v149
    v_mov_b32 v15, 163828
    v_mov_b32 v4, 1
    s_mov_b32 s10, 0
    v_lshrrev_b32 v16, 5, v0
    v_lshlrev_b32 v16, 6, v16
    v_and_b32 v17, 31, v0
    v_lshl_add_u32 v17, v17, 11, v16
    s_lshl_b32 s13, s5, 7
    s_lshl_b32 s14, s4, 2
    s_add_u32 s15, s14, s19
    s_add_u32 s14, s14, s18
    s_mul_i32 s16, s8, 114688
    s_mul_i32 s25, s14, 229376
    s_add_u32 s25, s25, s16
    s_mul_i32 s11, s15, 229376
    s_add_u32 s11, s11, s16
    s_lshl_b32 s14, s14, 16
    s_add_u32 s14, s14, s13
    s_mov_b64 exec, 1
    ds_add_u32 v15, v4
    s_mov_b64 exec, -1
    s_add_u32 s10, s10, 4
    s_mov_b32 s28, s54
    s_and_b32 s29, s55, 0xffff
    s_mov_b32 s30, 0x800
    s_mov_b32 s31, 0x00020000
    buffer_load_dwordx4 v[152:155], v16, s[28:31], s13 offen offset:0
    buffer_load_dwordx4 v[156:159], v16, s[28:31], s13 offen offset:16
    buffer_load_dwordx4 v[160:163], v16, s[28:31], s13 offen offset:32
    buffer_load_dwordx4 v[164:167], v16, s[28:31], s13 offen offset:48
    buffer_load_dwordx4 v[168:171], v17, s[68:71], s14 offen offset:0
    buffer_load_dwordx4 v[172:175], v17, s[68:71], s14 offen offset:16
    buffer_load_dwordx4 v[176:179], v17, s[68:71], s14 offen offset:32
    buffer_load_dwordx4 v[180:183], v17, s[68:71], s14 offen offset:48
    v_mov_b32 v116, 0
    v_mov_b32 v117, 0
    v_mov_b32 v118, 0
    v_mov_b32 v119, 0
    v_mov_b32 v120, 0
    v_mov_b32 v121, 0
    v_mov_b32 v122, 0
    v_mov_b32 v123, 0
    v_mov_b32 v124, 0
    v_mov_b32 v125, 0
    v_mov_b32 v126, 0
    v_mov_b32 v127, 0
    v_mov_b32 v128, 0
    v_mov_b32 v129, 0
    v_mov_b32 v130, 0
    v_mov_b32 v131, 0
    v_mov_b32 v132, 0
    v_mov_b32 v133, 0
    v_mov_b32 v134, 0
    v_mov_b32 v135, 0
    v_mov_b32 v136, 0
    v_mov_b32 v137, 0
    v_mov_b32 v138, 0
    v_mov_b32 v139, 0
    v_mov_b32 v140, 0
    v_mov_b32 v141, 0
    v_mov_b32 v142, 0
    v_mov_b32 v143, 0
    v_mov_b32 v144, 0
    v_mov_b32 v145, 0
    v_mov_b32 v146, 0
    v_mov_b32 v147, 0
    v_mov_b32 v184, 0
    v_mov_b32 v185, 0
    v_mov_b32 v186, 0
    v_mov_b32 v187, 0
    v_mov_b32 v188, 0
    v_mov_b32 v189, 0
    v_mov_b32 v190, 0
    v_mov_b32 v191, 0
    v_mov_b32 v192, 0
    v_mov_b32 v193, 0
    v_mov_b32 v194, 0
    v_mov_b32 v195, 0
    v_mov_b32 v196, 0
    v_mov_b32 v197, 0
    v_mov_b32 v198, 0
    v_mov_b32 v199, 0
    v_mov_b32 v200, 0
    v_mov_b32 v201, 0
    v_mov_b32 v202, 0
    v_mov_b32 v203, 0
    v_mov_b32 v204, 0
    v_mov_b32 v205, 0
    v_mov_b32 v206, 0
    v_mov_b32 v207, 0
    v_mov_b32 v208, 0
    v_mov_b32 v209, 0
    v_mov_b32 v210, 0
    v_mov_b32 v211, 0
    v_mov_b32 v212, 0
    v_mov_b32 v213, 0
    v_mov_b32 v214, 0
    v_mov_b32 v215, 0
    s_cmp_lg_u32 s6, 0
    s_cbranch_scc1 L_sp_o_56
    v_and_b32 v16, 15, v0
    v_lshlrev_b32 v16, 3, v16
    s_lshl_b32 s22, s4, 7
    s_add_u32 s22, s22, 17825792
    s_mov_b32 s17, 1048576
L_poll_58:
    buffer_load_dwordx2 v[20:21], v16, s[64:67], s22 offen sc1
    s_waitcnt vmcnt(0)
L_pollc_60:
    v_cmp_ne_u64 vcc, s[62:63], v[20:21]
    s_sub_u32 s17, s17, 1
    s_cbranch_scc1 L_polld_59
    s_cmp_eq_u64 vcc, 0
    s_cbranch_scc1 L_polld_59
    s_sleep 1
    s_branch L_poll_58
L_polld_59:
    v_mov_b32 v16, 163812
    v_mov_b32 v20, 1
    s_mov_b64 exec, 1
    ds_add_u32 v16, v20
    s_mov_b64 exec, -1
    s_branch L_sp_d_57
L_sp_o_56:
    v_mov_b32 v20, 163812
L_ow_61:
    ds_read_b32 v21, v20
    s_waitcnt lgkmcnt(0)
    v_readfirstlane_b32 s13, v21
    s_cmp_ge_u32 s13, 1
    s_cbranch_scc1 L_owok_62
    s_sleep 1
    s_branch L_ow_61
L_owok_62:
    s_waitcnt vmcnt(0)
L_sp_d_57:
    buffer_load_dwordx4 v[52:55], v5, s[64:67], s25 offen sc1
    s_add_u32 s25, s25, 1024
    buffer_load_dwordx4 v[56:59], v5, s[64:67], s11 offen sc1
    s_add_u32 s11, s11, 1024
    buffer_load_dwordx4 v[60:63], v5, s[64:67], s25 offen sc1
    s_add_u32 s25, s25, 1024
    buffer_load_dwordx4 v[64:67], v5, s[64:67], s11 offen sc1
    s_add_u32 s11, s11, 1024
    buffer_load_dwordx4 v[68:71], v5, s[64:67], s25 offen sc1
    s_add_u32 s25, s25, 1024
    buffer_load_dwordx4 v[72:75], v5, s[64:67], s11 offen sc1
    s_add_u32 s11, s11, 1024
    buffer_load_dwordx4 v[76:79], v5, s[64:67], s25 offen sc1
    s_add_u32 s25, s25, 1024
    buffer_load_dwordx4 v[80:83], v5, s[64:67], s11 offen sc1
    s_add_u32 s11, s11, 1024
    buffer_load_dwordx4 v[84:87], v5, s[64:67], s25 offen sc1
    s_add_u32 s25, s25, 1024
    buffer_load_dwordx4 v[88:91], v5, s[64:67], s11 offen sc1
    s_add_u32 s11, s11, 1024
    buffer_load_dwordx4 v[92:95], v5, s[64:67], s25 offen sc1
    s_add_u32 s25, s25, 1024
    buffer_load_dwordx4 v[96:99], v5, s[64:67], s11 offen sc1
    s_add_u32 s11, s11, 1024
    buffer_load_dwordx4 v[100:103], v5, s[64:67], s25 offen sc1
    s_add_u32 s25, s25, 1024
    buffer_load_dwordx4 v[104:107], v5, s[64:67], s11 offen sc1
    s_add_u32 s11, s11, 1024
    buffer_load_dwordx4 v[108:111], v5, s[64:67], s25 offen sc1
    s_add_u32 s25, s25, 1024
    buffer_load_dwordx4 v[112:115], v5, s[64:67], s11 offen sc1
    s_add_u32 s11, s11, 1024
    ds_read_b32 v3, v15
    s_waitcnt lgkmcnt(0)
L_sw_63:
    v_readfirstlane_b32 s13, v3
    s_cmp_ge_u32 s13, s10
    s_cbranch_scc1 L_swok_64
    ds_read_b32 v3, v15
    s_waitcnt lgkmcnt(0)
    s_branch L_sw_63
L_swok_64:
    ds_read_b64_tr_b16 v[20:21], v148 offset:0
    ds_read_b64_tr_b16 v[22:23], v148 offset:1024
    ds_read_b64_tr_b16 v[24:25], v149 offset:0
    ds_read_b64_tr_b16 v[26:27], v149 offset:1024
    ds_read_b64_tr_b16 v[28:29], v148 offset:2048
    ds_read_b64_tr_b16 v[30:31], v148 offset:3072
    ds_read_b64_tr_b16 v[32:33], v149 offset:2048
    ds_read_b64_tr_b16 v[34:35], v149 offset:3072
    s_waitcnt vmcnt(14) lgkmcnt(4)
    v_mfma_f32_32x32x16_bf16 v[116:131], v[20:23], v[52:55], v[116:131]
    s_mov_b64 exec, 1
    ds_add_u32 v15, v4
    s_mov_b64 exec, -1
    s_add_u32 s10, s10, 4
    ds_read_b64_tr_b16 v[36:37], v148 offset:4096
    ds_read_b64_tr_b16 v[38:39], v148 offset:5120
    v_mfma_f32_32x32x16_bf16 v[184:199], v[20:23], v[56:59], v[184:199]
    ds_read_b64_tr_b16 v[40:41], v149 offset:4096
    ds_read_b64_tr_b16 v[42:43], v149 offset:5120
    v_mfma_f32_32x32x16_bf16 v[132:147], v[24:27], v[52:55], v[132:147]
    buffer_load_dwordx4 v[52:55], v5, s[64:67], s25 offen sc1
    s_add_u32 s25, s25, 1024
    v_mfma_f32_32x32x16_bf16 v[200:215], v[24:27], v[56:59], v[200:215]
    buffer_load_dwordx4 v[56:59], v5, s[64:67], s11 offen sc1
    s_add_u32 s11, s11, 1024
    s_waitcnt vmcnt(14) lgkmcnt(5)
    v_mfma_f32_32x32x16_bf16 v[116:131], v[28:31], v[60:63], v[116:131]
    ds_read_b32 v3, v15
    ds_read_b64_tr_b16 v[44:45], v148 offset:6144
    ds_read_b64_tr_b16 v[46:47], v148 offset:7168
    v_mfma_f32_32x32x16_bf16 v[184:199], v[28:31], v[64:67], v[184:199]
    ds_read_b64_tr_b16 v[48:49], v149 offset:6144
    ds_read_b64_tr_b16 v[50:51], v149 offset:7168
    v_mfma_f32_32x32x16_bf16 v[132:147], v[32:35], v[60:63], v[132:147]
    buffer_load_dwordx4 v[60:63], v5, s[64:67], s25 offen sc1
    s_add_u32 s25, s25, 1024
    v_mfma_f32_32x32x16_bf16 v[200:215], v[32:35], v[64:67], v[200:215]
    buffer_load_dwordx4 v[64:67], v5, s[64:67], s11 offen sc1
    s_add_u32 s11, s11, 1024
    s_waitcnt vmcnt(14) lgkmcnt(4)
    v_mfma_f32_32x32x16_bf16 v[116:131], v[36:39], v[68:71], v[116:131]
L_sw_65:
    v_readfirstlane_b32 s13, v3
    s_cmp_ge_u32 s13, s10
    s_cbranch_scc1 L_swok_66
    ds_read_b32 v3, v15
    s_waitcnt lgkmcnt(0)
    s_branch L_sw_65
L_swok_66:
    ds_read_b64_tr_b16 v[20:21], v148 offset:16384
    ds_read_b64_tr_b16 v[22:23], v148 offset:17408
    v_mfma_f32_32x32x16_bf16 v[184:199], v[36:39], v[72:75], v[184:199]
    ds_read_b64_tr_b16 v[24:25], v149 offset:16384
    ds_read_b64_tr_b16 v[26:27], v149 offset:17408
    v_mfma_f32_32x32x16_bf16 v[132:147], v[40:43], v[68:71], v[132:147]
    buffer_load_dwordx4 v[68:71], v5, s[64:67], s25 offen sc1
    s_add_u32 s25, s25, 1024
    s_add_u32 m0, s96, 49152
    s_nop 0
    buffer_load_dwordx4 v1, s[72:75], s88 offen lds
    s_add_u32 s88, s88, 16384
    v_mfma_f32_32x32x16_bf16 v[200:215], v[40:43], v[72:75], v[200:215]
    buffer_load_dwordx4 v[72:75], v5, s[64:67], s11 offen sc1
    s_add_u32 s11, s11, 1024
    s_waitcnt vmcnt(15) lgkmcnt(4)
    v_mfma_f32_32x32x16_bf16 v[116:131], v[44:47], v[76:79], v[116:131]
    ds_read_b64_tr_b16 v[28:29], v148 offset:18432
    ds_read_b64_tr_b16 v[30:31], v148 offset:19456
    v_mfma_f32_32x32x16_bf16 v[184:199], v[44:47], v[80:83], v[184:199]
    ds_read_b64_tr_b16 v[32:33], v149 offset:18432
    ds_read_b64_tr_b16 v[34:35], v149 offset:19456
    v_mfma_f32_32x32x16_bf16 v[132:147], v[48:51], v[76:79], v[132:147]
    buffer_load_dwordx4 v[76:79], v5, s[64:67], s25 offen sc1
    s_add_u32 s25, s25, 1024
    s_add_u32 m0, s96, 50176
    s_nop 0
    buffer_load_dwordx4 v1, s[72:75], s88 offen lds
    s_add_u32 s88, s88, 16384
    v_mfma_f32_32x32x16_bf16 v[200:215], v[48:51], v[80:83], v[200:215]
    buffer_load_dwordx4 v[80:83], v5, s[64:67], s11 offen sc1
    s_add_u32 s11, s11, 1024
    s_waitcnt vmcnt(16) lgkmcnt(4)
    v_mfma_f32_32x32x16_bf16 v[116:131], v[20:23], v[84:87], v[116:131]
    s_mov_b64 exec, 1
    ds_add_u32 v15, v4
    s_mov_b64 exec, -1
    s_add_u32 s10, s10, 4
    ds_read_b64_tr_b16 v[36:37], v148 offset:20480
    ds_read_b64_tr_b16 v[38:39], v148 offset:21504
    v_mfma_f32_32x32x16_bf16 v[184:199], v[20:23], v[88:91], v[184:199]
    ds_read_b64_tr_b16 v[40:41], v149 offset:20480
    ds_read_b64_tr_b16 v[42:43], v149 offset:21504
    v_mfma_f32_32x32x16_bf16 v[132:147], v[24:27], v[84:87], v[132:147]
    buffer_load_dwordx4 v[84:87], v5, s[64:67], s25 offen sc1
    s_add_u32 s25, s25, 1024
    s_add_u32 m0, s96, 51200
    s_nop 0
    buffer_load_dwordx4 v1, s[72:75], s88 offen lds
    s_add_u32 s88, s88, 16384
    v_mfma_f32_32x32x16_bf16 v[200:215], v[24:27], v[88:91], v[200:215]
    buffer_load_dwordx4 v[88:91], v5, s[64:67], s11 offen sc1
    s_add_u32 s11, s11, 1024
    s_waitcnt vmcnt(17) lgkmcnt(5)
    v_mfma_f32_32x32x16_bf16 v[116:131], v[28:31], v[92:95], v[116:131]
    ds_read_b32 v3, v15
    ds_read_b64_tr_b16 v[44:45], v148 offset:22528
    ds_read_b64_tr_b16 v[46:47], v148 offset:23552
    v_mfma_f32_32x32x16_bf16 v[184:199], v[28:31], v[96:99], v[184:199]
    ds_read_b64_tr_b16 v[48:49], v149 offset:22528
    ds_read_b64_tr_b16 v[50:51], v149 offset:23552
    v_mfma_f32_32x32x16_bf16 v[132:147], v[32:35], v[92:95], v[132:147]
    buffer_load_dwordx4 v[92:95], v5, s[64:67], s25 offen sc1
    s_add_u32 s25, s25, 1024
    s_add_u32 m0, s96, 52224
    s_nop 0
    buffer_load_dwordx4 v1, s[72:75], s88 offen lds
    s_add_u32 s88, s88, 81920
    v_mfma_f32_32x32x16_bf16 v[200:215], v[32:35], v[96:99], v[200:215]
    buffer_load_dwordx4 v[96:99], v5, s[64:67], s11 offen sc1
    s_add_u32 s11, s11, 1024
    s_waitcnt vmcnt(18) lgkmcnt(4)
    v_mfma_f32_32x32x16_bf16 v[116:131], v[36:39], v[100:103], v[116:131]
L_sw_67:
    v_readfirstlane_b32 s13, v3
    s_cmp_ge_u32 s13, s10
    s_cbranch_scc1 L_swok_68
    ds_read_b32 v3, v15
    s_waitcnt lgkmcnt(0)
    s_branch L_sw_67
L_swok_68:
    ds_read_b64_tr_b16 v[20:21], v148 offset:32768
    ds_read_b64_tr_b16 v[22:23], v148 offset:33792
    v_mfma_f32_32x32x16_bf16 v[184:199], v[36:39], v[104:107], v[184:199]
    ds_read_b64_tr_b16 v[24:25], v149 offset:32768
    ds_read_b64_tr_b16 v[26:27], v149 offset:33792
    v_mfma_f32_32x32x16_bf16 v[132:147], v[40:43], v[100:103], v[132:147]
    buffer_load_dwordx4 v[100:103], v5, s[64:67], s25 offen sc1
    s_add_u32 s25, s25, 1024
    s_add_u32 m0, s96, 0
    s_nop 0
    buffer_load_dwordx4 v1, s[72:75], s88 offen lds
    s_add_u32 s88, s88, 16384
    v_mfma_f32_32x32x16_bf16 v[200:215], v[40:43], v[104:107], v[200:215]
    buffer_load_dwordx4 v[104:107], v5, s[64:67], s11 offen sc1
    s_add_u32 s11, s11, 1024
    s_waitcnt vmcnt(19) lgkmcnt(4)
    v_mfma_f32_32x32x16_bf16 v[116:131], v[44:47], v[108:111], v[116:131]
    ds_read_b64_tr_b16 v[28:29], v148 offset:34816
    ds_read_b64_tr_b16 v[30:31], v148 offset:35840
    v_mfma_f32_32x32x16_bf16 v[184:199], v[44:47], v[112:115], v[184:199]
    ds_read_b64_tr_b16 v[32:33], v149 offset:34816
    ds_read_b64_tr_b16 v[34:35], v149 offset:35840
    v_mfma_f32_32x32x16_bf16 v[132:147], v[48:51], v[108:111], v[132:147]
    buffer_load_dwordx4 v[108:111], v5, s[64:67], s25 offen sc1
    s_add_u32 s25, s25, 1024
    s_add_u32 m0, s96, 1024
    s_nop 0
    buffer_load_dwordx4 v1, s[72:75], s88 offen lds
    s_add_u32 s88, s88, 16384
    v_mfma_f32_32x32x16_bf16 v[200:215], v[48:51], v[112:115], v[200:215]
    buffer_load_dwordx4 v[112:115], v5, s[64:67], s11 offen sc1
    s_add_u32 s11, s11, 1024
    s_waitcnt vmcnt(7) lgkmcnt(4)
    v_mfma_f32_32x32x16_bf16 v[116:131], v[20:23], v[52:55], v[116:131]
    s_mov_b64 exec, 1
    ds_add_u32 v15, v4
    s_mov_b64 exec, -1
    s_add_u32 s10, s10, 4
    ds_read_b64_tr_b16 v[36:37], v148 offset:36864
    ds_read_b64_tr_b16 v[38:39], v148 offset:37888
    v_mfma_f32_32x32x16_bf16 v[184:199], v[20:23], v[56:59], v[184:199]
    ds_read_b64_tr_b16 v[40:41], v149 offset:36864
    ds_read_b64_tr_b16 v[42:43], v149 offset:37888
    v_mfma_f32_32x32x16_bf16 v[132:147], v[24:27], v[52:55], v[132:147]
    buffer_load_dwordx4 v[52:55], v5, s[64:67], s25 offen sc1
    s_add_u32 s25, s25, 1024
    s_add_u32 m0, s96, 2048
    s_nop 0
    buffer_load_dwordx4 v1, s[72:75], s88 offen lds
    s_add_u32 s88, s88, 16384
    v_mfma_f32_32x32x16_bf16 v[200:215], v[24:27], v[56:59], v[200:215]
    buffer_load_dwordx4 v[56:59], v5, s[64:67], s11 offen sc1
    s_add_u32 s11, s11, 1024
    s_waitcnt vmcnt(21) lgkmcnt(5)
    v_mfma_f32_32x32x16_bf16 v[116:131], v[28:31], v[60:63], v[116:131]
    ds_read_b32 v3, v15
    ds_read_b64_tr_b16 v[44:45], v148 offset:38912
    ds_read_b64_tr_b16 v[46:47], v148 offset:39936
    v_mfma_f32_32x32x16_bf16 v[184:199], v[28:31], v[64:67], v[184:199]
    ds_read_b64_tr_b16 v[48:49], v149 offset:38912
    ds_read_b64_tr_b16 v[50:51], v149 offset:39936
    v_mfma_f32_32x32x16_bf16 v[132:147], v[32:35], v[60:63], v[132:147]
    buffer_load_dwordx4 v[60:63], v5, s[64:67], s25 offen sc1
    s_add_u32 s25, s25, 1024
    s_add_u32 m0, s96, 3072
    s_nop 0
    buffer_load_dwordx4 v1, s[72:75], s88 offen lds
    s_add_u32 s88, s88, 81920
    v_mfma_f32_32x32x16_bf16 v[200:215], v[32:35], v[64:67], v[200:215]
    buffer_load_dwordx4 v[64:67], v5, s[64:67], s11 offen sc1
    s_add_u32 s11, s11, 1024
    s_waitcnt vmcnt(21) lgkmcnt(4)
    v_mfma_f32_32x32x16_bf16 v[116:131], v[36:39], v[68:71], v[116:131]
L_sw_69:
    v_readfirstlane_b32 s13, v3
    s_cmp_ge_u32 s13, s10
    s_cbranch_scc1 L_swok_70
    ds_read_b32 v3, v15
    s_waitcnt lgkmcnt(0)
    s_branch L_sw_69
L_swok_70:
    ds_read_b64_tr_b16 v[20:21], v148 offset:49152
    ds_read_b64_tr_b16 v[22:23], v148 offset:50176
    v_mfma_f32_32x32x16_bf16 v[184:199], v[36:39], v[72:75], v[184:199]
    ds_read_b64_tr_b16 v[24:25], v149 offset:49152
    ds_read_b64_tr_b16 v[26:27], v149 offset:50176
    v_mfma_f32_32x32x16_bf16 v[132:147], v[40:43], v[68:71], v[132:147]
    buffer_load_dwordx4 v[68:71], v5, s[64:67], s25 offen sc1
    s_add_u32 s25, s25, 1024
    s_add_u32 m0, s96, 16384
    s_nop 0
    buffer_load_dwordx4 v1, s[72:75], s88 offen lds
    s_add_u32 s88, s88, 16384
    v_mfma_f32_32x32x16_bf16 v[200:215], v[40:43], v[72:75], v[200:215]
    buffer_load_dwordx4 v[72:75], v5, s[64:67], s11 offen sc1
    s_add_u32 s11, s11, 1024
    s_waitcnt vmcnt(21) lgkmcnt(4)
    v_mfma_f32_32x32x16_bf16 v[116:131], v[44:47], v[76:79], v[116:131]
    ds_read_b64_tr_b16 v[28:29], v148 offset:51200
    ds_read_b64_tr_b16 v[30:31], v148 offset:52224
    v_mfma_f32_32x32x16_bf16 v[184:199], v[44:47], v[80:83], v[184:199]
    ds_read_b64_tr_b16 v[32:33], v149 offset:51200
    ds_read_b64_tr_b16 v[34:35], v149 offset:52224
    v_mfma_f32_32x32x16_bf16 v[132:147], v[48:51], v[76:79], v[132:147]
    buffer_load_dwordx4 v[76:79], v5, s[64:67], s25 offen sc1
    s_add_u32 s25, s25, 1024
    s_add_u32 m0, s96, 17408
    s_nop 0
    buffer_load_dwordx4 v1, s[72:75], s88 offen lds
    s_add_u32 s88, s88, 16384
    v_mfma_f32_32x32x16_bf16 v[200:215], v[48:51], v[80:83], v[200:215]
    buffer_load_dwordx4 v[80:83], v5, s[64:67], s11 offen sc1
    s_add_u32 s11, s11, 1024
    s_waitcnt vmcnt(7) lgkmcnt(4)
    v_mfma_f32_32x32x16_bf16 v[116:131], v[20:23], v[84:87], v[116:131]
    s_mov_b64 exec, 1
    ds_add_u32 v15, v4
    s_mov_b64 exec, -1
    s_add_u32 s10, s10, 4
    ds_read_b64_tr_b16 v[36:37], v148 offset:53248
    ds_read_b64_tr_b16 v[38:39], v148 offset:54272
    v_mfma_f32_32x32x16_bf16 v[184:199], v[20:23], v[88:91], v[184:199]
    ds_read_b64_tr_b16 v[40:41], v149 offset:53248
    ds_read_b64_tr_b16 v[42:43], v149 offset:54272
    v_mfma_f32_32x32x16_bf16 v[132:147], v[24:27], v[84:87], v[132:147]
    buffer_load_dwordx4 v[84:87], v5, s[64:67], s25 offen sc1
    s_add_u32 s25, s25, 1024
    s_add_u32 m0, s96, 18432
    s_nop 0
    buffer_load_dwordx4 v1, s[72:75], s88 offen lds
    s_add_u32 s88, s88, 16384
    v_mfma_f32_32x32x16_bf16 v[200:215], v[24:27], v[88:91], v[200:215]
    buffer_load_dwordx4 v[88:91], v5, s[64:67], s11 offen sc1
    s_add_u32 s11, s11, 1024
    s_waitcnt vmcnt(21) lgkmcnt(5)
    v_mfma_f32_32x32x16_bf16 v[116:131], v[28:31], v[92:95], v[116:131]
    ds_read_b32 v3, v15
    ds_read_b64_tr_b16 v[44:45], v148 offset:55296
    ds_read_b64_tr_b16 v[46:47], v148 offset:56320
    v_mfma_f32_32x32x16_bf16 v[184:199], v[28:31], v[96:99], v[184:199]
    ds_read_b64_tr_b16 v[48:49], v149 offset:55296
    ds_read_b64_tr_b16 v[50:51], v149 offset:56320
    v_mfma_f32_32x32x16_bf16 v[132:147], v[32:35], v[92:95], v[132:147]
    buffer_load_dwordx4 v[92:95], v5, s[64:67], s25 offen sc1
    s_add_u32 s25, s25, 1024
    s_add_u32 m0, s96, 19456
    s_nop 0
    buffer_load_dwordx4 v1, s[72:75], s88 offen lds
    s_add_u32 s88, s88, 81920
    v_mfma_f32_32x32x16_bf16 v[200:215], v[32:35], v[96:99], v[200:215]
    buffer_load_dwordx4 v[96:99], v5, s[64:67], s11 offen sc1
    s_add_u32 s11, s11, 1024
    s_waitcnt vmcnt(21) lgkmcnt(4)
    v_mfma_f32_32x32x16_bf16 v[116:131], v[36:39], v[100:103], v[116:131]
L_sw_71:
    v_readfirstlane_b32 s13, v3
    s_cmp_ge_u32 s13, s10
    s_cbranch_scc1 L_swok_72
    ds_read_b32 v3, v15
    s_waitcnt lgkmcnt(0)
    s_branch L_sw_71
L_swok_72:
    ds_read_b64_tr_b16 v[20:21], v148 offset:0
    ds_read_b64_tr_b16 v[22:23], v148 offset:1024
    v_mfma_f32_32x32x16_bf16 v[184:199], v[36:39], v[104:107], v[184:199]
    ds_read_b64_tr_b16 v[24:25], v149 offset:0
    ds_read_b64_tr_b16 v[26:27], v149 offset:1024
    v_mfma_f32_32x32x16_bf16 v[132:147], v[40:43], v[100:103], v[132:147]
    buffer_load_dwordx4 v[100:103], v5, s[64:67], s25 offen sc1
    s_add_u32 s25, s25, 1024
    s_add_u32 m0, s96, 32768
    s_nop 0
    buffer_load_dwordx4 v1, s[72:75], s88 offen lds
    s_add_u32 s88, s88, 16384
    v_mfma_f32_32x32x16_bf16 v[200:215], v[40:43], v[104:107], v[200:215]
    buffer_load_dwordx4 v[104:107], v5, s[64:67], s11 offen sc1
    s_add_u32 s11, s11, 1024
    s_waitcnt vmcnt(21) lgkmcnt(4)
    v_mfma_f32_32x32x16_bf16 v[116:131], v[44:47], v[108:111], v[116:131]
    ds_read_b64_tr_b16 v[28:29], v148 offset:2048
    ds_read_b64_tr_b16 v[30:31], v148 offset:3072
    v_mfma_f32_32x32x16_bf16 v[184:199], v[44:47], v[112:115], v[184:199]
    ds_read_b64_tr_b16 v[32:33], v149 offset:2048
    ds_read_b64_tr_b16 v[34:35], v149 offset:3072
    v_mfma_f32_32x32x16_bf16 v[132:147], v[48:51], v[108:111], v[132:147]
    buffer_load_dwordx4 v[108:111], v5, s[64:67], s25 offen sc1
    s_add_u32 s25, s25, 1024
    s_add_u32 m0, s96, 33792
    s_nop 0
    buffer_load_dwordx4 v1, s[72:75], s88 offen lds
    s_add_u32 s88, s88, 16384
    v_mfma_f32_32x32x16_bf16 v[200:215], v[48:51], v[112:115], v[200:215]
    buffer_load_dwordx4 v[112:115], v5, s[64:67], s11 offen sc1
    s_add_u32 s11, s11, 1024
    s_mov_b32 s9, 1
.p2align 6
L_bg_loop_73:
    s_waitcnt vmcnt(7) lgkmcnt(4)
    v_mfma_f32_32x32x16_bf16 v[116:131], v[20:23], v[52:55], v[116:131]
    s_mov_b64 exec, 1
    ds_add_u32 v15, v4
    s_mov_b64 exec, -1
    s_add_u32 s10, s10, 4
    ds_read_b64_tr_b16 v[36:37], v148 offset:4096
    ds_read_b64_tr_b16 v[38:39], v148 offset:5120
    v_mfma_f32_32x32x16_bf16 v[184:199], v[20:23], v[56:59], v[184:199]
    ds_read_b64_tr_b16 v[40:41], v149 offset:4096
    ds_read_b64_tr_b16 v[42:43], v149 offset:5120
    v_mfma_f32_32x32x16_bf16 v[132:147], v[24:27], v[52:55], v[132:147]
    buffer_load_dwordx4 v[52:55], v5, s[64:67], s25 offen sc1
    s_add_u32 s25, s25, 1024
    s_add_u32 m0, s96, 34816
    s_nop 0
    buffer_load_dwordx4 v1, s[72:75], s88 offen lds
    s_add_u32 s88, s88, 16384
    v_mfma_f32_32x32x16_bf16 v[200:215], v[24:27], v[56:59], v[200:215]
    buffer_load_dwordx4 v[56:59], v5, s[64:67], s11 offen sc1
    s_add_u32 s11, s11, 1024
    s_waitcnt vmcnt(21) lgkmcnt(5)
    v_mfma_f32_32x32x16_bf16 v[116:131], v[28:31], v[60:63], v[116:131]
    ds_read_b32 v3, v15
    ds_read_b64_tr_b16 v[44:45], v148 offset:6144
    ds_read_b64_tr_b16 v[46:47], v148 offset:7168
    v_mfma_f32_32x32x16_bf16 v[184:199], v[28:31], v[64:67], v[184:199]
    ds_read_b64_tr_b16 v[48:49], v149 offset:6144
    ds_read_b64_tr_b16 v[50:51], v149 offset:7168
    v_mfma_f32_32x32x16_bf16 v[132:147], v[32:35], v[60:63], v[132:147]
    buffer_load_dwordx4 v[60:63], v5, s[64:67], s25 offen sc1
    s_add_u32 s25, s25, 1024
    s_add_u32 m0, s96, 35840
    s_nop 0
    buffer_load_dwordx4 v1, s[72:75], s88 offen lds
    s_add_u32 s88, s88, 81920
    v_mfma_f32_32x32x16_bf16 v[200:215], v[32:35], v[64:67], v[200:215]
    buffer_load_dwordx4 v[64:67], v5, s[64:67], s11 offen sc1
    s_add_u32 s11, s11, 1024
    s_waitcnt vmcnt(21) lgkmcnt(4)
    v_mfma_f32_32x32x16_bf16 v[116:131], v[36:39], v[68:71], v[116:131]
L_sw_114:
    v_readfirstlane_b32 s13, v3
    s_cmp_ge_u32 s13, s10
    s_cbranch_scc1 L_swok_115
    ds_read_b32 v3, v15
    s_waitcnt lgkmcnt(0)
    s_branch L_sw_114
L_swok_115:
    ds_read_b64_tr_b16 v[20:21], v148 offset:16384
    ds_read_b64_tr_b16 v[22:23], v148 offset:17408
    v_mfma_f32_32x32x16_bf16 v[184:199], v[36:39], v[72:75], v[184:199]
    ds_read_b64_tr_b16 v[24:25], v149 offset:16384
    ds_read_b64_tr_b16 v[26:27], v149 offset:17408
    v_mfma_f32_32x32x16_bf16 v[132:147], v[40:43], v[68:71], v[132:147]
    buffer_load_dwordx4 v[68:71], v5, s[64:67], s25 offen sc1
    s_add_u32 s25, s25, 1024
    s_add_u32 m0, s96, 49152
    s_nop 0
    buffer_load_dwordx4 v1, s[72:75], s88 offen lds
    s_add_u32 s88, s88, 16384
    v_mfma_f32_32x32x16_bf16 v[200:215], v[40:43], v[72:75], v[200:215]
    buffer_load_dwordx4 v[72:75], v5, s[64:67], s11 offen sc1
    s_add_u32 s11, s11, 1024
    s_waitcnt vmcnt(21) lgkmcnt(4)
    v_mfma_f32_32x32x16_bf16 v[116:131], v[44:47], v[76:79], v[116:131]
    ds_read_b64_tr_b16 v[28:29], v148 offset:18432
    ds_read_b64_tr_b16 v[30:31], v148 offset:19456
    v_mfma_f32_32x32x16_bf16 v[184:199], v[44:47], v[80:83], v[184:199]
    ds_read_b64_tr_b16 v[32:33], v149 offset:18432
    ds_read_b64_tr_b16 v[34:35], v149 offset:19456
    v_mfma_f32_32x32x16_bf16 v[132:147], v[48:51], v[76:79], v[132:147]
    buffer_load_dwordx4 v[76:79], v5, s[64:67], s25 offen sc1
    s_add_u32 s25, s25, 1024
    s_add_u32 m0, s96, 50176
    s_nop 0
    buffer_load_dwordx4 v1, s[72:75], s88 offen lds
    s_add_u32 s88, s88, 16384
    v_mfma_f32_32x32x16_bf16 v[200:215], v[48:51], v[80:83], v[200:215]
    buffer_load_dwordx4 v[80:83], v5, s[64:67], s11 offen sc1
    s_add_u32 s11, s11, 1024
    s_waitcnt vmcnt(7) lgkmcnt(4)
    v_mfma_f32_32x32x16_bf16 v[116:131], v[20:23], v[84:87], v[116:131]
    s_mov_b64 exec, 1
    ds_add_u32 v15, v4
    s_mov_b64 exec, -1
    s_add_u32 s10, s10, 4
    ds_read_b64_tr_b16 v[36:37], v148 offset:20480
    ds_read_b64_tr_b16 v[38:39], v148 offset:21504
    v_mfma_f32_32x32x16_bf16 v[184:199], v[20:23], v[88:91], v[184:199]
    ds_read_b64_tr_b16 v[40:41], v149 offset:20480
    ds_read_b64_tr_b16 v[42:43], v149 offset:21504
    v_mfma_f32_32x32x16_bf16 v[132:147], v[24:27], v[84:87], v[132:147]
    buffer_load_dwordx4 v[84:87], v5, s[64:67], s25 offen sc1
    s_add_u32 s25, s25, 1024
    s_add_u32 m0, s96, 51200
    s_nop 0
    buffer_load_dwordx4 v1, s[72:75], s88 offen lds
    s_add_u32 s88, s88, 16384
    v_mfma_f32_32x32x16_bf16 v[200:215], v[24:27], v[88:91], v[200:215]
    buffer_load_dwordx4 v[88:91], v5, s[64:67], s11 offen sc1
    s_add_u32 s11, s11, 1024
    s_waitcnt vmcnt(21) lgkmcnt(5)
    v_mfma_f32_32x32x16_bf16 v[116:131], v[28:31], v[92:95], v[116:131]
    ds_read_b32 v3, v15
    ds_read_b64_tr_b16 v[44:45], v148 offset:22528
    ds_read_b64_tr_b16 v[46:47], v148 offset:23552
    v_mfma_f32_32x32x16_bf16 v[184:199], v[28:31], v[96:99], v[184:199]
    ds_read_b64_tr_b16 v[48:49], v149 offset:22528
    ds_read_b64_tr_b16 v[50:51], v149 offset:23552
    v_mfma_f32_32x32x16_bf16 v[132:147], v[32:35], v[92:95], v[132:147]
    buffer_load_dwordx4 v[92:95], v5, s[64:67], s25 offen sc1
    s_add_u32 s25, s25, 1024
    s_add_u32 m0, s96, 52224
    s_nop 0
    buffer_load_dwordx4 v1, s[72:75], s88 offen lds
    s_add_u32 s88, s88, 81920
    v_mfma_f32_32x32x16_bf16 v[200:215], v[32:35], v[96:99], v[200:215]
    buffer_load_dwordx4 v[96:99], v5, s[64:67], s11 offen sc1
    s_add_u32 s11, s11, 1024
    s_waitcnt vmcnt(21) lgkmcnt(4)
    v_mfma_f32_32x32x16_bf16 v[116:131], v[36:39], v[100:103], v[116:131]
L_sw_116:
    v_readfirstlane_b32 s13, v3
    s_cmp_ge_u32 s13, s10
    s_cbranch_scc1 L_swok_117
    ds_read_b32 v3, v15
    s_waitcnt lgkmcnt(0)
    s_branch L_sw_116
L_swok_117:
    ds_read_b64_tr_b16 v[20:21], v148 offset:32768
    ds_read_b64_tr_b16 v[22:23], v148 offset:33792
    v_mfma_f32_32x32x16_bf16 v[184:199], v[36:39], v[104:107], v[184:199]
    ds_read_b64_tr_b16 v[24:25], v149 offset:32768
    ds_read_b64_tr_b16 v[26:27], v149 offset:33792
    v_mfma_f32_32x32x16_bf16 v[132:147], v[40:43], v[100:103], v[132:147]
    buffer_load_dwordx4 v[100:103], v5, s[64:67], s25 offen sc1
    s_add_u32 s25, s25, 1024
    s_add_u32 m0, s96, 0
    s_nop 0
    buffer_load_dwordx4 v1, s[72:75], s88 offen lds
    s_add_u32 s88, s88, 16384
    v_mfma_f32_32x32x16_bf16 v[200:215], v[40:43], v[104:107], v[200:215]
    buffer_load_dwordx4 v[104:107], v5, s[64:67], s11 offen sc1
    s_add_u32 s11, s11, 1024
    s_waitcnt vmcnt(21) lgkmcnt(4)
    v_mfma_f32_32x32x16_bf16 v[116:131], v[44:47], v[108:111], v[116:131]
    ds_read_b64_tr_b16 v[28:29], v148 offset:34816
    ds_read_b64_tr_b16 v[30:31], v148 offset:35840
    v_mfma_f32_32x32x16_bf16 v[184:199], v[44:47], v[112:115], v[184:199]
    ds_read_b64_tr_b16 v[32:33], v149 offset:34816
    ds_read_b64_tr_b16 v[34:35], v149 offset:35840
    v_mfma_f32_32x32x16_bf16 v[132:147], v[48:51], v[108:111], v[132:147]
    buffer_load_dwordx4 v[108:111], v5, s[64:67], s25 offen sc1
    s_add_u32 s25, s25, 1024
    s_add_u32 m0, s96, 1024
    s_nop 0
    buffer_load_dwordx4 v1, s[72:75], s88 offen lds
    s_add_u32 s88, s88, 16384
    v_mfma_f32_32x32x16_bf16 v[200:215], v[48:51], v[112:115], v[200:215]
    buffer_load_dwordx4 v[112:115], v5, s[64:67], s11 offen sc1
    s_add_u32 s11, s11, 1024
    s_waitcnt vmcnt(7) lgkmcnt(4)
    v_mfma_f32_32x32x16_bf16 v[116:131], v[20:23], v[52:55], v[116:131]
    s_mov_b64 exec, 1
    ds_add_u32 v15, v4
    s_mov_b64 exec, -1
    s_add_u32 s10, s10, 4
    ds_read_b64_tr_b16 v[36:37], v148 offset:36864
    ds_read_b64_tr_b16 v[38:39], v148 offset:37888
    v_mfma_f32_32x32x16_bf16 v[184:199], v[20:23], v[56:59], v[184:199]
    ds_read_b64_tr_b16 v[40:41], v149 offset:36864
    ds_read_b64_tr_b16 v[42:43], v149 offset:37888
    v_mfma_f32_32x32x16_bf16 v[132:147], v[24:27], v[52:55], v[132:147]
    buffer_load_dwordx4 v[52:55], v5, s[64:67], s25 offen sc1
    s_add_u32 s25, s25, 1024
    s_add_u32 m0, s96, 2048
    s_nop 0
    buffer_load_dwordx4 v1, s[72:75], s88 offen lds
    s_add_u32 s88, s88, 16384
    v_mfma_f32_32x32x16_bf16 v[200:215], v[24:27], v[56:59], v[200:215]
    buffer_load_dwordx4 v[56:59], v5, s[64:67], s11 offen sc1
    s_add_u32 s11, s11, 1024
    s_waitcnt vmcnt(21) lgkmcnt(5)
    v_mfma_f32_32x32x16_bf16 v[116:131], v[28:31], v[60:63], v[116:131]
    ds_read_b32 v3, v15
    ds_read_b64_tr_b16 v[44:45], v148 offset:38912
    ds_read_b64_tr_b16 v[46:47], v148 offset:39936
    v_mfma_f32_32x32x16_bf16 v[184:199], v[28:31], v[64:67], v[184:199]
    ds_read_b64_tr_b16 v[48:49], v149 offset:38912
    ds_read_b64_tr_b16 v[50:51], v149 offset:39936
    v_mfma_f32_32x32x16_bf16 v[132:147], v[32:35], v[60:63], v[132:147]
    buffer_load_dwordx4 v[60:63], v5, s[64:67], s25 offen sc1
    s_add_u32 s25, s25, 1024
    s_add_u32 m0, s96, 3072
    s_nop 0
    buffer_load_dwordx4 v1, s[72:75], s88 offen lds
    s_add_u32 s88, s88, 81920
    v_mfma_f32_32x32x16_bf16 v[200:215], v[32:35], v[64:67], v[200:215]
    buffer_load_dwordx4 v[64:67], v5, s[64:67], s11 offen sc1
    s_add_u32 s11, s11, 1024
    s_waitcnt vmcnt(21) lgkmcnt(4)
    v_mfma_f32_32x32x16_bf16 v[116:131], v[36:39], v[68:71], v[116:131]
L_sw_118:
    v_readfirstlane_b32 s13, v3
    s_cmp_ge_u32 s13, s10
    s_cbranch_scc1 L_swok_119
    ds_read_b32 v3, v15
    s_waitcnt lgkmcnt(0)
    s_branch L_sw_118
L_swok_119:
    ds_read_b64_tr_b16 v[20:21], v148 offset:49152
    ds_read_b64_tr_b16 v[22:23], v148 offset:50176
    v_mfma_f32_32x32x16_bf16 v[184:199], v[36:39], v[72:75], v[184:199]
    ds_read_b64_tr_b16 v[24:25], v149 offset:49152
    ds_read_b64_tr_b16 v[26:27], v149 offset:50176
    v_mfma_f32_32x32x16_bf16 v[132:147], v[40:43], v[68:71], v[132:147]
    buffer_load_dwordx4 v[68:71], v5, s[64:67], s25 offen sc1
    s_add_u32 s25, s25, 1024
    s_add_u32 m0, s96, 16384
    s_nop 0
    buffer_load_dwordx4 v1, s[72:75], s88 offen lds
    s_add_u32 s88, s88, 16384
    v_mfma_f32_32x32x16_bf16 v[200:215], v[40:43], v[72:75], v[200:215]
    buffer_load_dwordx4 v[72:75], v5, s[64:67], s11 offen sc1
    s_add_u32 s11, s11, 1024
    s_waitcnt vmcnt(21) lgkmcnt(4)
    v_mfma_f32_32x32x16_bf16 v[116:131], v[44:47], v[76:79], v[116:131]
    ds_read_b64_tr_b16 v[28:29], v148 offset:51200
    ds_read_b64_tr_b16 v[30:31], v148 offset:52224
    v_mfma_f32_32x32x16_bf16 v[184:199], v[44:47], v[80:83], v[184:199]
    ds_read_b64_tr_b16 v[32:33], v149 offset:51200
    ds_read_b64_tr_b16 v[34:35], v149 offset:52224
    v_mfma_f32_32x32x16_bf16 v[132:147], v[48:51], v[76:79], v[132:147]
    buffer_load_dwordx4 v[76:79], v5, s[64:67], s25 offen sc1
    s_add_u32 s25, s25, 1024
    s_add_u32 m0, s96, 17408
    s_nop 0
    buffer_load_dwordx4 v1, s[72:75], s88 offen lds
    s_add_u32 s88, s88, 16384
    v_mfma_f32_32x32x16_bf16 v[200:215], v[48:51], v[80:83], v[200:215]
    buffer_load_dwordx4 v[80:83], v5, s[64:67], s11 offen sc1
    s_add_u32 s11, s11, 1024
    s_waitcnt vmcnt(7) lgkmcnt(4)
    v_mfma_f32_32x32x16_bf16 v[116:131], v[20:23], v[84:87], v[116:131]
    s_mov_b64 exec, 1
    ds_add_u32 v15, v4
    s_mov_b64 exec, -1
    s_add_u32 s10, s10, 4
    ds_read_b64_tr_b16 v[36:37], v148 offset:53248
    ds_read_b64_tr_b16 v[38:39], v148 offset:54272
    v_mfma_f32_32x32x16_bf16 v[184:199], v[20:23], v[88:91], v[184:199]
    ds_read_b64_tr_b16 v[40:41], v149 offset:53248
    ds_read_b64_tr_b16 v[42:43], v149 offset:54272
    v_mfma_f32_32x32x16_bf16 v[132:147], v[24:27], v[84:87], v[132:147]
    buffer_load_dwordx4 v[84:87], v5, s[64:67], s25 offen sc1
    s_add_u32 s25, s25, 1024
    s_add_u32 m0, s96, 18432
    s_nop 0
    buffer_load_dwordx4 v1, s[72:75], s88 offen lds
    s_add_u32 s88, s88, 16384
    v_mfma_f32_32x32x16_bf16 v[200:215], v[24:27], v[88:91], v[200:215]
    buffer_load_dwordx4 v[88:91], v5, s[64:67], s11 offen sc1
    s_add_u32 s11, s11, 1024
    s_waitcnt vmcnt(21) lgkmcnt(5)
    v_mfma_f32_32x32x16_bf16 v[116:131], v[28:31], v[92:95], v[116:131]
    ds_read_b32 v3, v15
    ds_read_b64_tr_b16 v[44:45], v148 offset:55296
    ds_read_b64_tr_b16 v[46:47], v148 offset:56320
    v_mfma_f32_32x32x16_bf16 v[184:199], v[28:31], v[96:99], v[184:199]
    ds_read_b64_tr_b16 v[48:49], v149 offset:55296
    ds_read_b64_tr_b16 v[50:51], v149 offset:56320
    v_mfma_f32_32x32x16_bf16 v[132:147], v[32:35], v[92:95], v[132:147]
    buffer_load_dwordx4 v[92:95], v5, s[64:67], s25 offen sc1
    s_add_u32 s25, s25, 1024
    s_add_u32 m0, s96, 19456
    s_nop 0
    buffer_load_dwordx4 v1, s[72:75], s88 offen lds
    s_add_u32 s88, s88, 81920
    v_mfma_f32_32x32x16_bf16 v[200:215], v[32:35], v[96:99], v[200:215]
    buffer_load_dwordx4 v[96:99], v5, s[64:67], s11 offen sc1
    s_add_u32 s11, s11, 1024
    s_waitcnt vmcnt(21) lgkmcnt(4)
    v_mfma_f32_32x32x16_bf16 v[116:131], v[36:39], v[100:103], v[116:131]
L_sw_120:
    v_readfirstlane_b32 s13, v3
    s_cmp_ge_u32 s13, s10
    s_cbranch_scc1 L_swok_121
    ds_read_b32 v3, v15
    s_waitcnt lgkmcnt(0)
    s_branch L_sw_120
L_swok_121:
    ds_read_b64_tr_b16 v[20:21], v148 offset:0
    ds_read_b64_tr_b16 v[22:23], v148 offset:1024
    v_mfma_f32_32x32x16_bf16 v[184:199], v[36:39], v[104:107], v[184:199]
    ds_read_b64_tr_b16 v[24:25], v149 offset:0
    ds_read_b64_tr_b16 v[26:27], v149 offset:1024
    v_mfma_f32_32x32x16_bf16 v[132:147], v[40:43], v[100:103], v[132:147]
    buffer_load_dwordx4 v[100:103], v5, s[64:67], s25 offen sc1
    s_add_u32 s25, s25, 1024
    s_add_u32 m0, s96, 32768
    s_nop 0
    buffer_load_dwordx4 v1, s[72:75], s88 offen lds
    s_add_u32 s88, s88, 16384
    v_mfma_f32_32x32x16_bf16 v[200:215], v[40:43], v[104:107], v[200:215]
    buffer_load_dwordx4 v[104:107], v5, s[64:67], s11 offen sc1
    s_add_u32 s11, s11, 1024
    s_waitcnt vmcnt(21) lgkmcnt(4)
    v_mfma_f32_32x32x16_bf16 v[116:131], v[44:47], v[108:111], v[116:131]
    ds_read_b64_tr_b16 v[28:29], v148 offset:2048
    ds_read_b64_tr_b16 v[30:31], v148 offset:3072
    v_mfma_f32_32x32x16_bf16 v[184:199], v[44:47], v[112:115], v[184:199]
    ds_read_b64_tr_b16 v[32:33], v149 offset:2048
    ds_read_b64_tr_b16 v[34:35], v149 offset:3072
    v_mfma_f32_32x32x16_bf16 v[132:147], v[48:51], v[108:111], v[132:147]
    buffer_load_dwordx4 v[108:111], v5, s[64:67], s25 offen sc1
    s_add_u32 s25, s25, 1024
    s_add_u32 m0, s96, 33792
    s_nop 0
    buffer_load_dwordx4 v1, s[72:75], s88 offen lds
    s_add_u32 s88, s88, 16384
    v_mfma_f32_32x32x16_bf16 v[200:215], v[48:51], v[112:115], v[200:215]
    buffer_load_dwordx4 v[112:115], v5, s[64:67], s11 offen sc1
    s_add_u32 s11, s11, 1024
    s_add_u32 s9, s9, 1
    s_cmp_lt_u32 s9, 6
    s_cbranch_scc1 L_bg_loop_73
    s_waitcnt vmcnt(7) lgkmcnt(4)
    v_mfma_f32_32x32x16_bf16 v[116:131], v[20:23], v[52:55], v[116:131]
    s_mov_b64 exec, 1
    ds_add_u32 v15, v4
    s_mov_b64 exec, -1
    s_add_u32 s10, s10, 4
    ds_read_b64_tr_b16 v[36:37], v148 offset:4096
    ds_read_b64_tr_b16 v[38:39], v148 offset:5120
    v_mfma_f32_32x32x16_bf16 v[184:199], v[20:23], v[56:59], v[184:199]
    ds_read_b64_tr_b16 v[40:41], v149 offset:4096
    ds_read_b64_tr_b16 v[42:43], v149 offset:5120
    v_mfma_f32_32x32x16_bf16 v[132:147], v[24:27], v[52:55], v[132:147]
    buffer_load_dwordx4 v[52:55], v5, s[64:67], s25 offen sc1
    s_add_u32 s25, s25, 1024
    s_add_u32 m0, s96, 34816
    s_nop 0
    buffer_load_dwordx4 v1, s[72:75], s88 offen lds
    s_add_u32 s88, s88, 16384
    v_mfma_f32_32x32x16_bf16 v[200:215], v[24:27], v[56:59], v[200:215]
    buffer_load_dwordx4 v[56:59], v5, s[64:67], s11 offen sc1
    s_add_u32 s11, s11, 1024
    s_waitcnt vmcnt(21) lgkmcnt(5)
    v_mfma_f32_32x32x16_bf16 v[116:131], v[28:31], v[60:63], v[116:131]
    ds_read_b32 v3, v15
    ds_read_b64_tr_b16 v[44:45], v148 offset:6144
    ds_read_b64_tr_b16 v[46:47], v148 offset:7168
    v_mfma_f32_32x32x16_bf16 v[184:199], v[28:31], v[64:67], v[184:199]
    ds_read_b64_tr_b16 v[48:49], v149 offset:6144
    ds_read_b64_tr_b16 v[50:51], v149 offset:7168
    v_mfma_f32_32x32x16_bf16 v[132:147], v[32:35], v[60:63], v[132:147]
    buffer_load_dwordx4 v[60:63], v5, s[64:67], s25 offen sc1
    s_add_u32 s25, s25, 1024
    s_add_u32 m0, s96, 35840
    s_nop 0
    buffer_load_dwordx4 v1, s[72:75], s88 offen lds
    s_add_u32 s88, s88, 81920
    v_mfma_f32_32x32x16_bf16 v[200:215], v[32:35], v[64:67], v[200:215]
    buffer_load_dwordx4 v[64:67], v5, s[64:67], s11 offen sc1
    s_add_u32 s11, s11, 1024
    s_waitcnt vmcnt(21) lgkmcnt(4)
    v_mfma_f32_32x32x16_bf16 v[116:131], v[36:39], v[68:71], v[116:131]
L_sw_122:
    v_readfirstlane_b32 s13, v3
    s_cmp_ge_u32 s13, s10
    s_cbranch_scc1 L_swok_123
    ds_read_b32 v3, v15
    s_waitcnt lgkmcnt(0)
    s_branch L_sw_122
L_swok_123:
    ds_read_b64_tr_b16 v[20:21], v148 offset:16384
    ds_read_b64_tr_b16 v[22:23], v148 offset:17408
    v_mfma_f32_32x32x16_bf16 v[184:199], v[36:39], v[72:75], v[184:199]
    ds_read_b64_tr_b16 v[24:25], v149 offset:16384
    ds_read_b64_tr_b16 v[26:27], v149 offset:17408
    v_mfma_f32_32x32x16_bf16 v[132:147], v[40:43], v[68:71], v[132:147]
    buffer_load_dwordx4 v[68:71], v5, s[64:67], s25 offen sc1
    s_add_u32 s25, s25, 1024
    s_add_u32 m0, s96, 49152
    s_nop 0
    buffer_load_dwordx4 v1, s[72:75], s88 offen lds
    s_add_u32 s88, s88, 16384
    v_mfma_f32_32x32x16_bf16 v[200:215], v[40:43], v[72:75], v[200:215]
    buffer_load_dwordx4 v[72:75], v5, s[64:67], s11 offen sc1
    s_add_u32 s11, s11, 1024
    s_waitcnt vmcnt(21) lgkmcnt(4)
    v_mfma_f32_32x32x16_bf16 v[116:131], v[44:47], v[76:79], v[116:131]
    ds_read_b64_tr_b16 v[28:29], v148 offset:18432
    ds_read_b64_tr_b16 v[30:31], v148 offset:19456
    v_mfma_f32_32x32x16_bf16 v[184:199], v[44:47], v[80:83], v[184:199]
    ds_read_b64_tr_b16 v[32:33], v149 offset:18432
    ds_read_b64_tr_b16 v[34:35], v149 offset:19456
    v_mfma_f32_32x32x16_bf16 v[132:147], v[48:51], v[76:79], v[132:147]
    buffer_load_dwordx4 v[76:79], v5, s[64:67], s25 offen sc1
    s_add_u32 s25, s25, 1024
    s_add_u32 m0, s96, 50176
    s_nop 0
    buffer_load_dwordx4 v1, s[72:75], s88 offen lds
    s_add_u32 s88, s88, 16384
    v_mfma_f32_32x32x16_bf16 v[200:215], v[48:51], v[80:83], v[200:215]
    buffer_load_dwordx4 v[80:83], v5, s[64:67], s11 offen sc1
    s_add_u32 s11, s11, 1024
    s_waitcnt vmcnt(7) lgkmcnt(4)
    v_mfma_f32_32x32x16_bf16 v[116:131], v[20:23], v[84:87], v[116:131]
    s_mov_b64 exec, 1
    ds_add_u32 v15, v4
    s_mov_b64 exec, -1
    s_add_u32 s10, s10, 4
    ds_read_b64_tr_b16 v[36:37], v148 offset:20480
    ds_read_b64_tr_b16 v[38:39], v148 offset:21504
    v_mfma_f32_32x32x16_bf16 v[184:199], v[20:23], v[88:91], v[184:199]
    ds_read_b64_tr_b16 v[40:41], v149 offset:20480
    ds_read_b64_tr_b16 v[42:43], v149 offset:21504
    v_mfma_f32_32x32x16_bf16 v[132:147], v[24:27], v[84:87], v[132:147]
    buffer_load_dwordx4 v[84:87], v5, s[64:67], s25 offen sc1
    s_add_u32 s25, s25, 1024
    s_add_u32 m0, s96, 51200
    s_nop 0
    buffer_load_dwordx4 v1, s[72:75], s88 offen lds
    s_add_u32 s88, s88, 16384
    v_mfma_f32_32x32x16_bf16 v[200:215], v[24:27], v[88:91], v[200:215]
    buffer_load_dwordx4 v[88:91], v5, s[64:67], s11 offen sc1
    s_add_u32 s11, s11, 1024
    s_waitcnt vmcnt(21) lgkmcnt(5)
    v_mfma_f32_32x32x16_bf16 v[116:131], v[28:31], v[92:95], v[116:131]
    ds_read_b32 v3, v15
    ds_read_b64_tr_b16 v[44:45], v148 offset:22528
    ds_read_b64_tr_b16 v[46:47], v148 offset:23552
    v_mfma_f32_32x32x16_bf16 v[184:199], v[28:31], v[96:99], v[184:199]
    ds_read_b64_tr_b16 v[48:49], v149 offset:22528
    ds_read_b64_tr_b16 v[50:51], v149 offset:23552
    v_mfma_f32_32x32x16_bf16 v[132:147], v[32:35], v[92:95], v[132:147]
    buffer_load_dwordx4 v[92:95], v5, s[64:67], s25 offen sc1
    s_add_u32 s25, s25, 1024
    s_add_u32 m0, s96, 52224
    s_nop 0
    buffer_load_dwordx4 v1, s[72:75], s88 offen lds
    s_add_u32 s88, s88, 81920
    v_mfma_f32_32x32x16_bf16 v[200:215], v[32:35], v[96:99], v[200:215]
    buffer_load_dwordx4 v[96:99], v5, s[64:67], s11 offen sc1
    s_add_u32 s11, s11, 1024
    s_waitcnt vmcnt(21) lgkmcnt(4)
    v_mfma_f32_32x32x16_bf16 v[116:131], v[36:39], v[100:103], v[116:131]
L_sw_124:
    v_readfirstlane_b32 s13, v3
    s_cmp_ge_u32 s13, s10
    s_cbranch_scc1 L_swok_125
    ds_read_b32 v3, v15
    s_waitcnt lgkmcnt(0)
    s_branch L_sw_124
L_swok_125:
    ds_read_b64_tr_b16 v[20:21], v148 offset:32768
    ds_read_b64_tr_b16 v[22:23], v148 offset:33792
    v_mfma_f32_32x32x16_bf16 v[184:199], v[36:39], v[104:107], v[184:199]
    ds_read_b64_tr_b16 v[24:25], v149 offset:32768
    ds_read_b64_tr_b16 v[26:27], v149 offset:33792
    v_mfma_f32_32x32x16_bf16 v[132:147], v[40:43], v[100:103], v[132:147]
    buffer_load_dwordx4 v[100:103], v5, s[64:67], s25 offen sc1
    s_add_u32 s25, s25, 1024
    v_mfma_f32_32x32x16_bf16 v[200:215], v[40:43], v[104:107], v[200:215]
    buffer_load_dwordx4 v[104:107], v5, s[64:67], s11 offen sc1
    s_add_u32 s11, s11, 1024
    s_waitcnt vmcnt(20) lgkmcnt(4)
    v_mfma_f32_32x32x16_bf16 v[116:131], v[44:47], v[108:111], v[116:131]
    ds_read_b64_tr_b16 v[28:29], v148 offset:34816
    ds_read_b64_tr_b16 v[30:31], v148 offset:35840
    v_mfma_f32_32x32x16_bf16 v[184:199], v[44:47], v[112:115], v[184:199]
    ds_read_b64_tr_b16 v[32:33], v149 offset:34816
    ds_read_b64_tr_b16 v[34:35], v149 offset:35840
    v_mfma_f32_32x32x16_bf16 v[132:147], v[48:51], v[108:111], v[132:147]
    buffer_load_dwordx4 v[108:111], v5, s[64:67], s25 offen sc1
    s_add_u32 s25, s25, 1024
    v_mfma_f32_32x32x16_bf16 v[200:215], v[48:51], v[112:115], v[200:215]
    buffer_load_dwordx4 v[112:115], v5, s[64:67], s11 offen sc1
    s_add_u32 s11, s11, 1024
    s_waitcnt vmcnt(5) lgkmcnt(4)
    v_mfma_f32_32x32x16_bf16 v[116:131], v[20:23], v[52:55], v[116:131]
    s_mov_b64 exec, 1
    ds_add_u32 v15, v4
    s_mov_b64 exec, -1
    s_add_u32 s10, s10, 4
    ds_read_b64_tr_b16 v[36:37], v148 offset:36864
    ds_read_b64_tr_b16 v[38:39], v148 offset:37888
    v_mfma_f32_32x32x16_bf16 v[184:199], v[20:23], v[56:59], v[184:199]
    ds_read_b64_tr_b16 v[40:41], v149 offset:36864
    ds_read_b64_tr_b16 v[42:43], v149 offset:37888
    v_mfma_f32_32x32x16_bf16 v[132:147], v[24:27], v[52:55], v[132:147]
    v_mfma_f32_32x32x16_bf16 v[200:215], v[24:27], v[56:59], v[200:215]
    s_waitcnt vmcnt(16) lgkmcnt(5)
    v_mfma_f32_32x32x16_bf16 v[116:131], v[28:31], v[60:63], v[116:131]
    ds_read_b32 v3, v15
    ds_read_b64_tr_b16 v[44:45], v148 offset:38912
    ds_read_b64_tr_b16 v[46:47], v148 offset:39936
    v_mfma_f32_32x32x16_bf16 v[184:199], v[28:31], v[64:67], v[184:199]
    ds_read_b64_tr_b16 v[48:49], v149 offset:38912
    ds_read_b64_tr_b16 v[50:51], v149 offset:39936
    v_mfma_f32_32x32x16_bf16 v[132:147], v[32:35], v[60:63], v[132:147]
    v_mfma_f32_32x32x16_bf16 v[200:215], v[32:35], v[64:67], v[200:215]
    s_waitcnt vmcnt(13) lgkmcnt(4)
    v_mfma_f32_32x32x16_bf16 v[116:131], v[36:39], v[68:71], v[116:131]
L_sw_126:
    v_readfirstlane_b32 s13, v3
    s_cmp_ge_u32 s13, s10
    s_cbranch_scc1 L_swok_127
    ds_read_b32 v3, v15
    s_waitcnt lgkmcnt(0)
    s_branch L_sw_126
L_swok_127:
    ds_read_b64_tr_b16 v[20:21], v148 offset:49152
    ds_read_b64_tr_b16 v[22:23], v148 offset:50176
    v_mfma_f32_32x32x16_bf16 v[184:199], v[36:39], v[72:75], v[184:199]
    ds_read_b64_tr_b16 v[24:25], v149 offset:49152
    ds_read_b64_tr_b16 v[26:27], v149 offset:50176
    v_mfma_f32_32x32x16_bf16 v[132:147], v[40:43], v[68:71], v[132:147]
    v_mfma_f32_32x32x16_bf16 v[200:215], v[40:43], v[72:75], v[200:215]
    s_waitcnt vmcnt(10) lgkmcnt(4)
    v_mfma_f32_32x32x16_bf16 v[116:131], v[44:47], v[76:79], v[116:131]
    ds_read_b64_tr_b16 v[28:29], v148 offset:51200
    ds_read_b64_tr_b16 v[30:31], v148 offset:52224
    v_mfma_f32_32x32x16_bf16 v[184:199], v[44:47], v[80:83], v[184:199]
    ds_read_b64_tr_b16 v[32:33], v149 offset:51200
    ds_read_b64_tr_b16 v[34:35], v149 offset:52224
    v_mfma_f32_32x32x16_bf16 v[132:147], v[48:51], v[76:79], v[132:147]
    v_mfma_f32_32x32x16_bf16 v[200:215], v[48:51], v[80:83], v[200:215]
    s_waitcnt vmcnt(7) lgkmcnt(4)
    v_mfma_f32_32x32x16_bf16 v[116:131], v[20:23], v[84:87], v[116:131]
    ds_read_b64_tr_b16 v[36:37], v148 offset:53248
    ds_read_b64_tr_b16 v[38:39], v148 offset:54272
    v_mfma_f32_32x32x16_bf16 v[184:199], v[20:23], v[88:91], v[184:199]
    ds_read_b64_tr_b16 v[40:41], v149 offset:53248
    ds_read_b64_tr_b16 v[42:43], v149 offset:54272
    v_mfma_f32_32x32x16_bf16 v[132:147], v[24:27], v[84:87], v[132:147]
    v_mfma_f32_32x32x16_bf16 v[200:215], v[24:27], v[88:91], v[200:215]
    s_waitcnt vmcnt(4) lgkmcnt(4)
    v_mfma_f32_32x32x16_bf16 v[116:131], v[28:31], v[92:95], v[116:131]
    ds_read_b64_tr_b16 v[44:45], v148 offset:55296
    ds_read_b64_tr_b16 v[46:47], v148 offset:56320
    v_mfma_f32_32x32x16_bf16 v[184:199], v[28:31], v[96:99], v[184:199]
    ds_read_b64_tr_b16 v[48:49], v149 offset:55296
    ds_read_b64_tr_b16 v[50:51], v149 offset:56320
    v_mfma_f32_32x32x16_bf16 v[132:147], v[32:35], v[92:95], v[132:147]
    v_mfma_f32_32x32x16_bf16 v[200:215], v[32:35], v[96:99], v[200:215]
    s_waitcnt vmcnt(2) lgkmcnt(4)
    v_mfma_f32_32x32x16_bf16 v[116:131], v[36:39], v[100:103], v[116:131]
    v_mfma_f32_32x32x16_bf16 v[184:199], v[36:39], v[104:107], v[184:199]
    v_mfma_f32_32x32x16_bf16 v[132:147], v[40:43], v[100:103], v[132:147]
    v_mfma_f32_32x32x16_bf16 v[200:215], v[40:43], v[104:107], v[200:215]
    s_waitcnt vmcnt(0) lgkmcnt(0)
    v_mfma_f32_32x32x16_bf16 v[116:131], v[44:47], v[108:111], v[116:131]
    v_mfma_f32_32x32x16_bf16 v[184:199], v[44:47], v[112:115], v[184:199]
    v_mfma_f32_32x32x16_bf16 v[132:147], v[48:51], v[108:111], v[132:147]
    v_mfma_f32_32x32x16_bf16 v[200:215], v[48:51], v[112:115], v[200:215]
    s_mov_b64 exec, 1
    ds_add_u32 v15, v4
    s_mov_b64 exec, -1
    s_add_u32 s10, s10, 4
    ds_read_b32 v3, v15
    s_waitcnt lgkmcnt(0)
L_sw_128:
    v_readfirstlane_b32 s13, v3
    s_cmp_ge_u32 s13, s10
    s_cbranch_scc1 L_swok_129
    ds_read_b32 v3, v15
    s_waitcnt lgkmcnt(0)
    s_branch L_sw_128
L_swok_129:
    s_nop 7
    s_lshl_b32 s13, s6, 13
    v_add_u32 v16, s13, v5
    v_xor_b32 v17, 0x4000, v16
    ds_write_b128 v16, v[184:187] offset:0
    ds_write_b128 v16, v[188:191] offset:1024
    ds_write_b128 v16, v[192:195] offset:2048
    ds_write_b128 v16, v[196:199] offset:3072
    ds_write_b128 v16, v[200:203] offset:4096
    ds_write_b128 v16, v[204:207] offset:5120
    ds_write_b128 v16, v[208:211] offset:6144
    ds_write_b128 v16, v[212:215] offset:7168
    s_waitcnt lgkmcnt(0)
    s_mov_b64 exec, 1
    ds_add_u32 v15, v4
    s_mov_b64 exec, -1
    s_add_u32 s10, s10, 4
    ds_read_b32 v3, v15
    s_waitcnt lgkmcnt(0)
L_sw_130:
    v_readfirstlane_b32 s13, v3
    s_cmp_ge_u32 s13, s10
    s_cbranch_scc1 L_swok_131
    ds_read_b32 v3, v15
    s_waitcnt lgkmcnt(0)
    s_branch L_sw_130
L_swok_131:
    ds_read_b128 v[184:187], v17 offset:0
    ds_read_b128 v[188:191], v17 offset:1024
    ds_read_b128 v[192:195], v17 offset:2048
    ds_read_b128 v[196:199], v17 offset:3072
    ds_read_b128 v[200:203], v17 offset:4096
    ds_read_b128 v[204:207], v17 offset:5120
    ds_read_b128 v[208:211], v17 offset:6144
    ds_read_b128 v[212:215], v17 offset:7168
    s_waitcnt lgkmcnt(7)
    v_add_f32 v116, v116, v184
    v_add_f32 v117, v117, v185
    v_add_f32 v118, v118, v186
    v_add_f32 v119, v119, v187
    s_waitcnt lgkmcnt(6)
    v_add_f32 v120, v120, v188
    v_add_f32 v121, v121, v189
    v_add_f32 v122, v122, v190
    v_add_f32 v123, v123, v191
    s_waitcnt lgkmcnt(5)
    v_add_f32 v124, v124, v192
    v_add_f32 v125, v125, v193
    v_add_f32 v126, v126, v194
    v_add_f32 v127, v127, v195
    s_waitcnt lgkmcnt(4)
    v_add_f32 v128, v128, v196
    v_add_f32 v129, v129, v197
    v_add_f32 v130, v130, v198
    v_add_f32 v131, v131, v199
    s_waitcnt lgkmcnt(3)
    v_add_f32 v132, v132, v200
    v_add_f32 v133, v133, v201
    v_add_f32 v134, v134, v202
    v_add_f32 v135, v135, v203
    s_waitcnt lgkmcnt(2)
    v_add_f32 v136, v136, v204
    v_add_f32 v137, v137, v205
    v_add_f32 v138, v138, v206
    v_add_f32 v139, v139, v207
    s_waitcnt lgkmcnt(1)
    v_add_f32 v140, v140, v208
    v_add_f32 v141, v141, v209
    v_add_f32 v142, v142, v210
    v_add_f32 v143, v143, v211
    s_waitcnt lgkmcnt(0)
    v_add_f32 v144, v144, v212
    v_add_f32 v145, v145, v213
    v_add_f32 v146, v146, v214
    v_add_f32 v147, v147, v215
    s_mov_b64 exec, 1
    ds_add_u32 v15, v4
    s_mov_b64 exec, -1
    s_add_u32 s10, s10, 4
    ds_read_b32 v3, v15
    s_waitcnt lgkmcnt(0)
L_sw_132:
    v_readfirstlane_b32 s13, v3
    s_cmp_ge_u32 s13, s10
    s_cbranch_scc1 L_swok_133
    ds_read_b32 v3, v15
    s_waitcnt lgkmcnt(0)
    s_branch L_sw_132
L_swok_133:
    v_lshrrev_b32 v16, 3, v0
    v_and_b32 v17, 7, v0
    v_and_b32 v1, 2, v16
    v_xor_b32 v17, v17, v1
    v_lshlrev_b32 v17, 4, v17
    v_lshl_add_u32 v1, v16, 11, v17
    s_mov_b32 s72, s44
    s_and_b32 s73, s45, 0xffff
    s_mov_b32 s74, 0x200000
    s_mov_b32 s75, 0x00020000
    s_lshl_b32 s20, s6, 18
    s_lshl_b32 s14, s5, 7
    s_add_u32 s20, s20, s14
    s_add_u32 s20, s20, 1048576
    s_lshl_b32 s21, s6, 14
    s_add_u32 m0, s21, 0
    s_nop 0
    buffer_load_dwordx4 v1, s[72:75], s20 offen lds
    s_add_u32 s20, s20, 16384
    s_add_u32 m0, s21, 1024
    s_nop 0
    buffer_load_dwordx4 v1, s[72:75], s20 offen lds
    s_add_u32 s20, s20, 16384
    s_add_u32 m0, s21, 2048
    s_nop 0
    buffer_load_dwordx4 v1, s[72:75], s20 offen lds
    s_add_u32 s20, s20, 16384
    s_add_u32 m0, s21, 3072
    s_nop 0
    buffer_load_dwordx4 v1, s[72:75], s20 offen lds
    s_add_u32 s20, s20, 16384
    s_add_u32 m0, s21, 4096
    s_nop 0
    buffer_load_dwordx4 v1, s[72:75], s20 offen lds
    s_add_u32 s20, s20, 16384
    s_add_u32 m0, s21, 5120
    s_nop 0
    buffer_load_dwordx4 v1, s[72:75], s20 offen lds
    s_add_u32 s20, s20, 16384
    s_add_u32 m0, s21, 6144
    s_nop 0
    buffer_load_dwordx4 v1, s[72:75], s20 offen lds
    s_add_u32 s20, s20, 16384
    s_add_u32 m0, s21, 7168
    s_nop 0
    buffer_load_dwordx4 v1, s[72:75], s20 offen lds
    s_add_u32 s20, s20, 16384
    s_add_u32 m0, s21, 8192
    s_nop 0
    buffer_load_dwordx4 v1, s[72:75], s20 offen lds
    s_add_u32 s20, s20, 16384
    s_add_u32 m0, s21, 9216
    s_nop 0
    buffer_load_dwordx4 v1, s[72:75], s20 offen lds
    s_add_u32 s20, s20, 16384
    s_add_u32 m0, s21, 10240
    s_nop 0
    buffer_load_dwordx4 v1, s[72:75], s20 offen lds
    s_add_u32 s20, s20, 16384
    s_add_u32 m0, s21, 11264
    s_nop 0
    buffer_load_dwordx4 v1, s[72:75], s20 offen lds
    s_add_u32 s20, s20, 16384
    s_add_u32 m0, s21, 12288
    s_nop 0
    buffer_load_dwordx4 v1, s[72:75], s20 offen lds
    s_add_u32 s20, s20, 16384
    s_add_u32 m0, s21, 13312
    s_nop 0
    buffer_load_dwordx4 v1, s[72:75], s20 offen lds
    s_add_u32 s20, s20, 16384
    s_add_u32 m0, s21, 14336
    s_nop 0
    buffer_load_dwordx4 v1, s[72:75], s20 offen lds
    s_add_u32 s20, s20, 16384
    s_add_u32 m0, s21, 15360
    s_nop 0
    buffer_load_dwordx4 v1, s[72:75], s20 offen lds
    s_add_u32 s20, s20, 16384
    v_lshrrev_b32 v16, 5, v0
    v_lshlrev_b32 v6, 9, v16
    v_bfe_u32 v16, v0, 2, 2
    v_lshl_add_u32 v6, v16, 7, v6
    v_lshrrev_b32 v16, 1, v16
    v_lshl_add_u32 v6, v16, 5, v6
    v_and_b32 v16, 1, v0
    v_lshl_add_u32 v6, v16, 6, v6
    v_bfe_u32 v16, v0, 4, 1
    v_lshl_add_u32 v6, v16, 4, v6
    v_bfe_u32 v16, v0, 1, 1
    v_lshl_add_u32 v6, v16, 3, v6
    v_xor_b32 v7, 32, v6
    v_lshlrev_b32 v20, 16, v152
    v_add_f32 v116, v116, v20
    v_mul_f32 v21, 0xbfb8aa3b, v116
    v_exp_f32 v21, v21
    s_nop 0
    v_add_f32 v21, 1.0, v21
    v_rcp_f32 v21, v21
    s_nop 0
    v_mul_f32 v116, v116, v21
    v_and_b32 v20, 0xffff0000, v152
    v_add_f32 v117, v117, v20
    v_mul_f32 v21, 0xbfb8aa3b, v117
    v_exp_f32 v21, v21
    s_nop 0
    v_add_f32 v21, 1.0, v21
    v_rcp_f32 v21, v21
    s_nop 0
    v_mul_f32 v117, v117, v21
    v_lshlrev_b32 v20, 16, v153
    v_add_f32 v118, v118, v20
    v_mul_f32 v21, 0xbfb8aa3b, v118
    v_exp_f32 v21, v21
    s_nop 0
    v_add_f32 v21, 1.0, v21
    v_rcp_f32 v21, v21
    s_nop 0
    v_mul_f32 v118, v118, v21
    v_and_b32 v20, 0xffff0000, v153
    v_add_f32 v119, v119, v20
    v_mul_f32 v21, 0xbfb8aa3b, v119
    v_exp_f32 v21, v21
    s_nop 0
    v_add_f32 v21, 1.0, v21
    v_rcp_f32 v21, v21
    s_nop 0
    v_mul_f32 v119, v119, v21
    v_lshlrev_b32 v20, 16, v154
    v_add_f32 v120, v120, v20
    v_mul_f32 v21, 0xbfb8aa3b, v120
    v_exp_f32 v21, v21
    s_nop 0
    v_add_f32 v21, 1.0, v21
    v_rcp_f32 v21, v21
    s_nop 0
    v_mul_f32 v120, v120, v21
    v_and_b32 v20, 0xffff0000, v154
    v_add_f32 v121, v121, v20
    v_mul_f32 v21, 0xbfb8aa3b, v121
    v_exp_f32 v21, v21
    s_nop 0
    v_add_f32 v21, 1.0, v21
    v_rcp_f32 v21, v21
    s_nop 0
    v_mul_f32 v121, v121, v21
    v_lshlrev_b32 v20, 16, v155
    v_add_f32 v122, v122, v20
    v_mul_f32 v21, 0xbfb8aa3b, v122
    v_exp_f32 v21, v21
    s_nop 0
    v_add_f32 v21, 1.0, v21
    v_rcp_f32 v21, v21
    s_nop 0
    v_mul_f32 v122, v122, v21
    v_and_b32 v20, 0xffff0000, v155
    v_add_f32 v123, v123, v20
    v_mul_f32 v21, 0xbfb8aa3b, v123
    v_exp_f32 v21, v21
    s_nop 0
    v_add_f32 v21, 1.0, v21
    v_rcp_f32 v21, v21
    s_nop 0
    v_mul_f32 v123, v123, v21
    v_lshlrev_b32 v20, 16, v156
    v_add_f32 v124, v124, v20
    v_mul_f32 v21, 0xbfb8aa3b, v124
    v_exp_f32 v21, v21
    s_nop 0
    v_add_f32 v21, 1.0, v21
    v_rcp_f32 v21, v21
    s_nop 0
    v_mul_f32 v124, v124, v21
    v_and_b32 v20, 0xffff0000, v156
    v_add_f32 v125, v125, v20
    v_mul_f32 v21, 0xbfb8aa3b, v125
    v_exp_f32 v21, v21
    s_nop 0
    v_add_f32 v21, 1.0, v21
    v_rcp_f32 v21, v21
    s_nop 0
    v_mul_f32 v125, v125, v21
    v_lshlrev_b32 v20, 16, v157
    v_add_f32 v126, v126, v20
    v_mul_f32 v21, 0xbfb8aa3b, v126
    v_exp_f32 v21, v21
    s_nop 0
    v_add_f32 v21, 1.0, v21
    v_rcp_f32 v21, v21
    s_nop 0
    v_mul_f32 v126, v126, v21
    v_and_b32 v20, 0xffff0000, v157
    v_add_f32 v127, v127, v20
    v_mul_f32 v21, 0xbfb8aa3b, v127
    v_exp_f32 v21, v21
    s_nop 0
    v_add_f32 v21, 1.0, v21
    v_rcp_f32 v21, v21
    s_nop 0
    v_mul_f32 v127, v127, v21
    v_lshlrev_b32 v20, 16, v158
    v_add_f32 v128, v128, v20
    v_mul_f32 v21, 0xbfb8aa3b, v128
    v_exp_f32 v21, v21
    s_nop 0
    v_add_f32 v21, 1.0, v21
    v_rcp_f32 v21, v21
    s_nop 0
    v_mul_f32 v128, v128, v21
    v_and_b32 v20, 0xffff0000, v158
    v_add_f32 v129, v129, v20
    v_mul_f32 v21, 0xbfb8aa3b, v129
    v_exp_f32 v21, v21
    s_nop 0
    v_add_f32 v21, 1.0, v21
    v_rcp_f32 v21, v21
    s_nop 0
    v_mul_f32 v129, v129, v21
    v_lshlrev_b32 v20, 16, v159
    v_add_f32 v130, v130, v20
    v_mul_f32 v21, 0xbfb8aa3b, v130
    v_exp_f32 v21, v21
    s_nop 0
    v_add_f32 v21, 1.0, v21
    v_rcp_f32 v21, v21
    s_nop 0
    v_mul_f32 v130, v130, v21
    v_and_b32 v20, 0xffff0000, v159
    v_add_f32 v131, v131, v20
    v_mul_f32 v21, 0xbfb8aa3b, v131
    v_exp_f32 v21, v21
    s_nop 0
    v_add_f32 v21, 1.0, v21
    v_rcp_f32 v21, v21
    s_nop 0
    v_mul_f32 v131, v131, v21
    v_lshlrev_b32 v20, 16, v160
    v_add_f32 v132, v132, v20
    v_mul_f32 v21, 0xbfb8aa3b, v132
    v_exp_f32 v21, v21
    s_nop 0
    v_add_f32 v21, 1.0, v21
    v_rcp_f32 v21, v21
    s_nop 0
    v_mul_f32 v132, v132, v21
    v_and_b32 v20, 0xffff0000, v160
    v_add_f32 v133, v133, v20
    v_mul_f32 v21, 0xbfb8aa3b, v133
    v_exp_f32 v21, v21
    s_nop 0
    v_add_f32 v21, 1.0, v21
    v_rcp_f32 v21, v21
    s_nop 0
    v_mul_f32 v133, v133, v21
    v_lshlrev_b32 v20, 16, v161
    v_add_f32 v134, v134, v20
    v_mul_f32 v21, 0xbfb8aa3b, v134
    v_exp_f32 v21, v21
    s_nop 0
    v_add_f32 v21, 1.0, v21
    v_rcp_f32 v21, v21
    s_nop 0
    v_mul_f32 v134, v134, v21
    v_and_b32 v20, 0xffff0000, v161
    v_add_f32 v135, v135, v20
    v_mul_f32 v21, 0xbfb8aa3b, v135
    v_exp_f32 v21, v21
    s_nop 0
    v_add_f32 v21, 1.0, v21
    v_rcp_f32 v21, v21
    s_nop 0
    v_mul_f32 v135, v135, v21
    v_lshlrev_b32 v20, 16, v162
    v_add_f32 v136, v136, v20
    v_mul_f32 v21, 0xbfb8aa3b, v136
    v_exp_f32 v21, v21
    s_nop 0
    v_add_f32 v21, 1.0, v21
    v_rcp_f32 v21, v21
    s_nop 0
    v_mul_f32 v136, v136, v21
    v_and_b32 v20, 0xffff0000, v162
    v_add_f32 v137, v137, v20
    v_mul_f32 v21, 0xbfb8aa3b, v137
    v_exp_f32 v21, v21
    s_nop 0
    v_add_f32 v21, 1.0, v21
    v_rcp_f32 v21, v21
    s_nop 0
    v_mul_f32 v137, v137, v21
    v_lshlrev_b32 v20, 16, v163
    v_add_f32 v138, v138, v20
    v_mul_f32 v21, 0xbfb8aa3b, v138
    v_exp_f32 v21, v21
    s_nop 0
    v_add_f32 v21, 1.0, v21
    v_rcp_f32 v21, v21
    s_nop 0
    v_mul_f32 v138, v138, v21
    v_and_b32 v20, 0xffff0000, v163
    v_add_f32 v139, v139, v20
    v_mul_f32 v21, 0xbfb8aa3b, v139
    v_exp_f32 v21, v21
    s_nop 0
    v_add_f32 v21, 1.0, v21
    v_rcp_f32 v21, v21
    s_nop 0
    v_mul_f32 v139, v139, v21
    v_lshlrev_b32 v20, 16, v164
    v_add_f32 v140, v140, v20
    v_mul_f32 v21, 0xbfb8aa3b, v140
    v_exp_f32 v21, v21
    s_nop 0
    v_add_f32 v21, 1.0, v21
    v_rcp_f32 v21, v21
    s_nop 0
    v_mul_f32 v140, v140, v21
    v_and_b32 v20, 0xffff0000, v164
    v_add_f32 v141, v141, v20
    v_mul_f32 v21, 0xbfb8aa3b, v141
    v_exp_f32 v21, v21
    s_nop 0
    v_add_f32 v21, 1.0, v21
    v_rcp_f32 v21, v21
    s_nop 0
    v_mul_f32 v141, v141, v21
    v_lshlrev_b32 v20, 16, v165
    v_add_f32 v142, v142, v20
    v_mul_f32 v21, 0xbfb8aa3b, v142
    v_exp_f32 v21, v21
    s_nop 0
    v_add_f32 v21, 1.0, v21
    v_rcp_f32 v21, v21
    s_nop 0
    v_mul_f32 v142, v142, v21
    v_and_b32 v20, 0xffff0000, v165
    v_add_f32 v143, v143, v20
    v_mul_f32 v21, 0xbfb8aa3b, v143
    v_exp_f32 v21, v21
    s_nop 0
    v_add_f32 v21, 1.0, v21
    v_rcp_f32 v21, v21
    s_nop 0
    v_mul_f32 v143, v143, v21
    v_lshlrev_b32 v20, 16, v166
    v_add_f32 v144, v144, v20
    v_mul_f32 v21, 0xbfb8aa3b, v144
    v_exp_f32 v21, v21
    s_nop 0
    v_add_f32 v21, 1.0, v21
    v_rcp_f32 v21, v21
    s_nop 0
    v_mul_f32 v144, v144, v21
    v_and_b32 v20, 0xffff0000, v166
    v_add_f32 v145, v145, v20
    v_mul_f32 v21, 0xbfb8aa3b, v145
    v_exp_f32 v21, v21
    s_nop 0
    v_add_f32 v21, 1.0, v21
    v_rcp_f32 v21, v21
    s_nop 0
    v_mul_f32 v145, v145, v21
    v_lshlrev_b32 v20, 16, v167
    v_add_f32 v146, v146, v20
    v_mul_f32 v21, 0xbfb8aa3b, v146
    v_exp_f32 v21, v21
    s_nop 0
    v_add_f32 v21, 1.0, v21
    v_rcp_f32 v21, v21
    s_nop 0
    v_mul_f32 v146, v146, v21
    v_and_b32 v20, 0xffff0000, v167
    v_add_f32 v147, v147, v20
    v_mul_f32 v21, 0xbfb8aa3b, v147
    v_exp_f32 v21, v21
    s_nop 0
    v_add_f32 v21, 1.0, v21
    v_rcp_f32 v21, v21
    s_nop 0
    v_mul_f32 v147, v147, v21
    v_mov_b32 v184, 0
    v_mov_b32 v185, 0
    v_mov_b32 v186, 0
    v_mov_b32 v187, 0
    v_mov_b32 v188, 0
    v_mov_b32 v189, 0
    v_mov_b32 v190, 0
    v_mov_b32 v191, 0
    v_mov_b32 v192, 0
    v_mov_b32 v193, 0
    v_mov_b32 v194, 0
    v_mov_b32 v195, 0
    v_mov_b32 v196, 0
    v_mov_b32 v197, 0
    v_mov_b32 v198, 0
    v_mov_b32 v199, 0
    v_mov_b32 v200, 0
    v_mov_b32 v201, 0
    v_mov_b32 v202, 0
    v_mov_b32 v203, 0
    v_mov_b32 v204, 0
    v_mov_b32 v205, 0
    v_mov_b32 v206, 0
    v_mov_b32 v207, 0
    v_mov_b32 v208, 0
    v_mov_b32 v209, 0
    v_mov_b32 v210, 0
    v_mov_b32 v211, 0
    v_mov_b32 v212, 0
    v_mov_b32 v213, 0
    v_mov_b32 v214, 0
    v_mov_b32 v215, 0
    v_mov_b32 v16, 163808
L_ow_134:
    ds_read_b32 v17, v16
    s_waitcnt lgkmcnt(0)
    v_readfirstlane_b32 s13, v17
    s_cmp_ge_u32 s13, 1
    s_cbranch_scc1 L_owok_135
    s_sleep 1
    s_branch L_ow_134
L_owok_135:
    s_waitcnt vmcnt(0)
    s_mov_b64 exec, 1
    ds_add_u32 v15, v4
    s_mov_b64 exec, -1
    s_add_u32 s10, s10, 4
    s_lshl_b32 s25, s4, 2
    s_add_u32 s25, s25, s18
    s_lshl_b32 s25, s25, 16
    s_add_u32 s25, s25, 18907136
    buffer_load_dwordx4 v[52:55], v5, s[64:67], s25 offen sc1
    s_add_u32 s25, s25, 1024
    buffer_load_dwordx4 v[56:59], v5, s[64:67], s25 offen sc1
    s_add_u32 s25, s25, 1024
    buffer_load_dwordx4 v[60:63], v5, s[64:67], s25 offen sc1
    s_add_u32 s25, s25, 1024
    buffer_load_dwordx4 v[64:67], v5, s[64:67], s25 offen sc1
    s_add_u32 s25, s25, 1024
    buffer_load_dwordx4 v[68:71], v5, s[64:67], s25 offen sc1
    s_add_u32 s25, s25, 1024
    buffer_load_dwordx4 v[72:75], v5, s[64:67], s25 offen sc1
    s_add_u32 s25, s25, 1024
    buffer_load_dwordx4 v[76:79], v5, s[64:67], s25 offen sc1
    s_add_u32 s25, s25, 1024
    buffer_load_dwordx4 v[80:83], v5, s[64:67], s25 offen sc1
    s_add_u32 s25, s25, 1024
    buffer_load_dwordx4 v[84:87], v5, s[64:67], s25 offen sc1
    s_add_u32 s25, s25, 1024
    buffer_load_dwordx4 v[88:91], v5, s[64:67], s25 offen sc1
    s_add_u32 s25, s25, 1024
    buffer_load_dwordx4 v[92:95], v5, s[64:67], s25 offen sc1
    s_add_u32 s25, s25, 1024
    buffer_load_dwordx4 v[96:99], v5, s[64:67], s25 offen sc1
    s_add_u32 s25, s25, 1024
    buffer_load_dwordx4 v[100:103], v5, s[64:67], s25 offen sc1
    s_add_u32 s25, s25, 1024
    buffer_load_dwordx4 v[104:107], v5, s[64:67], s25 offen sc1
    s_add_u32 s25, s25, 1024
    buffer_load_dwordx4 v[108:111], v5, s[64:67], s25 offen sc1
    s_add_u32 s25, s25, 1024
    buffer_load_dwordx4 v[112:115], v5, s[64:67], s25 offen sc1
    s_add_u32 s25, s25, 1024
    buffer_load_dwordx4 v[216:219], v5, s[64:67], s25 offen sc1
    s_add_u32 s25, s25, 1024
    buffer_load_dwordx4 v[220:223], v5, s[64:67], s25 offen sc1
    s_add_u32 s25, s25, 1024
    buffer_load_dwordx4 v[224:227], v5, s[64:67], s25 offen sc1
    s_add_u32 s25, s25, 1024
    buffer_load_dwordx4 v[228:231], v5, s[64:67], s25 offen sc1
    s_add_u32 s25, s25, 1024
    buffer_load_dwordx4 v[232:235], v5, s[64:67], s25 offen sc1
    s_add_u32 s25, s25, 1024
    buffer_load_dwordx4 v[236:239], v5, s[64:67], s25 offen sc1
    s_add_u32 s25, s25, 1024
    buffer_load_dwordx4 v[240:243], v5, s[64:67], s25 offen sc1
    s_add_u32 s25, s25, 1024
    buffer_load_dwordx4 v[244:247], v5, s[64:67], s25 offen sc1
    s_add_u32 s25, s25, 1024
    ds_read_b32 v3, v15
    s_waitcnt lgkmcnt(0)
L_sw_136:
    v_readfirstlane_b32 s13, v3
    s_cmp_ge_u32 s13, s10
    s_cbranch_scc1 L_swok_137
    ds_read_b32 v3, v15
    s_waitcnt lgkmcnt(0)
    s_branch L_sw_136
L_swok_137:
    ds_read_b64_tr_b16 v[20:21], v6 offset:0
    ds_read_b64_tr_b16 v[22:23], v6 offset:1024
    ds_read_b64_tr_b16 v[24:25], v7 offset:0
    ds_read_b64_tr_b16 v[26:27], v7 offset:1024
    ds_read_b64_tr_b16 v[28:29], v6 offset:2048
    ds_read_b64_tr_b16 v[30:31], v6 offset:3072
    ds_read_b64_tr_b16 v[32:33], v7 offset:2048
    ds_read_b64_tr_b16 v[34:35], v7 offset:3072
    s_waitcnt vmcnt(23) lgkmcnt(4)
    v_mfma_f32_32x32x16_bf16 v[184:199], v[20:23], v[52:55], v[184:199]
    ds_read_b64_tr_b16 v[36:37], v6 offset:4096
    ds_read_b64_tr_b16 v[38:39], v6 offset:5120
    v_mfma_f32_32x32x16_bf16 v[200:215], v[24:27], v[52:55], v[200:215]
    ds_read_b64_tr_b16 v[40:41], v7 offset:4096
    ds_read_b64_tr_b16 v[42:43], v7 offset:5120
    buffer_load_dwordx4 v[52:55], v5, s[64:67], s25 offen sc1
    s_add_u32 s25, s25, 1024
    s_waitcnt vmcnt(23) lgkmcnt(4)
    v_mfma_f32_32x32x16_bf16 v[184:199], v[28:31], v[56:59], v[184:199]
    ds_read_b64_tr_b16 v[44:45], v6 offset:6144
    ds_read_b64_tr_b16 v[46:47], v6 offset:7168
    v_mfma_f32_32x32x16_bf16 v[200:215], v[32:35], v[56:59], v[200:215]
    ds_read_b64_tr_b16 v[48:49], v7 offset:6144
    ds_read_b64_tr_b16 v[50:51], v7 offset:7168
    buffer_load_dwordx4 v[56:59], v5, s[64:67], s25 offen sc1
    s_add_u32 s25, s25, 1024
    s_waitcnt vmcnt(23) lgkmcnt(4)
    v_mfma_f32_32x32x16_bf16 v[184:199], v[36:39], v[60:63], v[184:199]
    ds_read_b64_tr_b16 v[20:21], v6 offset:8192
    ds_read_b64_tr_b16 v[22:23], v6 offset:9216
    v_mfma_f32_32x32x16_bf16 v[200:215], v[40:43], v[60:63], v[200:215]
    ds_read_b64_tr_b16 v[24:25], v7 offset:8192
    ds_read_b64_tr_b16 v[26:27], v7 offset:9216
    buffer_load_dwordx4 v[60:63], v5, s[64:67], s25 offen sc1
    s_add_u32 s25, s25, 1024
    s_waitcnt vmcnt(23) lgkmcnt(4)
    v_mfma_f32_32x32x16_bf16 v[184:199], v[44:47], v[64:67], v[184:199]
    ds_read_b64_tr_b16 v[28:29], v6 offset:10240
    ds_read_b64_tr_b16 v[30:31], v6 offset:11264
    v_mfma_f32_32x32x16_bf16 v[200:215], v[48:51], v[64:67], v[200:215]
    ds_read_b64_tr_b16 v[32:33], v7 offset:10240
    ds_read_b64_tr_b16 v[34:35], v7 offset:11264
    buffer_load_dwordx4 v[64:67], v5, s[64:67], s25 offen sc1
    s_add_u32 s25, s25, 1024
    s_waitcnt vmcnt(23) lgkmcnt(4)
    v_mfma_f32_32x32x16_bf16 v[184:199], v[20:23], v[68:71], v[184:199]
    ds_read_b64_tr_b16 v[36:37], v6 offset:12288
    ds_read_b64_tr_b16 v[38:39], v6 offset:13312
    v_mfma_f32_32x32x16_bf16 v[200:215], v[24:27], v[68:71], v[200:215]
    ds_read_b64_tr_b16 v[40:41], v7 offset:12288
    ds_read_b64_tr_b16 v[42:43], v7 offset:13312
    buffer_load_dwordx4 v[68:71], v5, s[64:67], s25 offen sc1
    s_add_u32 s25, s25, 1024
    s_waitcnt vmcnt(23) lgkmcnt(4)
    v_mfma_f32_32x32x16_bf16 v[184:199], v[28:31], v[72:75], v[184:199]
    ds_read_b64_tr_b16 v[44:45], v6 offset:14336
    ds_read_b64_tr_b16 v[46:47], v6 offset:15360
    v_mfma_f32_32x32x16_bf16 v[200:215], v[32:35], v[72:75], v[200:215]
    ds_read_b64_tr_b16 v[48:49], v7 offset:14336
    ds_read_b64_tr_b16 v[50:51], v7 offset:15360
    buffer_load_dwordx4 v[72:75], v5, s[64:67], s25 offen sc1
    s_add_u32 s25, s25, 1024
    s_waitcnt vmcnt(23) lgkmcnt(4)
    v_mfma_f32_32x32x16_bf16 v[184:199], v[36:39], v[76:79], v[184:199]
    ds_read_b64_tr_b16 v[20:21], v6 offset:16384
    ds_read_b64_tr_b16 v[22:23], v6 offset:17408
    v_mfma_f32_32x32x16_bf16 v[200:215], v[40:43], v[76:79], v[200:215]
    ds_read_b64_tr_b16 v[24:25], v7 offset:16384
    ds_read_b64_tr_b16 v[26:27], v7 offset:17408
    buffer_load_dwordx4 v[76:79], v5, s[64:67], s25 offen sc1
    s_add_u32 s25, s25, 1024
    s_waitcnt vmcnt(23) lgkmcnt(4)
    v_mfma_f32_32x32x16_bf16 v[184:199], v[44:47], v[80:83], v[184:199]
    ds_read_b64_tr_b16 v[28:29], v6 offset:18432
    ds_read_b64_tr_b16 v[30:31], v6 offset:19456
    v_mfma_f32_32x32x16_bf16 v[200:215], v[48:51], v[80:83], v[200:215]
    ds_read_b64_tr_b16 v[32:33], v7 offset:18432
    ds_read_b64_tr_b16 v[34:35], v7 offset:19456
    buffer_load_dwordx4 v[80:83], v5, s[64:67], s25 offen sc1
    s_add_u32 s25, s25, 1024
    s_waitcnt vmcnt(23) lgkmcnt(4)
    v_mfma_f32_32x32x16_bf16 v[184:199], v[20:23], v[84:87], v[184:199]
    ds_read_b64_tr_b16 v[36:37], v6 offset:20480
    ds_read_b64_tr_b16 v[38:39], v6 offset:21504
    v_mfma_f32_32x32x16_bf16 v[200:215], v[24:27], v[84:87], v[200:215]
    ds_read_b64_tr_b16 v[40:41], v7 offset:20480
    ds_read_b64_tr_b16 v[42:43], v7 offset:21504
    s_waitcnt vmcnt(22) lgkmcnt(4)
    v_mfma_f32_32x32x16_bf16 v[184:199], v[28:31], v[88:91], v[184:199]
    ds_read_b64_tr_b16 v[44:45], v6 offset:22528
    ds_read_b64_tr_b16 v[46:47], v6 offset:23552
    v_mfma_f32_32x32x16_bf16 v[200:215], v[32:35], v[88:91], v[200:215]
    ds_read_b64_tr_b16 v[48:49], v7 offset:22528
    ds_read_b64_tr_b16 v[50:51], v7 offset:23552
    s_waitcnt vmcnt(21) lgkmcnt(4)
    v_mfma_f32_32x32x16_bf16 v[184:199], v[36:39], v[92:95], v[184:199]
    ds_read_b64_tr_b16 v[20:21], v6 offset:24576
    ds_read_b64_tr_b16 v[22:23], v6 offset:25600
    v_mfma_f32_32x32x16_bf16 v[200:215], v[40:43], v[92:95], v[200:215]
    ds_read_b64_tr_b16 v[24:25], v7 offset:24576
    ds_read_b64_tr_b16 v[26:27], v7 offset:25600
    s_waitcnt vmcnt(20) lgkmcnt(4)
    v_mfma_f32_32x32x16_bf16 v[184:199], v[44:47], v[96:99], v[184:199]
    ds_read_b64_tr_b16 v[28:29], v6 offset:26624
    ds_read_b64_tr_b16 v[30:31], v6 offset:27648
    v_mfma_f32_32x32x16_bf16 v[200:215], v[48:51], v[96:99], v[200:215]
    ds_read_b64_tr_b16 v[32:33], v7 offset:26624
    ds_read_b64_tr_b16 v[34:35], v7 offset:27648
    s_waitcnt vmcnt(19) lgkmcnt(4)
    v_mfma_f32_32x32x16_bf16 v[184:199], v[20:23], v[100:103], v[184:199]
    ds_read_b64_tr_b16 v[36:37], v6 offset:28672
    ds_read_b64_tr_b16 v[38:39], v6 offset:29696
    v_mfma_f32_32x32x16_bf16 v[200:215], v[24:27], v[100:103], v[200:215]
    ds_read_b64_tr_b16 v[40:41], v7 offset:28672
    ds_read_b64_tr_b16 v[42:43], v7 offset:29696
    s_waitcnt vmcnt(18) lgkmcnt(4)
    v_mfma_f32_32x32x16_bf16 v[184:199], v[28:31], v[104:107], v[184:199]
    ds_read_b64_tr_b16 v[44:45], v6 offset:30720
    ds_read_b64_tr_b16 v[46:47], v6 offset:31744
    v_mfma_f32_32x32x16_bf16 v[200:215], v[32:35], v[104:107], v[200:215]
    ds_read_b64_tr_b16 v[48:49], v7 offset:30720
    ds_read_b64_tr_b16 v[50:51], v7 offset:31744
    s_waitcnt vmcnt(17) lgkmcnt(4)
    v_mfma_f32_32x32x16_bf16 v[184:199], v[36:39], v[108:111], v[184:199]
    ds_read_b64_tr_b16 v[20:21], v6 offset:32768
    ds_read_b64_tr_b16 v[22:23], v6 offset:33792
    v_mfma_f32_32x32x16_bf16 v[200:215], v[40:43], v[108:111], v[200:215]
    ds_read_b64_tr_b16 v[24:25], v7 offset:32768
    ds_read_b64_tr_b16 v[26:27], v7 offset:33792
    s_waitcnt vmcnt(16) lgkmcnt(4)
    v_mfma_f32_32x32x16_bf16 v[184:199], v[44:47], v[112:115], v[184:199]
    ds_read_b64_tr_b16 v[28:29], v6 offset:34816
    ds_read_b64_tr_b16 v[30:31], v6 offset:35840
    v_mfma_f32_32x32x16_bf16 v[200:215], v[48:51], v[112:115], v[200:215]
    ds_read_b64_tr_b16 v[32:33], v7 offset:34816
    ds_read_b64_tr_b16 v[34:35], v7 offset:35840
    s_waitcnt vmcnt(15) lgkmcnt(4)
    v_mfma_f32_32x32x16_bf16 v[184:199], v[20:23], v[216:219], v[184:199]
    ds_read_b64_tr_b16 v[36:37], v6 offset:36864
    ds_read_b64_tr_b16 v[38:39], v6 offset:37888
    v_mfma_f32_32x32x16_bf16 v[200:215], v[24:27], v[216:219], v[200:215]
    ds_read_b64_tr_b16 v[40:41], v7 offset:36864
    ds_read_b64_tr_b16 v[42:43], v7 offset:37888
    s_waitcnt vmcnt(14) lgkmcnt(4)
    v_mfma_f32_32x32x16_bf16 v[184:199], v[28:31], v[220:223], v[184:199]
    ds_read_b64_tr_b16 v[44:45], v6 offset:38912
    ds_read_b64_tr_b16 v[46:47], v6 offset:39936
    v_mfma_f32_32x32x16_bf16 v[200:215], v[32:35], v[220:223], v[200:215]
    ds_read_b64_tr_b16 v[48:49], v7 offset:38912
    ds_read_b64_tr_b16 v[50:51], v7 offset:39936
    s_waitcnt vmcnt(13) lgkmcnt(4)
    v_mfma_f32_32x32x16_bf16 v[184:199], v[36:39], v[224:227], v[184:199]
    ds_read_b64_tr_b16 v[20:21], v6 offset:40960
    ds_read_b64_tr_b16 v[22:23], v6 offset:41984
    v_mfma_f32_32x32x16_bf16 v[200:215], v[40:43], v[224:227], v[200:215]
    ds_read_b64_tr_b16 v[24:25], v7 offset:40960
    ds_read_b64_tr_b16 v[26:27], v7 offset:41984
    s_waitcnt vmcnt(12) lgkmcnt(4)
    v_mfma_f32_32x32x16_bf16 v[184:199], v[44:47], v[228:231], v[184:199]
    ds_read_b64_tr_b16 v[28:29], v6 offset:43008
    ds_read_b64_tr_b16 v[30:31], v6 offset:44032
    v_mfma_f32_32x32x16_bf16 v[200:215], v[48:51], v[228:231], v[200:215]
    ds_read_b64_tr_b16 v[32:33], v7 offset:43008
    ds_read_b64_tr_b16 v[34:35], v7 offset:44032
    s_waitcnt vmcnt(11) lgkmcnt(4)
    v_mfma_f32_32x32x16_bf16 v[184:199], v[20:23], v[232:235], v[184:199]
    ds_read_b64_tr_b16 v[36:37], v6 offset:45056
    ds_read_b64_tr_b16 v[38:39], v6 offset:46080
    v_mfma_f32_32x32x16_bf16 v[200:215], v[24:27], v[232:235], v[200:215]
    ds_read_b64_tr_b16 v[40:41], v7 offset:45056
    ds_read_b64_tr_b16 v[42:43], v7 offset:46080
    s_waitcnt vmcnt(10) lgkmcnt(4)
    v_mfma_f32_32x32x16_bf16 v[184:199], v[28:31], v[236:239], v[184:199]
    ds_read_b64_tr_b16 v[44:45], v6 offset:47104
    ds_read_b64_tr_b16 v[46:47], v6 offset:48128
    v_mfma_f32_32x32x16_bf16 v[200:215], v[32:35], v[236:239], v[200:215]
    ds_read_b64_tr_b16 v[48:49], v7 offset:47104
    ds_read_b64_tr_b16 v[50:51], v7 offset:48128
    s_waitcnt vmcnt(9) lgkmcnt(4)
    v_mfma_f32_32x32x16_bf16 v[184:199], v[36:39], v[240:243], v[184:199]
    ds_read_b64_tr_b16 v[20:21], v6 offset:49152
    ds_read_b64_tr_b16 v[22:23], v6 offset:50176
    v_mfma_f32_32x32x16_bf16 v[200:215], v[40:43], v[240:243], v[200:215]
    ds_read_b64_tr_b16 v[24:25], v7 offset:49152
    ds_read_b64_tr_b16 v[26:27], v7 offset:50176
    s_waitcnt vmcnt(8) lgkmcnt(4)
    v_mfma_f32_32x32x16_bf16 v[184:199], v[44:47], v[244:247], v[184:199]
    ds_read_b64_tr_b16 v[28:29], v6 offset:51200
    ds_read_b64_tr_b16 v[30:31], v6 offset:52224
    v_mfma_f32_32x32x16_bf16 v[200:215], v[48:51], v[244:247], v[200:215]
    ds_read_b64_tr_b16 v[32:33], v7 offset:51200
    ds_read_b64_tr_b16 v[34:35], v7 offset:52224
    s_waitcnt vmcnt(7) lgkmcnt(4)
    v_mfma_f32_32x32x16_bf16 v[184:199], v[20:23], v[52:55], v[184:199]
    ds_read_b64_tr_b16 v[36:37], v6 offset:53248
    ds_read_b64_tr_b16 v[38:39], v6 offset:54272
    v_mfma_f32_32x32x16_bf16 v[200:215], v[24:27], v[52:55], v[200:215]
    ds_read_b64_tr_b16 v[40:41], v7 offset:53248
    ds_read_b64_tr_b16 v[42:43], v7 offset:54272
    s_waitcnt vmcnt(6) lgkmcnt(4)
    v_mfma_f32_32x32x16_bf16 v[184:199], v[28:31], v[56:59], v[184:199]
    ds_read_b64_tr_b16 v[44:45], v6 offset:55296
    ds_read_b64_tr_b16 v[46:47], v6 offset:56320
    v_mfma_f32_32x32x16_bf16 v[200:215], v[32:35], v[56:59], v[200:215]
    ds_read_b64_tr_b16 v[48:49], v7 offset:55296
    ds_read_b64_tr_b16 v[50:51], v7 offset:56320
    s_waitcnt vmcnt(5) lgkmcnt(4)
    v_mfma_f32_32x32x16_bf16 v[184:199], v[36:39], v[60:63], v[184:199]
    ds_read_b64_tr_b16 v[20:21], v6 offset:57344
    ds_read_b64_tr_b16 v[22:23], v6 offset:58368
    v_mfma_f32_32x32x16_bf16 v[200:215], v[40:43], v[60:63], v[200:215]
    ds_read_b64_tr_b16 v[24:25], v7 offset:57344
    ds_read_b64_tr_b16 v[26:27], v7 offset:58368
    s_waitcnt vmcnt(4) lgkmcnt(4)
    v_mfma_f32_32x32x16_bf16 v[184:199], v[44:47], v[64:67], v[184:199]
    ds_read_b64_tr_b16 v[28:29], v6 offset:59392
    ds_read_b64_tr_b16 v[30:31], v6 offset:60416
    v_mfma_f32_32x32x16_bf16 v[200:215], v[48:51], v[64:67], v[200:215]
    ds_read_b64_tr_b16 v[32:33], v7 offset:59392
    ds_read_b64_tr_b16 v[34:35], v7 offset:60416
    s_waitcnt vmcnt(3) lgkmcnt(4)
    v_mfma_f32_32x32x16_bf16 v[184:199], v[20:23], v[68:71], v[184:199]
    ds_read_b64_tr_b16 v[36:37], v6 offset:61440
    ds_read_b64_tr_b16 v[38:39], v6 offset:62464
    v_mfma_f32_32x32x16_bf16 v[200:215], v[24:27], v[68:71], v[200:215]
    ds_read_b64_tr_b16 v[40:41], v7 offset:61440
    ds_read_b64_tr_b16 v[42:43], v7 offset:62464
    s_waitcnt vmcnt(2) lgkmcnt(4)
    v_mfma_f32_32x32x16_bf16 v[184:199], v[28:31], v[72:75], v[184:199]
    ds_read_b64_tr_b16 v[44:45], v6 offset:63488
    ds_read_b64_tr_b16 v[46:47], v6 offset:64512
    v_mfma_f32_32x32x16_bf16 v[200:215], v[32:35], v[72:75], v[200:215]
    ds_read_b64_tr_b16 v[48:49], v7 offset:63488
    ds_read_b64_tr_b16 v[50:51], v7 offset:64512
    s_waitcnt vmcnt(1) lgkmcnt(4)
    v_mfma_f32_32x32x16_bf16 v[184:199], v[36:39], v[76:79], v[184:199]
    v_mfma_f32_32x32x16_bf16 v[200:215], v[40:43], v[76:79], v[200:215]
    s_waitcnt vmcnt(0) lgkmcnt(0)
    v_mfma_f32_32x32x16_bf16 v[184:199], v[44:47], v[80:83], v[184:199]
    v_mfma_f32_32x32x16_bf16 v[200:215], v[48:51], v[80:83], v[200:215]
    s_mov_b32 s28, s56
    s_and_b32 s29, s57, 0xffff
    s_mov_b32 s30, 0x400000
    s_mov_b32 s31, 0x00020000
    v_lshrrev_b32 v16, 5, v0
    v_lshlrev_b32 v16, 6, v16
    v_and_b32 v17, 31, v0
    v_lshl_add_u32 v17, v17, 11, v16
    s_lshl_b32 s15, s5, 7
    s_lshl_b32 s14, s4, 2
    s_add_u32 s14, s14, s18
    s_lshl_b32 s14, s14, 16
    s_add_u32 s14, s14, s15
    s_lshl_b32 s15, s18, 13
    s_add_u32 s15, s15, 65536
    v_add_u32 v16, s15, v5
    v_mov_b32 v18, 163832
L_ow_138:
    ds_read_b32 v19, v18
    s_waitcnt lgkmcnt(0)
    v_readfirstlane_b32 s13, v19
    s_cmp_ge_u32 s13, 148
    s_cbranch_scc1 L_owok_139
    s_sleep 1
    s_branch L_ow_138
L_owok_139:
    ds_read_b128 v[52:55], v16 offset:0
    ds_read_b128 v[56:59], v16 offset:1024
    ds_read_b128 v[60:63], v16 offset:2048
    ds_read_b128 v[64:67], v16 offset:3072
    ds_read_b128 v[68:71], v16 offset:4096
    ds_read_b128 v[72:75], v16 offset:5120
    ds_read_b128 v[76:79], v16 offset:6144
    ds_read_b128 v[80:83], v16 offset:7168
    s_waitcnt lgkmcnt(7)
    v_lshlrev_b32 v18, 16, v168
    v_add_f32 v52, v52, v184
    v_fma_f32 v52, v52, v116, v18
    v_and_b32 v18, 0xffff0000, v168
    v_add_f32 v53, v53, v185
    v_fma_f32 v53, v53, v117, v18
    v_cvt_pk_bf16_f32 v20, v52, v53
    v_lshlrev_b32 v18, 16, v169
    v_add_f32 v54, v54, v186
    v_fma_f32 v54, v54, v118, v18
    v_and_b32 v18, 0xffff0000, v169
    v_add_f32 v55, v55, v187
    v_fma_f32 v55, v55, v119, v18
    v_cvt_pk_bf16_f32 v21, v54, v55
    s_waitcnt lgkmcnt(6)
    v_lshlrev_b32 v18, 16, v170
    v_add_f32 v56, v56, v188
    v_fma_f32 v56, v56, v120, v18
    v_and_b32 v18, 0xffff0000, v170
    v_add_f32 v57, v57, v189
    v_fma_f32 v57, v57, v121, v18
    v_cvt_pk_bf16_f32 v22, v56, v57
    v_lshlrev_b32 v18, 16, v171
    v_add_f32 v58, v58, v190
    v_fma_f32 v58, v58, v122, v18
    v_and_b32 v18, 0xffff0000, v171
    v_add_f32 v59, v59, v191
    v_fma_f32 v59, v59, v123, v18
    v_cvt_pk_bf16_f32 v23, v58, v59
    buffer_store_dwordx4 v[20:23], v17, s[28:31], s14 offen offset:0
    s_waitcnt lgkmcnt(5)
    v_lshlrev_b32 v18, 16, v172
    v_add_f32 v60, v60, v192
    v_fma_f32 v60, v60, v124, v18
    v_and_b32 v18, 0xffff0000, v172
    v_add_f32 v61, v61, v193
    v_fma_f32 v61, v61, v125, v18
    v_cvt_pk_bf16_f32 v24, v60, v61
    v_lshlrev_b32 v18, 16, v173
    v_add_f32 v62, v62, v194
    v_fma_f32 v62, v62, v126, v18
    v_and_b32 v18, 0xffff0000, v173
    v_add_f32 v63, v63, v195
    v_fma_f32 v63, v63, v127, v18
    v_cvt_pk_bf16_f32 v25, v62, v63
    s_waitcnt lgkmcnt(4)
    v_lshlrev_b32 v18, 16, v174
    v_add_f32 v64, v64, v196
    v_fma_f32 v64, v64, v128, v18
    v_and_b32 v18, 0xffff0000, v174
    v_add_f32 v65, v65, v197
    v_fma_f32 v65, v65, v129, v18
    v_cvt_pk_bf16_f32 v26, v64, v65
    v_lshlrev_b32 v18, 16, v175
    v_add_f32 v66, v66, v198
    v_fma_f32 v66, v66, v130, v18
    v_and_b32 v18, 0xffff0000, v175
    v_add_f32 v67, v67, v199
    v_fma_f32 v67, v67, v131, v18
    v_cvt_pk_bf16_f32 v27, v66, v67
    buffer_store_dwordx4 v[24:27], v17, s[28:31], s14 offen offset:16
    s_waitcnt lgkmcnt(3)
    v_lshlrev_b32 v18, 16, v176
    v_add_f32 v68, v68, v200
    v_fma_f32 v68, v68, v132, v18
    v_and_b32 v18, 0xffff0000, v176
    v_add_f32 v69, v69, v201
    v_fma_f32 v69, v69, v133, v18
    v_cvt_pk_bf16_f32 v28, v68, v69
    v_lshlrev_b32 v18, 16, v177
    v_add_f32 v70, v70, v202
    v_fma_f32 v70, v70, v134, v18
    v_and_b32 v18, 0xffff0000, v177
    v_add_f32 v71, v71, v203
    v_fma_f32 v71, v71, v135, v18
    v_cvt_pk_bf16_f32 v29, v70, v71
    s_waitcnt lgkmcnt(2)
    v_lshlrev_b32 v18, 16, v178
    v_add_f32 v72, v72, v204
    v_fma_f32 v72, v72, v136, v18
    v_and_b32 v18, 0xffff0000, v178
    v_add_f32 v73, v73, v205
    v_fma_f32 v73, v73, v137, v18
    v_cvt_pk_bf16_f32 v30, v72, v73
    v_lshlrev_b32 v18, 16, v179
    v_add_f32 v74, v74, v206
    v_fma_f32 v74, v74, v138, v18
    v_and_b32 v18, 0xffff0000, v179
    v_add_f32 v75, v75, v207
    v_fma_f32 v75, v75, v139, v18
    v_cvt_pk_bf16_f32 v31, v74, v75
    buffer_store_dwordx4 v[28:31], v17, s[28:31], s14 offen offset:32
    s_waitcnt lgkmcnt(1)
    v_lshlrev_b32 v18, 16, v180
    v_add_f32 v76, v76, v208
    v_fma_f32 v76, v76, v140, v18
    v_and_b32 v18, 0xffff0000, v180
    v_add_f32 v77, v77, v209
    v_fma_f32 v77, v77, v141, v18
    v_cvt_pk_bf16_f32 v32, v76, v77
    v_lshlrev_b32 v18, 16, v181
    v_add_f32 v78, v78, v210
    v_fma_f32 v78, v78, v142, v18
    v_and_b32 v18, 0xffff0000, v181
    v_add_f32 v79, v79, v211
    v_fma_f32 v79, v79, v143, v18
    v_cvt_pk_bf16_f32 v33, v78, v79
    s_waitcnt lgkmcnt(0)
    v_lshlrev_b32 v18, 16, v182
    v_add_f32 v80, v80, v212
    v_fma_f32 v80, v80, v144, v18
    v_and_b32 v18, 0xffff0000, v182
    v_add_f32 v81, v81, v213
    v_fma_f32 v81, v81, v145, v18
    v_cvt_pk_bf16_f32 v34, v80, v81
    v_lshlrev_b32 v18, 16, v183
    v_add_f32 v82, v82, v214
    v_fma_f32 v82, v82, v146, v18
    v_and_b32 v18, 0xffff0000, v183
    v_add_f32 v83, v83, v215
    v_fma_f32 v83, v83, v147, v18
    v_cvt_pk_bf16_f32 v35, v82, v83
    buffer_store_dwordx4 v[32:35], v17, s[28:31], s14 offen offset:48
    s_endpgm
L_exit:
    s_endpgm
.section .rodata,"a"
.p2align 6
.amdhsa_kernel recurrent_scan__grouped_kv_mqa__dense_activation_squared_relu__prompt_kernel
  .amdhsa_next_free_vgpr 256
  .amdhsa_next_free_sgpr 102
  .amdhsa_accum_offset 256
  .amdhsa_group_segment_fixed_size 0
  .amdhsa_kernarg_size 104
  .amdhsa_user_sgpr_count 2
  .amdhsa_user_sgpr_kernarg_segment_ptr 1
  .amdhsa_system_sgpr_workgroup_id_x 1
.end_amdhsa_kernel
```
